```python
import torch

def _softmax(x, axis=-1):
    return torch.softmax(x, dim=axis)
def _gelu(x):
    return torch.nn.functional.gelu(x, approximate="tanh")
def _silu(x):
    return torch.nn.functional.silu(x)
def _sigmoid(x):
    return torch.sigmoid(x)
def _layernorm(x, axis=-1, eps=1e-5):
    m = x.mean(dim=axis, keepdim=True)
    v = x.var(dim=axis, keepdim=True, unbiased=False)
    return (x - m) / torch.sqrt(v + eps)
def _scatter_add(tgt, idx, src, axis=0):
    return tgt.clone().index_add_(axis, idx, src)
def _segment_sum(src, seg, n):
    out = torch.zeros((n,) + src.shape[1:], dtype=src.dtype)
    return out.index_add_(0, seg, src)
def _pad(x, pw):
    flat = tuple(v for pair in reversed(pw) for v in pair)
    return torch.nn.functional.pad(x, flat)

kernel_name = 'sequential_preLN__mha_block__mixer_channel_mlp__prompt'

def setup_inputs():

    _w = (lambda a: (lambda t: t.to(torch.bfloat16) if t.is_floating_point() else t)(torch.as_tensor(a)))
    def _A_setup():
        B, S, D, H = 1, 2048, 640, 32
        return {
            "x": _w((lambda *s: torch.randn(*s, dtype=torch.bfloat16) * 0.05)(B, S, D)),
            "wqkv": _w((lambda *s: torch.randn(*s, dtype=torch.bfloat16) * 0.05)(D, 3 * D)),
            "wo": _w((lambda *s: torch.randn(*s, dtype=torch.bfloat16) * 0.05)(D, D)),
        }
    _A_in = _A_setup()

    def _B_setup():
        B, S, D, F = 1, 2048, 640, 1728
        return {
            "x": _w((lambda *s: torch.randn(*s, dtype=torch.bfloat16) * 0.05)(B, S, D)),
            "w1": _w((lambda *s: torch.randn(*s, dtype=torch.bfloat16) * 3.2)(D, F) * (D ** -0.5)),
            "b1": _w((lambda *s: torch.randn(*s, dtype=torch.bfloat16) * 1.6)(F)),
            "w2": _w((lambda *s: torch.randn(*s, dtype=torch.bfloat16) * 0.2)(F, D) * (F ** -0.5)),
            "b2": _w((lambda *s: torch.randn(*s, dtype=torch.bfloat16) * 0.4)(D)),
        }
    _B_in = _B_setup()

    return {
        "A_x": _A_in["x"],
        "A_wqkv": _A_in["wqkv"],
        "A_wo": _A_in["wo"],
        "B_x": _B_in["x"],
        "B_w1": _B_in["w1"],
        "B_b1": _B_in["b1"],
        "B_w2": _B_in["w2"],
        "B_b2": _B_in["b2"],
    }

def reference(A_x, A_wqkv, A_wo, B_x, B_w1, B_b1, B_w2, B_b2):
    def _A_ref(x, wqkv, wo):
        B, S, D = x.shape
        H = 32
        Dh = D // H
        qkv = (lambda x, *d: x.permute(*d))((x @ wqkv).reshape(B, S, 3, H, Dh), 2, 0, 3, 1, 4)
        q, k, v = qkv[0], qkv[1], qkv[2]
        scores = torch.einsum("bhqd,bhkd->bhqk", q, k) * (Dh ** -0.5)
        p = _softmax(scores, axis=-1)
        o = torch.einsum("bhqk,bhkd->bhqd", p, v)
        return (lambda x, *d: x.permute(*d))(o, 0, 2, 1, 3).reshape(B, S, D) @ wo

    def _B_ref(x, w1, b1, w2, b2):
        y = _layernorm(x, axis=-1)
        h = _gelu(torch.einsum("bsd,df->bsf", y, w1) + b1)
        return torch.einsum("bsf,fd->bsd", h, w2) + b2

    x = A_x
    h = x + _A_ref(_layernorm(x, axis=-1), A_wqkv, A_wo)
    h2 = h + _B_ref(_layernorm(h, axis=-1), B_w1, B_b1, B_w2, B_b2)
    return h2
```

```asm
; @launch grid=(256,1,1) block=(512,1,1) lds=163840
.amdgcn_target "amdgcn-amd-amdhsa--gfx950"
.text
.globl sequential_preLN__mha_block__mixer_channel_mlp__prompt_kernel
.p2align 8
.type sequential_preLN__mha_block__mixer_channel_mlp__prompt_kernel,@function
sequential_preLN__mha_block__mixer_channel_mlp__prompt_kernel:
    s_cmp_ge_u32 s2, 256
    s_cbranch_scc1 L_f_end
    s_load_dwordx4 s[4:7], s[0:1], 0
    s_load_dwordx2 s[8:9], s[0:1], 80
    s_load_dwordx2 s[10:11], s[0:1], 72
    v_and_b32 v1, 63, v0
    v_lshrrev_b32 v2, 6, v0
    s_and_b32 s27, s2, 7
    v_readfirstlane_b32 s24, v2
    s_lshr_b32 s28, s2, 3
    s_lshr_b32 s25, s27, 1
    s_mov_b32 s29, s25
    s_lshl_b32 s25, s25, 2
    s_and_b32 s26, s28, 3
    s_add_u32 s25, s25, s26
    s_mul_i32 s26, s26, 3
    s_add_u32 s29, s29, s26
    s_and_b32 s27, s27, 1
    s_mul_i32 s26, s27, 5
    s_add_u32 s29, s29, s26
    s_lshr_b32 s39, s28, 2
    s_add_u32 s29, s29, s39
    s_lshl_b32 s26, s27, 3
    s_add_u32 s26, s26, s39
    v_lshrrev_b32 v5, 4, v1
    v_and_b32 v6, 15, v1
    s_mul_i32 s37, s25, 163840
    v_mov_b32 v246, 0
    s_cmp_ge_u32 s26, 15
    s_cbranch_scc1 L_qkv_help
    s_cmp_lt_u32 s24, 4
    s_cbranch_scc1 L_qkv_comp
    s_cmp_ge_u32 s29, 10
    s_cselect_b32 s27, 10, 0
    s_sub_u32 s29, s29, s27
    s_cmp_ge_u32 s29, 10
    s_cselect_b32 s27, 10, 0
    s_sub_u32 s29, s29, s27
    s_add_u32 s29, s25, s26
    s_and_b32 s29, s29, 3
    s_mul_i32 s29, s29, 5
    s_lshr_b32 s29, s29, 1
    s_and_b32 s51, s24, 3
    v_lshrrev_b32 v2, 3, v1
    v_mul_u32_u24 v2, 1280, v2
    v_and_b32 v3, 7, v1
    v_xor_b32 v3, v3, v5
    v_lshl_add_u32 v7, v3, 4, v2
    v_xor_b32 v8, 64, v7
    v_add_u32 v8, 10240, v8
    v_mul_u32_u24 v2, 3840, v5
    v_lshlrev_b32 v3, 1, v5
    v_xor_b32 v3, v3, v6
    v_lshl_add_u32 v9, v3, 4, v2
    v_xor_b32 v10, 128, v9
    v_add_u32 v10, 30720, v10
    s_mul_i32 s27, s51, 40960
    s_add_u32 s37, s37, s27
    s_lshl_b32 s38, s26, 8
    s_mul_i32 s27, s51, 61440
    s_add_u32 s38, s38, s27
    s_lshl_b32 s32, s51, 12
    s_waitcnt lgkmcnt(0)
    s_mov_b32 s12, s4
    s_mov_b32 s13, s5
    s_mov_b32 s14, 2621440
    s_mov_b32 s15, 0x00020000
    s_mov_b32 s16, s6
    s_mov_b32 s17, s7
    s_mov_b32 s18, 2457600
    s_mov_b32 s19, 0x00020000
    s_lshl_b32 s30, s29, 7
    s_add_u32 s30, s30, s37
    s_mul_i32 s31, s29, 245760
    s_add_u32 s31, s31, s38
    s_add_u32 s27, s30, 20480
    s_add_u32 s28, s31, 15360
    s_add_u32 m0, s32, 0
    s_nop 0
    buffer_load_dwordx4 v7, s[12:15], s30 offen lds
    s_add_u32 m0, s32, 16384
    s_nop 0
    buffer_load_dwordx4 v9, s[16:19], s31 offen lds
    s_add_u32 m0, s32, 1024
    s_nop 0
    buffer_load_dwordx4 v8, s[12:15], s30 offen lds
    s_add_u32 m0, s32, 17408
    s_nop 0
    buffer_load_dwordx4 v9, s[16:19], s28 offen lds
    s_add_u32 m0, s32, 2048
    s_nop 0
    buffer_load_dwordx4 v7, s[12:15], s27 offen lds
    s_add_u32 m0, s32, 18432
    s_nop 0
    buffer_load_dwordx4 v10, s[16:19], s31 offen lds
    s_add_u32 m0, s32, 3072
    s_nop 0
    buffer_load_dwordx4 v8, s[12:15], s27 offen lds
    s_add_u32 m0, s32, 19456
    s_nop 0
    buffer_load_dwordx4 v10, s[16:19], s28 offen lds
    s_add_u32 s29, s29, 1
    s_cmp_ge_u32 s29, 10
    s_cselect_b32 s29, 0, s29
    s_lshl_b32 s30, s29, 7
    s_add_u32 s30, s30, s37
    s_mul_i32 s31, s29, 245760
    s_add_u32 s31, s31, s38
    s_add_u32 s27, s30, 20480
    s_add_u32 s28, s31, 15360
    s_add_u32 m0, s32, 32768
    s_nop 0
    buffer_load_dwordx4 v7, s[12:15], s30 offen lds
    s_add_u32 m0, s32, 49152
    s_nop 0
    buffer_load_dwordx4 v9, s[16:19], s31 offen lds
    s_add_u32 m0, s32, 33792
    s_nop 0
    buffer_load_dwordx4 v8, s[12:15], s30 offen lds
    s_add_u32 m0, s32, 50176
    s_nop 0
    buffer_load_dwordx4 v9, s[16:19], s28 offen lds
    s_add_u32 m0, s32, 34816
    s_nop 0
    buffer_load_dwordx4 v7, s[12:15], s27 offen lds
    s_add_u32 m0, s32, 51200
    s_nop 0
    buffer_load_dwordx4 v10, s[16:19], s31 offen lds
    s_add_u32 m0, s32, 35840
    s_nop 0
    buffer_load_dwordx4 v8, s[12:15], s27 offen lds
    s_add_u32 m0, s32, 52224
    s_nop 0
    buffer_load_dwordx4 v10, s[16:19], s28 offen lds
    s_add_u32 s29, s29, 1
    s_cmp_ge_u32 s29, 10
    s_cselect_b32 s29, 0, s29
    s_mov_b32 s20, s8
    s_mov_b32 s21, s9
    s_mov_b32 s22, 35651584
    s_mov_b32 s23, 0x00020000
    s_mov_b32 s76, s10
    s_mov_b32 s77, s11
    s_mov_b32 s78, 256
    s_mov_b32 s79, 0x00020000
    s_waitcnt vmcnt(8)
    s_barrier
    s_lshl_b32 s30, s29, 7
    s_add_u32 s30, s30, s37
    s_mul_i32 s31, s29, 245760
    s_add_u32 s31, s31, s38
    s_add_u32 s27, s30, 20480
    s_add_u32 s28, s31, 15360
    s_add_u32 m0, s32, 65536
    s_nop 0
    buffer_load_dwordx4 v7, s[12:15], s30 offen lds
    s_add_u32 m0, s32, 81920
    s_nop 0
    buffer_load_dwordx4 v9, s[16:19], s31 offen lds
    s_add_u32 m0, s32, 66560
    s_nop 0
    buffer_load_dwordx4 v8, s[12:15], s30 offen lds
    s_add_u32 m0, s32, 82944
    s_nop 0
    buffer_load_dwordx4 v9, s[16:19], s28 offen lds
    s_add_u32 m0, s32, 67584
    s_nop 0
    buffer_load_dwordx4 v7, s[12:15], s27 offen lds
    s_add_u32 m0, s32, 83968
    s_nop 0
    buffer_load_dwordx4 v10, s[16:19], s31 offen lds
    s_add_u32 m0, s32, 68608
    s_nop 0
    buffer_load_dwordx4 v8, s[12:15], s27 offen lds
    s_add_u32 m0, s32, 84992
    s_nop 0
    buffer_load_dwordx4 v10, s[16:19], s28 offen lds
    s_add_u32 s29, s29, 1
    s_cmp_ge_u32 s29, 10
    s_cselect_b32 s29, 0, s29
    s_waitcnt vmcnt(8)
    s_barrier
    s_lshl_b32 s30, s29, 7
    s_add_u32 s30, s30, s37
    s_mul_i32 s31, s29, 245760
    s_add_u32 s31, s31, s38
    s_add_u32 s27, s30, 20480
    s_add_u32 s28, s31, 15360
    s_add_u32 m0, s32, 98304
    s_nop 0
    buffer_load_dwordx4 v7, s[12:15], s30 offen lds
    s_add_u32 m0, s32, 114688
    s_nop 0
    buffer_load_dwordx4 v9, s[16:19], s31 offen lds
    s_add_u32 m0, s32, 99328
    s_nop 0
    buffer_load_dwordx4 v8, s[12:15], s30 offen lds
    s_add_u32 m0, s32, 115712
    s_nop 0
    buffer_load_dwordx4 v9, s[16:19], s28 offen lds
    s_add_u32 m0, s32, 100352
    s_nop 0
    buffer_load_dwordx4 v7, s[12:15], s27 offen lds
    s_add_u32 m0, s32, 116736
    s_nop 0
    buffer_load_dwordx4 v10, s[16:19], s31 offen lds
    s_add_u32 m0, s32, 101376
    s_nop 0
    buffer_load_dwordx4 v8, s[12:15], s27 offen lds
    s_add_u32 m0, s32, 117760
    s_nop 0
    buffer_load_dwordx4 v10, s[16:19], s28 offen lds
    s_add_u32 s29, s29, 1
    s_cmp_ge_u32 s29, 10
    s_cselect_b32 s29, 0, s29
    s_waitcnt vmcnt(8)
    s_barrier
    s_lshl_b32 s30, s29, 7
    s_add_u32 s30, s30, s37
    s_mul_i32 s31, s29, 245760
    s_add_u32 s31, s31, s38
    s_add_u32 s27, s30, 20480
    s_add_u32 s28, s31, 15360
    s_add_u32 m0, s32, 131072
    s_nop 0
    buffer_load_dwordx4 v7, s[12:15], s30 offen lds
    s_add_u32 m0, s32, 147456
    s_nop 0
    buffer_load_dwordx4 v9, s[16:19], s31 offen lds
    s_add_u32 m0, s32, 132096
    s_nop 0
    buffer_load_dwordx4 v8, s[12:15], s30 offen lds
    s_add_u32 m0, s32, 148480
    s_nop 0
    buffer_load_dwordx4 v9, s[16:19], s28 offen lds
    s_add_u32 m0, s32, 133120
    s_nop 0
    buffer_load_dwordx4 v7, s[12:15], s27 offen lds
    s_add_u32 m0, s32, 149504
    s_nop 0
    buffer_load_dwordx4 v10, s[16:19], s31 offen lds
    s_add_u32 m0, s32, 134144
    s_nop 0
    buffer_load_dwordx4 v8, s[12:15], s27 offen lds
    s_add_u32 m0, s32, 150528
    s_nop 0
    buffer_load_dwordx4 v10, s[16:19], s28 offen lds
    s_add_u32 s29, s29, 1
    s_cmp_ge_u32 s29, 10
    s_cselect_b32 s29, 0, s29
    s_waitcnt vmcnt(8)
    s_barrier
    s_lshl_b32 s30, s29, 7
    s_add_u32 s30, s30, s37
    s_mul_i32 s31, s29, 245760
    s_add_u32 s31, s31, s38
    s_add_u32 s27, s30, 20480
    s_add_u32 s28, s31, 15360
    s_add_u32 m0, s32, 0
    s_nop 0
    buffer_load_dwordx4 v7, s[12:15], s30 offen lds
    s_add_u32 m0, s32, 16384
    s_nop 0
    buffer_load_dwordx4 v9, s[16:19], s31 offen lds
    s_add_u32 m0, s32, 1024
    s_nop 0
    buffer_load_dwordx4 v8, s[12:15], s30 offen lds
    s_add_u32 m0, s32, 17408
    s_nop 0
    buffer_load_dwordx4 v9, s[16:19], s28 offen lds
    s_add_u32 m0, s32, 2048
    s_nop 0
    buffer_load_dwordx4 v7, s[12:15], s27 offen lds
    s_add_u32 m0, s32, 18432
    s_nop 0
    buffer_load_dwordx4 v10, s[16:19], s31 offen lds
    s_add_u32 m0, s32, 3072
    s_nop 0
    buffer_load_dwordx4 v8, s[12:15], s27 offen lds
    s_add_u32 m0, s32, 19456
    s_nop 0
    buffer_load_dwordx4 v10, s[16:19], s28 offen lds
    s_add_u32 s29, s29, 1
    s_cmp_ge_u32 s29, 10
    s_cselect_b32 s29, 0, s29
    s_waitcnt vmcnt(8)
    s_barrier
    s_lshl_b32 s30, s29, 7
    s_add_u32 s30, s30, s37
    s_mul_i32 s31, s29, 245760
    s_add_u32 s31, s31, s38
    s_add_u32 s27, s30, 20480
    s_add_u32 s28, s31, 15360
    s_add_u32 m0, s32, 32768
    s_nop 0
    buffer_load_dwordx4 v7, s[12:15], s30 offen lds
    s_add_u32 m0, s32, 49152
    s_nop 0
    buffer_load_dwordx4 v9, s[16:19], s31 offen lds
    s_add_u32 m0, s32, 33792
    s_nop 0
    buffer_load_dwordx4 v8, s[12:15], s30 offen lds
    s_add_u32 m0, s32, 50176
    s_nop 0
    buffer_load_dwordx4 v9, s[16:19], s28 offen lds
    s_add_u32 m0, s32, 34816
    s_nop 0
    buffer_load_dwordx4 v7, s[12:15], s27 offen lds
    s_add_u32 m0, s32, 51200
    s_nop 0
    buffer_load_dwordx4 v10, s[16:19], s31 offen lds
    s_add_u32 m0, s32, 35840
    s_nop 0
    buffer_load_dwordx4 v8, s[12:15], s27 offen lds
    s_add_u32 m0, s32, 52224
    s_nop 0
    buffer_load_dwordx4 v10, s[16:19], s28 offen lds
    s_add_u32 s29, s29, 1
    s_cmp_ge_u32 s29, 10
    s_cselect_b32 s29, 0, s29
    s_waitcnt vmcnt(8)
    s_barrier
    s_lshl_b32 s30, s29, 7
    s_add_u32 s30, s30, s37
    s_mul_i32 s31, s29, 245760
    s_add_u32 s31, s31, s38
    s_add_u32 s27, s30, 20480
    s_add_u32 s28, s31, 15360
    s_add_u32 m0, s32, 65536
    s_nop 0
    buffer_load_dwordx4 v7, s[12:15], s30 offen lds
    s_add_u32 m0, s32, 81920
    s_nop 0
    buffer_load_dwordx4 v9, s[16:19], s31 offen lds
    s_add_u32 m0, s32, 66560
    s_nop 0
    buffer_load_dwordx4 v8, s[12:15], s30 offen lds
    s_add_u32 m0, s32, 82944
    s_nop 0
    buffer_load_dwordx4 v9, s[16:19], s28 offen lds
    s_add_u32 m0, s32, 67584
    s_nop 0
    buffer_load_dwordx4 v7, s[12:15], s27 offen lds
    s_add_u32 m0, s32, 83968
    s_nop 0
    buffer_load_dwordx4 v10, s[16:19], s31 offen lds
    s_add_u32 m0, s32, 68608
    s_nop 0
    buffer_load_dwordx4 v8, s[12:15], s27 offen lds
    s_add_u32 m0, s32, 84992
    s_nop 0
    buffer_load_dwordx4 v10, s[16:19], s28 offen lds
    s_add_u32 s29, s29, 1
    s_cmp_ge_u32 s29, 10
    s_cselect_b32 s29, 0, s29
    s_waitcnt vmcnt(8)
    s_barrier
    s_lshl_b32 s30, s29, 7
    s_add_u32 s30, s30, s37
    s_mul_i32 s31, s29, 245760
    s_add_u32 s31, s31, s38
    s_add_u32 s27, s30, 20480
    s_add_u32 s28, s31, 15360
    s_add_u32 m0, s32, 98304
    s_nop 0
    buffer_load_dwordx4 v7, s[12:15], s30 offen lds
    s_add_u32 m0, s32, 114688
    s_nop 0
    buffer_load_dwordx4 v9, s[16:19], s31 offen lds
    s_add_u32 m0, s32, 99328
    s_nop 0
    buffer_load_dwordx4 v8, s[12:15], s30 offen lds
    s_add_u32 m0, s32, 115712
    s_nop 0
    buffer_load_dwordx4 v9, s[16:19], s28 offen lds
    s_add_u32 m0, s32, 100352
    s_nop 0
    buffer_load_dwordx4 v7, s[12:15], s27 offen lds
    s_add_u32 m0, s32, 116736
    s_nop 0
    buffer_load_dwordx4 v10, s[16:19], s31 offen lds
    s_add_u32 m0, s32, 101376
    s_nop 0
    buffer_load_dwordx4 v8, s[12:15], s27 offen lds
    s_add_u32 m0, s32, 117760
    s_nop 0
    buffer_load_dwordx4 v10, s[16:19], s28 offen lds
    s_add_u32 s29, s29, 1
    s_cmp_ge_u32 s29, 10
    s_cselect_b32 s29, 0, s29
    s_waitcnt vmcnt(8)
    s_barrier
    s_lshl_b32 s30, s29, 7
    s_add_u32 s30, s30, s37
    s_mul_i32 s31, s29, 245760
    s_add_u32 s31, s31, s38
    s_add_u32 s27, s30, 20480
    s_add_u32 s28, s31, 15360
    s_add_u32 m0, s32, 131072
    s_nop 0
    buffer_load_dwordx4 v7, s[12:15], s30 offen lds
    s_add_u32 m0, s32, 147456
    s_nop 0
    buffer_load_dwordx4 v9, s[16:19], s31 offen lds
    s_add_u32 m0, s32, 132096
    s_nop 0
    buffer_load_dwordx4 v8, s[12:15], s30 offen lds
    s_add_u32 m0, s32, 148480
    s_nop 0
    buffer_load_dwordx4 v9, s[16:19], s28 offen lds
    s_add_u32 m0, s32, 133120
    s_nop 0
    buffer_load_dwordx4 v7, s[12:15], s27 offen lds
    s_add_u32 m0, s32, 149504
    s_nop 0
    buffer_load_dwordx4 v10, s[16:19], s31 offen lds
    s_add_u32 m0, s32, 134144
    s_nop 0
    buffer_load_dwordx4 v8, s[12:15], s27 offen lds
    s_add_u32 m0, s32, 150528
    s_nop 0
    buffer_load_dwordx4 v10, s[16:19], s28 offen lds
    s_add_u32 s29, s29, 1
    s_cmp_ge_u32 s29, 10
    s_cselect_b32 s29, 0, s29
    s_waitcnt vmcnt(8)
    s_barrier
    s_waitcnt vmcnt(0)
    s_barrier
    s_barrier
    s_branch L_qkv_join
L_qkv_comp:
    s_lshr_b32 s35, s24, 1
    s_and_b32 s36, s24, 1
    s_lshl_b32 s27, s35, 6
    v_add_u32 v2, s27, v6
    v_lshlrev_b32 v31, 3, v2
    v_lshlrev_b32 v2, 7, v2
    v_lshrrev_b32 v3, 1, v6
    v_xor_b32 v3, v3, v5
    v_lshl_add_u32 v11, v3, 4, v2
    v_xor_b32 v12, 64, v11
    v_bfe_u32 v2, v1, 2, 2
    v_lshl_add_u32 v3, v5, 3, v2
    v_lshlrev_b32 v3, 8, v3
    v_and_b32 v4, 3, v1
    v_lshl_add_u32 v3, v4, 3, v3
    v_and_b32 v4, 1, v5
    v_lshl_or_b32 v2, v4, 2, v2
    s_lshl_b32 s39, s36, 2
    s_lshl_b32 s27, s35, 1
    s_or_b32 s39, s39, s27
    v_xor_b32 v2, s39, v2
    v_lshl_add_u32 v17, v2, 5, v3
    v_xor_b32 v18, 32, v17
    v_xor_b32 v19, 64, v17
    v_xor_b32 v20, 96, v17
    v_add_u32 v13, 65536, v11
    v_add_u32 v14, 65536, v12
    v_add_u32 v21, 65536, v17
    v_add_u32 v22, 65536, v18
    v_add_u32 v23, 65536, v19
    v_add_u32 v24, 65536, v20
    v_add_u32 v15, 131072, v11
    v_add_u32 v16, 131072, v12
    v_add_u32 v25, 131072, v17
    v_add_u32 v26, 131072, v18
    v_add_u32 v27, 131072, v19
    v_add_u32 v28, 131072, v20
    v_mov_b32 v40, 0x3f803f80
    v_mov_b32 v41, 0x3f803f80
    v_mov_b32 v42, 0x3f803f80
    v_mov_b32 v43, 0x3f803f80
    s_lshl_b32 s27, s39, 6
    s_add_u32 s27, s27, 65536
    v_lshl_add_u32 v36, v6, 2, s27
    s_lshl_b32 s50, s25, 10
    s_add_u32 s50, s50, 16121856
    s_lshl_b32 s27, s25, 1
    s_add_u32 s27, s27, s35
    s_mul_i32 s33, s27, 81920
    s_waitcnt lgkmcnt(0)
    s_mov_b32 s20, s8
    s_mov_b32 s21, s9
    s_mov_b32 s22, 35651584
    s_mov_b32 s23, 0x00020000
    s_mov_b32 s76, s10
    s_mov_b32 s77, s11
    s_mov_b32 s78, 256
    s_mov_b32 s79, 0x00020000
    v_mov_b32 v247, 0
    s_cmp_lg_u32 s24, 3
    s_cbranch_scc1 L_q_o1
    v_mov_b32 v240, 0
    v_mov_b32 v241, 0
    v_mov_b32 v242, 0
    v_mov_b32 v243, 0
    v_lshlrev_b32 v244, 4, v1
    s_lshl_b32 s27, s2, 10
    s_add_u32 s27, s27, 32505856
    buffer_store_dwordx4 v[240:243], v244, s[20:23], s27 offen sc1
L_q_o1:
    s_cmp_lg_u32 s24, 2
    s_cbranch_scc1 L_q_o2
    s_getpc_b64 s[74:75]
    v_lshlrev_b32 v240, 12, v6
    s_lshl_b32 s27, s28, 7
    v_add_u32 v240, s27, v240
    v_min_u32 v240, 50824, v240
    global_load_dword v241, v240, s[74:75]
L_q_cpf:
L_q_o2:
    s_cmp_ge_u32 s26, 10
    s_cbranch_scc1 L_qkv_vpath
    s_cmp_ge_u32 s26, 5
    s_cselect_b32 s27, 3104768, 0
    s_mov_b32 s34, 0x3ea52b5c
    s_cselect_b32 s34, 1.0, s34
    s_add_u32 s33, s33, s27
    s_lshl_b32 s28, s26, 13
    s_add_u32 s33, s33, s28
    s_xor_b32 s27, s39, 0
    s_lshl_b32 s28, s27, 10
    s_add_u32 s44, s28, s33
    s_lshl_b32 s27, s27, 6
    s_add_u32 s27, s27, 65536
    v_lshl_add_u32 v32, v5, 4, s27
    s_xor_b32 s27, s39, 1
    s_lshl_b32 s28, s27, 10
    s_add_u32 s45, s28, s33
    s_lshl_b32 s27, s27, 6
    s_add_u32 s27, s27, 65536
    v_lshl_add_u32 v33, v5, 4, s27
    s_xor_b32 s27, s39, 2
    s_lshl_b32 s28, s27, 10
    s_add_u32 s46, s28, s33
    s_lshl_b32 s27, s27, 6
    s_add_u32 s27, s27, 65536
    v_lshl_add_u32 v34, v5, 4, s27
    s_xor_b32 s27, s39, 3
    s_lshl_b32 s28, s27, 10
    s_add_u32 s47, s28, s33
    s_lshl_b32 s27, s27, 6
    s_add_u32 s27, s27, 65536
    v_lshl_add_u32 v35, v5, 4, s27
    v_lshlrev_b32 v29, 3, v6
    v_lshl_add_u32 v29, v5, 8, v29
    v_add_u32 v30, 40960, v29
    s_barrier
    ds_read_b64_tr_b16 v[76:77], v17 offset:16384
    ds_read_b64_tr_b16 v[78:79], v17 offset:17408
    ds_read_b128 v[44:47], v11 offset:0
    ds_read_b128 v[48:51], v11 offset:2048
    ds_read_b128 v[52:55], v11 offset:4096
    ds_read_b128 v[56:59], v11 offset:6144
    ds_read_b64_tr_b16 v[80:81], v18 offset:16384
    ds_read_b64_tr_b16 v[82:83], v18 offset:17408
    ds_read_b64_tr_b16 v[84:85], v19 offset:16384
    ds_read_b64_tr_b16 v[86:87], v19 offset:17408
    ds_read_b64_tr_b16 v[88:89], v20 offset:16384
    ds_read_b64_tr_b16 v[90:91], v20 offset:17408
    s_waitcnt lgkmcnt(10)
    v_mfma_f32_16x16x32_bf16 v[172:175], v[40:43], v[76:79], 0
    ds_read_b64_tr_b16 v[92:93], v17 offset:24576
    s_waitcnt lgkmcnt(10)
    v_mfma_f32_16x16x32_bf16 v[108:111], v[76:79], v[44:47], 0
    ds_read_b64_tr_b16 v[94:95], v17 offset:25600
    s_waitcnt lgkmcnt(10)
    v_mfma_f32_16x16x32_bf16 v[124:127], v[76:79], v[48:51], 0
    ds_read_b128 v[60:63], v12 offset:0
    s_waitcnt lgkmcnt(10)
    v_mfma_f32_16x16x32_bf16 v[140:143], v[76:79], v[52:55], 0
    ds_read_b128 v[64:67], v12 offset:2048
    s_waitcnt lgkmcnt(10)
    v_mfma_f32_16x16x32_bf16 v[156:159], v[76:79], v[56:59], 0
    ds_read_b128 v[68:71], v12 offset:4096
    s_waitcnt lgkmcnt(9)
    v_mfma_f32_16x16x32_bf16 v[176:179], v[40:43], v[80:83], 0
    ds_read_b128 v[72:75], v12 offset:6144
    v_mfma_f32_16x16x32_bf16 v[112:115], v[80:83], v[44:47], 0
    ds_read_b64_tr_b16 v[96:97], v18 offset:24576
    v_mfma_f32_16x16x32_bf16 v[128:131], v[80:83], v[48:51], 0
    ds_read_b64_tr_b16 v[98:99], v18 offset:25600
    v_mfma_f32_16x16x32_bf16 v[144:147], v[80:83], v[52:55], 0
    ds_read_b64_tr_b16 v[100:101], v19 offset:24576
    v_mfma_f32_16x16x32_bf16 v[160:163], v[80:83], v[56:59], 0
    ds_read_b64_tr_b16 v[102:103], v19 offset:25600
    s_waitcnt lgkmcnt(12)
    v_mfma_f32_16x16x32_bf16 v[116:119], v[84:87], v[44:47], 0
    ds_read_b64_tr_b16 v[104:105], v20 offset:24576
    v_mfma_f32_16x16x32_bf16 v[132:135], v[84:87], v[48:51], 0
    ds_read_b64_tr_b16 v[106:107], v20 offset:25600
    v_mfma_f32_16x16x32_bf16 v[148:151], v[84:87], v[52:55], 0
    v_mfma_f32_16x16x32_bf16 v[164:167], v[84:87], v[56:59], 0
    s_waitcnt lgkmcnt(12)
    v_mfma_f32_16x16x32_bf16 v[120:123], v[88:91], v[44:47], 0
    v_mfma_f32_16x16x32_bf16 v[136:139], v[88:91], v[48:51], 0
    v_mfma_f32_16x16x32_bf16 v[152:155], v[88:91], v[52:55], 0
    v_mfma_f32_16x16x32_bf16 v[168:171], v[88:91], v[56:59], 0
    s_barrier
    s_waitcnt lgkmcnt(10)
    v_mfma_f32_16x16x32_bf16 v[172:175], v[40:43], v[92:95], v[172:175]
    ds_read_b64_tr_b16 v[76:77], v17 offset:49152
    s_waitcnt lgkmcnt(10)
    v_mfma_f32_16x16x32_bf16 v[108:111], v[92:95], v[60:63], v[108:111]
    ds_read_b64_tr_b16 v[78:79], v17 offset:50176
    s_waitcnt lgkmcnt(10)
    v_mfma_f32_16x16x32_bf16 v[124:127], v[92:95], v[64:67], v[124:127]
    ds_read_b128 v[44:47], v11 offset:32768
    s_waitcnt lgkmcnt(10)
    v_mfma_f32_16x16x32_bf16 v[140:143], v[92:95], v[68:71], v[140:143]
    ds_read_b128 v[48:51], v11 offset:34816
    s_waitcnt lgkmcnt(10)
    v_mfma_f32_16x16x32_bf16 v[156:159], v[92:95], v[72:75], v[156:159]
    ds_read_b128 v[52:55], v11 offset:36864
    s_waitcnt lgkmcnt(9)
    v_mfma_f32_16x16x32_bf16 v[176:179], v[40:43], v[96:99], v[176:179]
    ds_read_b128 v[56:59], v11 offset:38912
    v_mfma_f32_16x16x32_bf16 v[112:115], v[96:99], v[60:63], v[112:115]
    ds_read_b64_tr_b16 v[80:81], v18 offset:49152
    v_mfma_f32_16x16x32_bf16 v[128:131], v[96:99], v[64:67], v[128:131]
    ds_read_b64_tr_b16 v[82:83], v18 offset:50176
    v_mfma_f32_16x16x32_bf16 v[144:147], v[96:99], v[68:71], v[144:147]
    ds_read_b64_tr_b16 v[84:85], v19 offset:49152
    v_mfma_f32_16x16x32_bf16 v[160:163], v[96:99], v[72:75], v[160:163]
    ds_read_b64_tr_b16 v[86:87], v19 offset:50176
    s_waitcnt lgkmcnt(12)
    v_mfma_f32_16x16x32_bf16 v[116:119], v[100:103], v[60:63], v[116:119]
    ds_read_b64_tr_b16 v[88:89], v20 offset:49152
    v_mfma_f32_16x16x32_bf16 v[132:135], v[100:103], v[64:67], v[132:135]
    ds_read_b64_tr_b16 v[90:91], v20 offset:50176
    v_mfma_f32_16x16x32_bf16 v[148:151], v[100:103], v[68:71], v[148:151]
    v_mfma_f32_16x16x32_bf16 v[164:167], v[100:103], v[72:75], v[164:167]
    s_waitcnt lgkmcnt(12)
    v_mfma_f32_16x16x32_bf16 v[120:123], v[104:107], v[60:63], v[120:123]
    v_mfma_f32_16x16x32_bf16 v[136:139], v[104:107], v[64:67], v[136:139]
    v_mfma_f32_16x16x32_bf16 v[152:155], v[104:107], v[68:71], v[152:155]
    v_mfma_f32_16x16x32_bf16 v[168:171], v[104:107], v[72:75], v[168:171]
    s_waitcnt lgkmcnt(10)
    v_mfma_f32_16x16x32_bf16 v[172:175], v[40:43], v[76:79], v[172:175]
    ds_read_b64_tr_b16 v[92:93], v17 offset:57344
    s_waitcnt lgkmcnt(10)
    v_mfma_f32_16x16x32_bf16 v[108:111], v[76:79], v[44:47], v[108:111]
    ds_read_b64_tr_b16 v[94:95], v17 offset:58368
    s_waitcnt lgkmcnt(10)
    v_mfma_f32_16x16x32_bf16 v[124:127], v[76:79], v[48:51], v[124:127]
    ds_read_b128 v[60:63], v12 offset:32768
    s_waitcnt lgkmcnt(10)
    v_mfma_f32_16x16x32_bf16 v[140:143], v[76:79], v[52:55], v[140:143]
    ds_read_b128 v[64:67], v12 offset:34816
    s_waitcnt lgkmcnt(10)
    v_mfma_f32_16x16x32_bf16 v[156:159], v[76:79], v[56:59], v[156:159]
    ds_read_b128 v[68:71], v12 offset:36864
    s_waitcnt lgkmcnt(9)
    v_mfma_f32_16x16x32_bf16 v[176:179], v[40:43], v[80:83], v[176:179]
    ds_read_b128 v[72:75], v12 offset:38912
    v_mfma_f32_16x16x32_bf16 v[112:115], v[80:83], v[44:47], v[112:115]
    ds_read_b64_tr_b16 v[96:97], v18 offset:57344
    v_mfma_f32_16x16x32_bf16 v[128:131], v[80:83], v[48:51], v[128:131]
    ds_read_b64_tr_b16 v[98:99], v18 offset:58368
    v_mfma_f32_16x16x32_bf16 v[144:147], v[80:83], v[52:55], v[144:147]
    ds_read_b64_tr_b16 v[100:101], v19 offset:57344
    v_mfma_f32_16x16x32_bf16 v[160:163], v[80:83], v[56:59], v[160:163]
    ds_read_b64_tr_b16 v[102:103], v19 offset:58368
    s_waitcnt lgkmcnt(12)
    v_mfma_f32_16x16x32_bf16 v[116:119], v[84:87], v[44:47], v[116:119]
    ds_read_b64_tr_b16 v[104:105], v20 offset:57344
    v_mfma_f32_16x16x32_bf16 v[132:135], v[84:87], v[48:51], v[132:135]
    ds_read_b64_tr_b16 v[106:107], v20 offset:58368
    v_mfma_f32_16x16x32_bf16 v[148:151], v[84:87], v[52:55], v[148:151]
    v_mfma_f32_16x16x32_bf16 v[164:167], v[84:87], v[56:59], v[164:167]
    s_waitcnt lgkmcnt(12)
    v_mfma_f32_16x16x32_bf16 v[120:123], v[88:91], v[44:47], v[120:123]
    v_mfma_f32_16x16x32_bf16 v[136:139], v[88:91], v[48:51], v[136:139]
    v_mfma_f32_16x16x32_bf16 v[152:155], v[88:91], v[52:55], v[152:155]
    v_mfma_f32_16x16x32_bf16 v[168:171], v[88:91], v[56:59], v[168:171]
    s_barrier
    s_waitcnt lgkmcnt(10)
    v_mfma_f32_16x16x32_bf16 v[172:175], v[40:43], v[92:95], v[172:175]
    ds_read_b64_tr_b16 v[76:77], v21 offset:16384
    s_waitcnt lgkmcnt(10)
    v_mfma_f32_16x16x32_bf16 v[108:111], v[92:95], v[60:63], v[108:111]
    ds_read_b64_tr_b16 v[78:79], v21 offset:17408
    s_waitcnt lgkmcnt(10)
    v_mfma_f32_16x16x32_bf16 v[124:127], v[92:95], v[64:67], v[124:127]
    ds_read_b128 v[44:47], v13 offset:0
    s_waitcnt lgkmcnt(10)
    v_mfma_f32_16x16x32_bf16 v[140:143], v[92:95], v[68:71], v[140:143]
    ds_read_b128 v[48:51], v13 offset:2048
    s_waitcnt lgkmcnt(10)
    v_mfma_f32_16x16x32_bf16 v[156:159], v[92:95], v[72:75], v[156:159]
    ds_read_b128 v[52:55], v13 offset:4096
    s_waitcnt lgkmcnt(9)
    v_mfma_f32_16x16x32_bf16 v[176:179], v[40:43], v[96:99], v[176:179]
    ds_read_b128 v[56:59], v13 offset:6144
    v_mfma_f32_16x16x32_bf16 v[112:115], v[96:99], v[60:63], v[112:115]
    ds_read_b64_tr_b16 v[80:81], v22 offset:16384
    v_mfma_f32_16x16x32_bf16 v[128:131], v[96:99], v[64:67], v[128:131]
    ds_read_b64_tr_b16 v[82:83], v22 offset:17408
    v_mfma_f32_16x16x32_bf16 v[144:147], v[96:99], v[68:71], v[144:147]
    ds_read_b64_tr_b16 v[84:85], v23 offset:16384
    v_mfma_f32_16x16x32_bf16 v[160:163], v[96:99], v[72:75], v[160:163]
    ds_read_b64_tr_b16 v[86:87], v23 offset:17408
    s_waitcnt lgkmcnt(12)
    v_mfma_f32_16x16x32_bf16 v[116:119], v[100:103], v[60:63], v[116:119]
    ds_read_b64_tr_b16 v[88:89], v24 offset:16384
    v_mfma_f32_16x16x32_bf16 v[132:135], v[100:103], v[64:67], v[132:135]
    ds_read_b64_tr_b16 v[90:91], v24 offset:17408
    v_mfma_f32_16x16x32_bf16 v[148:151], v[100:103], v[68:71], v[148:151]
    v_mfma_f32_16x16x32_bf16 v[164:167], v[100:103], v[72:75], v[164:167]
    s_waitcnt lgkmcnt(12)
    v_mfma_f32_16x16x32_bf16 v[120:123], v[104:107], v[60:63], v[120:123]
    v_mfma_f32_16x16x32_bf16 v[136:139], v[104:107], v[64:67], v[136:139]
    v_mfma_f32_16x16x32_bf16 v[152:155], v[104:107], v[68:71], v[152:155]
    v_mfma_f32_16x16x32_bf16 v[168:171], v[104:107], v[72:75], v[168:171]
    s_waitcnt lgkmcnt(10)
    v_mfma_f32_16x16x32_bf16 v[172:175], v[40:43], v[76:79], v[172:175]
    ds_read_b64_tr_b16 v[92:93], v21 offset:24576
    s_waitcnt lgkmcnt(10)
    v_mfma_f32_16x16x32_bf16 v[108:111], v[76:79], v[44:47], v[108:111]
    ds_read_b64_tr_b16 v[94:95], v21 offset:25600
    s_waitcnt lgkmcnt(10)
    v_mfma_f32_16x16x32_bf16 v[124:127], v[76:79], v[48:51], v[124:127]
    ds_read_b128 v[60:63], v14 offset:0
    s_waitcnt lgkmcnt(10)
    v_mfma_f32_16x16x32_bf16 v[140:143], v[76:79], v[52:55], v[140:143]
    ds_read_b128 v[64:67], v14 offset:2048
    s_waitcnt lgkmcnt(10)
    v_mfma_f32_16x16x32_bf16 v[156:159], v[76:79], v[56:59], v[156:159]
    ds_read_b128 v[68:71], v14 offset:4096
    s_waitcnt lgkmcnt(9)
    v_mfma_f32_16x16x32_bf16 v[176:179], v[40:43], v[80:83], v[176:179]
    ds_read_b128 v[72:75], v14 offset:6144
    v_mfma_f32_16x16x32_bf16 v[112:115], v[80:83], v[44:47], v[112:115]
    ds_read_b64_tr_b16 v[96:97], v22 offset:24576
    v_mfma_f32_16x16x32_bf16 v[128:131], v[80:83], v[48:51], v[128:131]
    ds_read_b64_tr_b16 v[98:99], v22 offset:25600
    v_mfma_f32_16x16x32_bf16 v[144:147], v[80:83], v[52:55], v[144:147]
    ds_read_b64_tr_b16 v[100:101], v23 offset:24576
    v_mfma_f32_16x16x32_bf16 v[160:163], v[80:83], v[56:59], v[160:163]
    ds_read_b64_tr_b16 v[102:103], v23 offset:25600
    s_waitcnt lgkmcnt(12)
    v_mfma_f32_16x16x32_bf16 v[116:119], v[84:87], v[44:47], v[116:119]
    ds_read_b64_tr_b16 v[104:105], v24 offset:24576
    v_mfma_f32_16x16x32_bf16 v[132:135], v[84:87], v[48:51], v[132:135]
    ds_read_b64_tr_b16 v[106:107], v24 offset:25600
    v_mfma_f32_16x16x32_bf16 v[148:151], v[84:87], v[52:55], v[148:151]
    v_mfma_f32_16x16x32_bf16 v[164:167], v[84:87], v[56:59], v[164:167]
    s_waitcnt lgkmcnt(12)
    v_mfma_f32_16x16x32_bf16 v[120:123], v[88:91], v[44:47], v[120:123]
    v_mfma_f32_16x16x32_bf16 v[136:139], v[88:91], v[48:51], v[136:139]
    v_mfma_f32_16x16x32_bf16 v[152:155], v[88:91], v[52:55], v[152:155]
    v_mfma_f32_16x16x32_bf16 v[168:171], v[88:91], v[56:59], v[168:171]
    s_barrier
    s_waitcnt lgkmcnt(10)
    v_mfma_f32_16x16x32_bf16 v[172:175], v[40:43], v[92:95], v[172:175]
    ds_read_b64_tr_b16 v[76:77], v21 offset:49152
    s_waitcnt lgkmcnt(10)
    v_mfma_f32_16x16x32_bf16 v[108:111], v[92:95], v[60:63], v[108:111]
    ds_read_b64_tr_b16 v[78:79], v21 offset:50176
    s_waitcnt lgkmcnt(10)
    v_mfma_f32_16x16x32_bf16 v[124:127], v[92:95], v[64:67], v[124:127]
    ds_read_b128 v[44:47], v13 offset:32768
    s_waitcnt lgkmcnt(10)
    v_mfma_f32_16x16x32_bf16 v[140:143], v[92:95], v[68:71], v[140:143]
    ds_read_b128 v[48:51], v13 offset:34816
    s_waitcnt lgkmcnt(10)
    v_mfma_f32_16x16x32_bf16 v[156:159], v[92:95], v[72:75], v[156:159]
    ds_read_b128 v[52:55], v13 offset:36864
    s_waitcnt lgkmcnt(9)
    v_mfma_f32_16x16x32_bf16 v[176:179], v[40:43], v[96:99], v[176:179]
    ds_read_b128 v[56:59], v13 offset:38912
    v_mfma_f32_16x16x32_bf16 v[112:115], v[96:99], v[60:63], v[112:115]
    ds_read_b64_tr_b16 v[80:81], v22 offset:49152
    v_mfma_f32_16x16x32_bf16 v[128:131], v[96:99], v[64:67], v[128:131]
    ds_read_b64_tr_b16 v[82:83], v22 offset:50176
    v_mfma_f32_16x16x32_bf16 v[144:147], v[96:99], v[68:71], v[144:147]
    ds_read_b64_tr_b16 v[84:85], v23 offset:49152
    v_mfma_f32_16x16x32_bf16 v[160:163], v[96:99], v[72:75], v[160:163]
    ds_read_b64_tr_b16 v[86:87], v23 offset:50176
    s_waitcnt lgkmcnt(12)
    v_mfma_f32_16x16x32_bf16 v[116:119], v[100:103], v[60:63], v[116:119]
    ds_read_b64_tr_b16 v[88:89], v24 offset:49152
    v_mfma_f32_16x16x32_bf16 v[132:135], v[100:103], v[64:67], v[132:135]
    ds_read_b64_tr_b16 v[90:91], v24 offset:50176
    v_mfma_f32_16x16x32_bf16 v[148:151], v[100:103], v[68:71], v[148:151]
    v_mfma_f32_16x16x32_bf16 v[164:167], v[100:103], v[72:75], v[164:167]
    s_waitcnt lgkmcnt(12)
    v_mfma_f32_16x16x32_bf16 v[120:123], v[104:107], v[60:63], v[120:123]
    v_mfma_f32_16x16x32_bf16 v[136:139], v[104:107], v[64:67], v[136:139]
    v_mfma_f32_16x16x32_bf16 v[152:155], v[104:107], v[68:71], v[152:155]
    v_mfma_f32_16x16x32_bf16 v[168:171], v[104:107], v[72:75], v[168:171]
    s_waitcnt lgkmcnt(10)
    v_mfma_f32_16x16x32_bf16 v[172:175], v[40:43], v[76:79], v[172:175]
    ds_read_b64_tr_b16 v[92:93], v21 offset:57344
    s_waitcnt lgkmcnt(10)
    v_mfma_f32_16x16x32_bf16 v[108:111], v[76:79], v[44:47], v[108:111]
    ds_read_b64_tr_b16 v[94:95], v21 offset:58368
    s_waitcnt lgkmcnt(10)
    v_mfma_f32_16x16x32_bf16 v[124:127], v[76:79], v[48:51], v[124:127]
    ds_read_b128 v[60:63], v14 offset:32768
    s_waitcnt lgkmcnt(10)
    v_mfma_f32_16x16x32_bf16 v[140:143], v[76:79], v[52:55], v[140:143]
    ds_read_b128 v[64:67], v14 offset:34816
    s_waitcnt lgkmcnt(10)
    v_mfma_f32_16x16x32_bf16 v[156:159], v[76:79], v[56:59], v[156:159]
    ds_read_b128 v[68:71], v14 offset:36864
    s_waitcnt lgkmcnt(9)
    v_mfma_f32_16x16x32_bf16 v[176:179], v[40:43], v[80:83], v[176:179]
    ds_read_b128 v[72:75], v14 offset:38912
    v_mfma_f32_16x16x32_bf16 v[112:115], v[80:83], v[44:47], v[112:115]
    ds_read_b64_tr_b16 v[96:97], v22 offset:57344
    v_mfma_f32_16x16x32_bf16 v[128:131], v[80:83], v[48:51], v[128:131]
    ds_read_b64_tr_b16 v[98:99], v22 offset:58368
    v_mfma_f32_16x16x32_bf16 v[144:147], v[80:83], v[52:55], v[144:147]
    ds_read_b64_tr_b16 v[100:101], v23 offset:57344
    v_mfma_f32_16x16x32_bf16 v[160:163], v[80:83], v[56:59], v[160:163]
    ds_read_b64_tr_b16 v[102:103], v23 offset:58368
    s_waitcnt lgkmcnt(12)
    v_mfma_f32_16x16x32_bf16 v[116:119], v[84:87], v[44:47], v[116:119]
    ds_read_b64_tr_b16 v[104:105], v24 offset:57344
    v_mfma_f32_16x16x32_bf16 v[132:135], v[84:87], v[48:51], v[132:135]
    ds_read_b64_tr_b16 v[106:107], v24 offset:58368
    v_mfma_f32_16x16x32_bf16 v[148:151], v[84:87], v[52:55], v[148:151]
    v_mfma_f32_16x16x32_bf16 v[164:167], v[84:87], v[56:59], v[164:167]
    s_waitcnt lgkmcnt(12)
    v_mfma_f32_16x16x32_bf16 v[120:123], v[88:91], v[44:47], v[120:123]
    v_mfma_f32_16x16x32_bf16 v[136:139], v[88:91], v[48:51], v[136:139]
    v_mfma_f32_16x16x32_bf16 v[152:155], v[88:91], v[52:55], v[152:155]
    v_mfma_f32_16x16x32_bf16 v[168:171], v[88:91], v[56:59], v[168:171]
    s_barrier
    s_waitcnt lgkmcnt(10)
    v_mfma_f32_16x16x32_bf16 v[172:175], v[40:43], v[92:95], v[172:175]
    ds_read_b64_tr_b16 v[76:77], v25 offset:16384
    s_waitcnt lgkmcnt(10)
    v_mfma_f32_16x16x32_bf16 v[108:111], v[92:95], v[60:63], v[108:111]
    ds_read_b64_tr_b16 v[78:79], v25 offset:17408
    s_waitcnt lgkmcnt(10)
    v_mfma_f32_16x16x32_bf16 v[124:127], v[92:95], v[64:67], v[124:127]
    ds_read_b128 v[44:47], v15 offset:0
    s_waitcnt lgkmcnt(10)
    v_mfma_f32_16x16x32_bf16 v[140:143], v[92:95], v[68:71], v[140:143]
    ds_read_b128 v[48:51], v15 offset:2048
    s_waitcnt lgkmcnt(10)
    v_mfma_f32_16x16x32_bf16 v[156:159], v[92:95], v[72:75], v[156:159]
    ds_read_b128 v[52:55], v15 offset:4096
    s_waitcnt lgkmcnt(9)
    v_mfma_f32_16x16x32_bf16 v[176:179], v[40:43], v[96:99], v[176:179]
    ds_read_b128 v[56:59], v15 offset:6144
    v_mfma_f32_16x16x32_bf16 v[112:115], v[96:99], v[60:63], v[112:115]
    ds_read_b64_tr_b16 v[80:81], v26 offset:16384
    v_mfma_f32_16x16x32_bf16 v[128:131], v[96:99], v[64:67], v[128:131]
    ds_read_b64_tr_b16 v[82:83], v26 offset:17408
    v_mfma_f32_16x16x32_bf16 v[144:147], v[96:99], v[68:71], v[144:147]
    ds_read_b64_tr_b16 v[84:85], v27 offset:16384
    v_mfma_f32_16x16x32_bf16 v[160:163], v[96:99], v[72:75], v[160:163]
    ds_read_b64_tr_b16 v[86:87], v27 offset:17408
    s_waitcnt lgkmcnt(12)
    v_mfma_f32_16x16x32_bf16 v[116:119], v[100:103], v[60:63], v[116:119]
    ds_read_b64_tr_b16 v[88:89], v28 offset:16384
    v_mfma_f32_16x16x32_bf16 v[132:135], v[100:103], v[64:67], v[132:135]
    ds_read_b64_tr_b16 v[90:91], v28 offset:17408
    v_mfma_f32_16x16x32_bf16 v[148:151], v[100:103], v[68:71], v[148:151]
    v_mfma_f32_16x16x32_bf16 v[164:167], v[100:103], v[72:75], v[164:167]
    s_waitcnt lgkmcnt(12)
    v_mfma_f32_16x16x32_bf16 v[120:123], v[104:107], v[60:63], v[120:123]
    v_mfma_f32_16x16x32_bf16 v[136:139], v[104:107], v[64:67], v[136:139]
    v_mfma_f32_16x16x32_bf16 v[152:155], v[104:107], v[68:71], v[152:155]
    v_mfma_f32_16x16x32_bf16 v[168:171], v[104:107], v[72:75], v[168:171]
    s_waitcnt lgkmcnt(10)
    v_mfma_f32_16x16x32_bf16 v[172:175], v[40:43], v[76:79], v[172:175]
    ds_read_b64_tr_b16 v[92:93], v25 offset:24576
    s_waitcnt lgkmcnt(10)
    v_mfma_f32_16x16x32_bf16 v[108:111], v[76:79], v[44:47], v[108:111]
    ds_read_b64_tr_b16 v[94:95], v25 offset:25600
    s_waitcnt lgkmcnt(10)
    v_mfma_f32_16x16x32_bf16 v[124:127], v[76:79], v[48:51], v[124:127]
    ds_read_b128 v[60:63], v16 offset:0
    s_waitcnt lgkmcnt(10)
    v_mfma_f32_16x16x32_bf16 v[140:143], v[76:79], v[52:55], v[140:143]
    ds_read_b128 v[64:67], v16 offset:2048
    s_waitcnt lgkmcnt(10)
    v_mfma_f32_16x16x32_bf16 v[156:159], v[76:79], v[56:59], v[156:159]
    ds_read_b128 v[68:71], v16 offset:4096
    s_waitcnt lgkmcnt(9)
    v_mfma_f32_16x16x32_bf16 v[176:179], v[40:43], v[80:83], v[176:179]
    ds_read_b128 v[72:75], v16 offset:6144
    v_mfma_f32_16x16x32_bf16 v[112:115], v[80:83], v[44:47], v[112:115]
    ds_read_b64_tr_b16 v[96:97], v26 offset:24576
    v_mfma_f32_16x16x32_bf16 v[128:131], v[80:83], v[48:51], v[128:131]
    ds_read_b64_tr_b16 v[98:99], v26 offset:25600
    v_mfma_f32_16x16x32_bf16 v[144:147], v[80:83], v[52:55], v[144:147]
    ds_read_b64_tr_b16 v[100:101], v27 offset:24576
    v_mfma_f32_16x16x32_bf16 v[160:163], v[80:83], v[56:59], v[160:163]
    ds_read_b64_tr_b16 v[102:103], v27 offset:25600
    s_waitcnt lgkmcnt(12)
    v_mfma_f32_16x16x32_bf16 v[116:119], v[84:87], v[44:47], v[116:119]
    ds_read_b64_tr_b16 v[104:105], v28 offset:24576
    v_mfma_f32_16x16x32_bf16 v[132:135], v[84:87], v[48:51], v[132:135]
    ds_read_b64_tr_b16 v[106:107], v28 offset:25600
    v_mfma_f32_16x16x32_bf16 v[148:151], v[84:87], v[52:55], v[148:151]
    v_mfma_f32_16x16x32_bf16 v[164:167], v[84:87], v[56:59], v[164:167]
    s_waitcnt lgkmcnt(12)
    v_mfma_f32_16x16x32_bf16 v[120:123], v[88:91], v[44:47], v[120:123]
    v_mfma_f32_16x16x32_bf16 v[136:139], v[88:91], v[48:51], v[136:139]
    v_mfma_f32_16x16x32_bf16 v[152:155], v[88:91], v[52:55], v[152:155]
    v_mfma_f32_16x16x32_bf16 v[168:171], v[88:91], v[56:59], v[168:171]
    s_cmp_lg_u32 s24, 3
    s_cbranch_scc1 L_q_o3
    s_waitcnt vmcnt(0)
    s_and_b32 s27, s2, 31
    s_lshl_b32 s27, s27, 2
    s_add_u32 s27, s27, 128
    v_mov_b32 v245, 1
    s_mov_b64 exec, 1
    buffer_atomic_add v245, v246, s[76:79], s27 offen sc1
    s_mov_b64 exec, -1
L_q_o3:
    s_barrier
    s_waitcnt lgkmcnt(10)
    v_mfma_f32_16x16x32_bf16 v[172:175], v[40:43], v[92:95], v[172:175]
    ds_read_b64_tr_b16 v[76:77], v17 offset:16384
    s_waitcnt lgkmcnt(10)
    v_mfma_f32_16x16x32_bf16 v[108:111], v[92:95], v[60:63], v[108:111]
    ds_read_b64_tr_b16 v[78:79], v17 offset:17408
    s_waitcnt lgkmcnt(10)
    v_mfma_f32_16x16x32_bf16 v[124:127], v[92:95], v[64:67], v[124:127]
    ds_read_b128 v[44:47], v11 offset:0
    s_waitcnt lgkmcnt(10)
    v_mfma_f32_16x16x32_bf16 v[140:143], v[92:95], v[68:71], v[140:143]
    ds_read_b128 v[48:51], v11 offset:2048
    s_waitcnt lgkmcnt(10)
    v_mfma_f32_16x16x32_bf16 v[156:159], v[92:95], v[72:75], v[156:159]
    ds_read_b128 v[52:55], v11 offset:4096
    s_waitcnt lgkmcnt(9)
    v_mfma_f32_16x16x32_bf16 v[176:179], v[40:43], v[96:99], v[176:179]
    ds_read_b128 v[56:59], v11 offset:6144
    v_mfma_f32_16x16x32_bf16 v[112:115], v[96:99], v[60:63], v[112:115]
    ds_read_b64_tr_b16 v[80:81], v18 offset:16384
    v_mfma_f32_16x16x32_bf16 v[128:131], v[96:99], v[64:67], v[128:131]
    ds_read_b64_tr_b16 v[82:83], v18 offset:17408
    v_mfma_f32_16x16x32_bf16 v[144:147], v[96:99], v[68:71], v[144:147]
    ds_read_b64_tr_b16 v[84:85], v19 offset:16384
    v_mfma_f32_16x16x32_bf16 v[160:163], v[96:99], v[72:75], v[160:163]
    ds_read_b64_tr_b16 v[86:87], v19 offset:17408
    s_waitcnt lgkmcnt(12)
    v_mfma_f32_16x16x32_bf16 v[116:119], v[100:103], v[60:63], v[116:119]
    ds_read_b64_tr_b16 v[88:89], v20 offset:16384
    v_mfma_f32_16x16x32_bf16 v[132:135], v[100:103], v[64:67], v[132:135]
    ds_read_b64_tr_b16 v[90:91], v20 offset:17408
    v_mfma_f32_16x16x32_bf16 v[148:151], v[100:103], v[68:71], v[148:151]
    v_mfma_f32_16x16x32_bf16 v[164:167], v[100:103], v[72:75], v[164:167]
    s_waitcnt lgkmcnt(12)
    v_mfma_f32_16x16x32_bf16 v[120:123], v[104:107], v[60:63], v[120:123]
    v_mfma_f32_16x16x32_bf16 v[136:139], v[104:107], v[64:67], v[136:139]
    v_mfma_f32_16x16x32_bf16 v[152:155], v[104:107], v[68:71], v[152:155]
    v_mfma_f32_16x16x32_bf16 v[168:171], v[104:107], v[72:75], v[168:171]
    s_waitcnt lgkmcnt(10)
    v_mfma_f32_16x16x32_bf16 v[172:175], v[40:43], v[76:79], v[172:175]
    ds_read_b64_tr_b16 v[92:93], v17 offset:24576
    s_waitcnt lgkmcnt(10)
    v_mfma_f32_16x16x32_bf16 v[108:111], v[76:79], v[44:47], v[108:111]
    ds_read_b64_tr_b16 v[94:95], v17 offset:25600
    s_waitcnt lgkmcnt(10)
    v_mfma_f32_16x16x32_bf16 v[124:127], v[76:79], v[48:51], v[124:127]
    ds_read_b128 v[60:63], v12 offset:0
    s_waitcnt lgkmcnt(10)
    v_mfma_f32_16x16x32_bf16 v[140:143], v[76:79], v[52:55], v[140:143]
    ds_read_b128 v[64:67], v12 offset:2048
    s_waitcnt lgkmcnt(10)
    v_mfma_f32_16x16x32_bf16 v[156:159], v[76:79], v[56:59], v[156:159]
    ds_read_b128 v[68:71], v12 offset:4096
    s_waitcnt lgkmcnt(9)
    v_mfma_f32_16x16x32_bf16 v[176:179], v[40:43], v[80:83], v[176:179]
    ds_read_b128 v[72:75], v12 offset:6144
    v_mfma_f32_16x16x32_bf16 v[112:115], v[80:83], v[44:47], v[112:115]
    ds_read_b64_tr_b16 v[96:97], v18 offset:24576
    v_mfma_f32_16x16x32_bf16 v[128:131], v[80:83], v[48:51], v[128:131]
    ds_read_b64_tr_b16 v[98:99], v18 offset:25600
    v_mfma_f32_16x16x32_bf16 v[144:147], v[80:83], v[52:55], v[144:147]
    ds_read_b64_tr_b16 v[100:101], v19 offset:24576
    v_mfma_f32_16x16x32_bf16 v[160:163], v[80:83], v[56:59], v[160:163]
    ds_read_b64_tr_b16 v[102:103], v19 offset:25600
    s_waitcnt lgkmcnt(12)
    v_mfma_f32_16x16x32_bf16 v[116:119], v[84:87], v[44:47], v[116:119]
    ds_read_b64_tr_b16 v[104:105], v20 offset:24576
    v_mfma_f32_16x16x32_bf16 v[132:135], v[84:87], v[48:51], v[132:135]
    ds_read_b64_tr_b16 v[106:107], v20 offset:25600
    v_mfma_f32_16x16x32_bf16 v[148:151], v[84:87], v[52:55], v[148:151]
    v_mfma_f32_16x16x32_bf16 v[164:167], v[84:87], v[56:59], v[164:167]
    s_waitcnt lgkmcnt(12)
    v_mfma_f32_16x16x32_bf16 v[120:123], v[88:91], v[44:47], v[120:123]
    v_mfma_f32_16x16x32_bf16 v[136:139], v[88:91], v[48:51], v[136:139]
    v_mfma_f32_16x16x32_bf16 v[152:155], v[88:91], v[52:55], v[152:155]
    v_mfma_f32_16x16x32_bf16 v[168:171], v[88:91], v[56:59], v[168:171]
    s_barrier
    s_waitcnt lgkmcnt(10)
    v_mfma_f32_16x16x32_bf16 v[172:175], v[40:43], v[92:95], v[172:175]
    ds_read_b64_tr_b16 v[76:77], v17 offset:49152
    s_waitcnt lgkmcnt(10)
    v_mfma_f32_16x16x32_bf16 v[108:111], v[92:95], v[60:63], v[108:111]
    ds_read_b64_tr_b16 v[78:79], v17 offset:50176
    s_waitcnt lgkmcnt(10)
    v_mfma_f32_16x16x32_bf16 v[124:127], v[92:95], v[64:67], v[124:127]
    ds_read_b128 v[44:47], v11 offset:32768
    s_waitcnt lgkmcnt(10)
    v_mfma_f32_16x16x32_bf16 v[140:143], v[92:95], v[68:71], v[140:143]
    ds_read_b128 v[48:51], v11 offset:34816
    s_waitcnt lgkmcnt(10)
    v_mfma_f32_16x16x32_bf16 v[156:159], v[92:95], v[72:75], v[156:159]
    ds_read_b128 v[52:55], v11 offset:36864
    s_waitcnt lgkmcnt(9)
    v_mfma_f32_16x16x32_bf16 v[176:179], v[40:43], v[96:99], v[176:179]
    ds_read_b128 v[56:59], v11 offset:38912
    v_mfma_f32_16x16x32_bf16 v[112:115], v[96:99], v[60:63], v[112:115]
    ds_read_b64_tr_b16 v[80:81], v18 offset:49152
    v_mfma_f32_16x16x32_bf16 v[128:131], v[96:99], v[64:67], v[128:131]
    ds_read_b64_tr_b16 v[82:83], v18 offset:50176
    v_mfma_f32_16x16x32_bf16 v[144:147], v[96:99], v[68:71], v[144:147]
    ds_read_b64_tr_b16 v[84:85], v19 offset:49152
    v_mfma_f32_16x16x32_bf16 v[160:163], v[96:99], v[72:75], v[160:163]
    ds_read_b64_tr_b16 v[86:87], v19 offset:50176
    s_waitcnt lgkmcnt(12)
    v_mfma_f32_16x16x32_bf16 v[116:119], v[100:103], v[60:63], v[116:119]
    ds_read_b64_tr_b16 v[88:89], v20 offset:49152
    v_mfma_f32_16x16x32_bf16 v[132:135], v[100:103], v[64:67], v[132:135]
    ds_read_b64_tr_b16 v[90:91], v20 offset:50176
    v_mfma_f32_16x16x32_bf16 v[148:151], v[100:103], v[68:71], v[148:151]
    v_mfma_f32_16x16x32_bf16 v[164:167], v[100:103], v[72:75], v[164:167]
    s_waitcnt lgkmcnt(12)
    v_mfma_f32_16x16x32_bf16 v[120:123], v[104:107], v[60:63], v[120:123]
    v_mfma_f32_16x16x32_bf16 v[136:139], v[104:107], v[64:67], v[136:139]
    v_mfma_f32_16x16x32_bf16 v[152:155], v[104:107], v[68:71], v[152:155]
    v_mfma_f32_16x16x32_bf16 v[168:171], v[104:107], v[72:75], v[168:171]
    s_waitcnt lgkmcnt(10)
    v_mfma_f32_16x16x32_bf16 v[172:175], v[40:43], v[76:79], v[172:175]
    ds_read_b64_tr_b16 v[92:93], v17 offset:57344
    s_waitcnt lgkmcnt(10)
    v_mfma_f32_16x16x32_bf16 v[108:111], v[76:79], v[44:47], v[108:111]
    ds_read_b64_tr_b16 v[94:95], v17 offset:58368
    s_waitcnt lgkmcnt(10)
    v_mfma_f32_16x16x32_bf16 v[124:127], v[76:79], v[48:51], v[124:127]
    ds_read_b128 v[60:63], v12 offset:32768
    s_waitcnt lgkmcnt(10)
    v_mfma_f32_16x16x32_bf16 v[140:143], v[76:79], v[52:55], v[140:143]
    ds_read_b128 v[64:67], v12 offset:34816
    s_waitcnt lgkmcnt(10)
    v_mfma_f32_16x16x32_bf16 v[156:159], v[76:79], v[56:59], v[156:159]
    ds_read_b128 v[68:71], v12 offset:36864
    s_waitcnt lgkmcnt(9)
    v_mfma_f32_16x16x32_bf16 v[176:179], v[40:43], v[80:83], v[176:179]
    ds_read_b128 v[72:75], v12 offset:38912
    v_mfma_f32_16x16x32_bf16 v[112:115], v[80:83], v[44:47], v[112:115]
    ds_read_b64_tr_b16 v[96:97], v18 offset:57344
    v_mfma_f32_16x16x32_bf16 v[128:131], v[80:83], v[48:51], v[128:131]
    ds_read_b64_tr_b16 v[98:99], v18 offset:58368
    v_mfma_f32_16x16x32_bf16 v[144:147], v[80:83], v[52:55], v[144:147]
    ds_read_b64_tr_b16 v[100:101], v19 offset:57344
    v_mfma_f32_16x16x32_bf16 v[160:163], v[80:83], v[56:59], v[160:163]
    ds_read_b64_tr_b16 v[102:103], v19 offset:58368
    s_waitcnt lgkmcnt(12)
    v_mfma_f32_16x16x32_bf16 v[116:119], v[84:87], v[44:47], v[116:119]
    ds_read_b64_tr_b16 v[104:105], v20 offset:57344
    v_mfma_f32_16x16x32_bf16 v[132:135], v[84:87], v[48:51], v[132:135]
    ds_read_b64_tr_b16 v[106:107], v20 offset:58368
    v_mfma_f32_16x16x32_bf16 v[148:151], v[84:87], v[52:55], v[148:151]
    v_mfma_f32_16x16x32_bf16 v[164:167], v[84:87], v[56:59], v[164:167]
    s_waitcnt lgkmcnt(12)
    v_mfma_f32_16x16x32_bf16 v[120:123], v[88:91], v[44:47], v[120:123]
    v_mfma_f32_16x16x32_bf16 v[136:139], v[88:91], v[48:51], v[136:139]
    v_mfma_f32_16x16x32_bf16 v[152:155], v[88:91], v[52:55], v[152:155]
    v_mfma_f32_16x16x32_bf16 v[168:171], v[88:91], v[56:59], v[168:171]
    s_barrier
    s_waitcnt lgkmcnt(10)
    v_mfma_f32_16x16x32_bf16 v[172:175], v[40:43], v[92:95], v[172:175]
    ds_read_b64_tr_b16 v[76:77], v21 offset:16384
    s_waitcnt lgkmcnt(10)
    v_mfma_f32_16x16x32_bf16 v[108:111], v[92:95], v[60:63], v[108:111]
    ds_read_b64_tr_b16 v[78:79], v21 offset:17408
    s_waitcnt lgkmcnt(10)
    v_mfma_f32_16x16x32_bf16 v[124:127], v[92:95], v[64:67], v[124:127]
    ds_read_b128 v[44:47], v13 offset:0
    s_waitcnt lgkmcnt(10)
    v_mfma_f32_16x16x32_bf16 v[140:143], v[92:95], v[68:71], v[140:143]
    ds_read_b128 v[48:51], v13 offset:2048
    s_waitcnt lgkmcnt(10)
    v_mfma_f32_16x16x32_bf16 v[156:159], v[92:95], v[72:75], v[156:159]
    ds_read_b128 v[52:55], v13 offset:4096
    s_waitcnt lgkmcnt(9)
    v_mfma_f32_16x16x32_bf16 v[176:179], v[40:43], v[96:99], v[176:179]
    ds_read_b128 v[56:59], v13 offset:6144
    v_mfma_f32_16x16x32_bf16 v[112:115], v[96:99], v[60:63], v[112:115]
    ds_read_b64_tr_b16 v[80:81], v22 offset:16384
    v_mfma_f32_16x16x32_bf16 v[128:131], v[96:99], v[64:67], v[128:131]
    ds_read_b64_tr_b16 v[82:83], v22 offset:17408
    v_mfma_f32_16x16x32_bf16 v[144:147], v[96:99], v[68:71], v[144:147]
    ds_read_b64_tr_b16 v[84:85], v23 offset:16384
    v_mfma_f32_16x16x32_bf16 v[160:163], v[96:99], v[72:75], v[160:163]
    ds_read_b64_tr_b16 v[86:87], v23 offset:17408
    s_waitcnt lgkmcnt(12)
    v_mfma_f32_16x16x32_bf16 v[116:119], v[100:103], v[60:63], v[116:119]
    ds_read_b64_tr_b16 v[88:89], v24 offset:16384
    v_mfma_f32_16x16x32_bf16 v[132:135], v[100:103], v[64:67], v[132:135]
    ds_read_b64_tr_b16 v[90:91], v24 offset:17408
    v_mfma_f32_16x16x32_bf16 v[148:151], v[100:103], v[68:71], v[148:151]
    v_mfma_f32_16x16x32_bf16 v[164:167], v[100:103], v[72:75], v[164:167]
    s_waitcnt lgkmcnt(12)
    v_mfma_f32_16x16x32_bf16 v[120:123], v[104:107], v[60:63], v[120:123]
    v_mfma_f32_16x16x32_bf16 v[136:139], v[104:107], v[64:67], v[136:139]
    v_mfma_f32_16x16x32_bf16 v[152:155], v[104:107], v[68:71], v[152:155]
    v_mfma_f32_16x16x32_bf16 v[168:171], v[104:107], v[72:75], v[168:171]
    s_cmp_lg_u32 s24, 2
    s_cbranch_scc1 L_q_o4
    s_lshl_b32 s27, s25, 2
    buffer_load_dword v247, v246, s[76:79], s27 offen sc1
L_q_o4:
    s_waitcnt lgkmcnt(10)
    v_mfma_f32_16x16x32_bf16 v[172:175], v[40:43], v[76:79], v[172:175]
    ds_read_b64_tr_b16 v[92:93], v21 offset:24576
    s_waitcnt lgkmcnt(10)
    v_mfma_f32_16x16x32_bf16 v[108:111], v[76:79], v[44:47], v[108:111]
    ds_read_b64_tr_b16 v[94:95], v21 offset:25600
    s_waitcnt lgkmcnt(10)
    v_mfma_f32_16x16x32_bf16 v[124:127], v[76:79], v[48:51], v[124:127]
    ds_read_b128 v[60:63], v14 offset:0
    s_waitcnt lgkmcnt(10)
    v_mfma_f32_16x16x32_bf16 v[140:143], v[76:79], v[52:55], v[140:143]
    ds_read_b128 v[64:67], v14 offset:2048
    s_waitcnt lgkmcnt(10)
    v_mfma_f32_16x16x32_bf16 v[156:159], v[76:79], v[56:59], v[156:159]
    ds_read_b128 v[68:71], v14 offset:4096
    s_waitcnt lgkmcnt(9)
    v_mfma_f32_16x16x32_bf16 v[176:179], v[40:43], v[80:83], v[176:179]
    ds_read_b128 v[72:75], v14 offset:6144
    v_mfma_f32_16x16x32_bf16 v[112:115], v[80:83], v[44:47], v[112:115]
    ds_read_b64_tr_b16 v[96:97], v22 offset:24576
    v_mfma_f32_16x16x32_bf16 v[128:131], v[80:83], v[48:51], v[128:131]
    ds_read_b64_tr_b16 v[98:99], v22 offset:25600
    v_mfma_f32_16x16x32_bf16 v[144:147], v[80:83], v[52:55], v[144:147]
    ds_read_b64_tr_b16 v[100:101], v23 offset:24576
    v_mfma_f32_16x16x32_bf16 v[160:163], v[80:83], v[56:59], v[160:163]
    ds_read_b64_tr_b16 v[102:103], v23 offset:25600
    s_waitcnt lgkmcnt(12)
    v_mfma_f32_16x16x32_bf16 v[116:119], v[84:87], v[44:47], v[116:119]
    ds_read_b64_tr_b16 v[104:105], v24 offset:24576
    v_mfma_f32_16x16x32_bf16 v[132:135], v[84:87], v[48:51], v[132:135]
    ds_read_b64_tr_b16 v[106:107], v24 offset:25600
    v_mfma_f32_16x16x32_bf16 v[148:151], v[84:87], v[52:55], v[148:151]
    v_mfma_f32_16x16x32_bf16 v[164:167], v[84:87], v[56:59], v[164:167]
    s_waitcnt lgkmcnt(12)
    v_mfma_f32_16x16x32_bf16 v[120:123], v[88:91], v[44:47], v[120:123]
    v_mfma_f32_16x16x32_bf16 v[136:139], v[88:91], v[48:51], v[136:139]
    v_mfma_f32_16x16x32_bf16 v[152:155], v[88:91], v[52:55], v[152:155]
    v_mfma_f32_16x16x32_bf16 v[168:171], v[88:91], v[56:59], v[168:171]
    s_barrier
    s_waitcnt lgkmcnt(10)
    v_mfma_f32_16x16x32_bf16 v[172:175], v[40:43], v[92:95], v[172:175]
    ds_read_b64_tr_b16 v[76:77], v21 offset:49152
    s_waitcnt lgkmcnt(10)
    v_mfma_f32_16x16x32_bf16 v[108:111], v[92:95], v[60:63], v[108:111]
    ds_read_b64_tr_b16 v[78:79], v21 offset:50176
    s_waitcnt lgkmcnt(10)
    v_mfma_f32_16x16x32_bf16 v[124:127], v[92:95], v[64:67], v[124:127]
    ds_read_b128 v[44:47], v13 offset:32768
    s_waitcnt lgkmcnt(10)
    v_mfma_f32_16x16x32_bf16 v[140:143], v[92:95], v[68:71], v[140:143]
    ds_read_b128 v[48:51], v13 offset:34816
    s_waitcnt lgkmcnt(10)
    v_mfma_f32_16x16x32_bf16 v[156:159], v[92:95], v[72:75], v[156:159]
    ds_read_b128 v[52:55], v13 offset:36864
    s_waitcnt lgkmcnt(9)
    v_mfma_f32_16x16x32_bf16 v[176:179], v[40:43], v[96:99], v[176:179]
    ds_read_b128 v[56:59], v13 offset:38912
    v_mfma_f32_16x16x32_bf16 v[112:115], v[96:99], v[60:63], v[112:115]
    ds_read_b64_tr_b16 v[80:81], v22 offset:49152
    v_mfma_f32_16x16x32_bf16 v[128:131], v[96:99], v[64:67], v[128:131]
    ds_read_b64_tr_b16 v[82:83], v22 offset:50176
    v_mfma_f32_16x16x32_bf16 v[144:147], v[96:99], v[68:71], v[144:147]
    ds_read_b64_tr_b16 v[84:85], v23 offset:49152
    v_mfma_f32_16x16x32_bf16 v[160:163], v[96:99], v[72:75], v[160:163]
    ds_read_b64_tr_b16 v[86:87], v23 offset:50176
    s_waitcnt lgkmcnt(12)
    v_mfma_f32_16x16x32_bf16 v[116:119], v[100:103], v[60:63], v[116:119]
    ds_read_b64_tr_b16 v[88:89], v24 offset:49152
    v_mfma_f32_16x16x32_bf16 v[132:135], v[100:103], v[64:67], v[132:135]
    ds_read_b64_tr_b16 v[90:91], v24 offset:50176
    v_mfma_f32_16x16x32_bf16 v[148:151], v[100:103], v[68:71], v[148:151]
    v_mfma_f32_16x16x32_bf16 v[164:167], v[100:103], v[72:75], v[164:167]
    s_waitcnt lgkmcnt(12)
    v_mfma_f32_16x16x32_bf16 v[120:123], v[104:107], v[60:63], v[120:123]
    v_mfma_f32_16x16x32_bf16 v[136:139], v[104:107], v[64:67], v[136:139]
    v_mfma_f32_16x16x32_bf16 v[152:155], v[104:107], v[68:71], v[152:155]
    v_mfma_f32_16x16x32_bf16 v[168:171], v[104:107], v[72:75], v[168:171]
    s_waitcnt lgkmcnt(10)
    v_mfma_f32_16x16x32_bf16 v[172:175], v[40:43], v[76:79], v[172:175]
    ds_read_b64_tr_b16 v[92:93], v21 offset:57344
    s_waitcnt lgkmcnt(10)
    v_mfma_f32_16x16x32_bf16 v[108:111], v[76:79], v[44:47], v[108:111]
    ds_read_b64_tr_b16 v[94:95], v21 offset:58368
    s_waitcnt lgkmcnt(10)
    v_mfma_f32_16x16x32_bf16 v[124:127], v[76:79], v[48:51], v[124:127]
    ds_read_b128 v[60:63], v14 offset:32768
    s_waitcnt lgkmcnt(10)
    v_mfma_f32_16x16x32_bf16 v[140:143], v[76:79], v[52:55], v[140:143]
    ds_read_b128 v[64:67], v14 offset:34816
    s_waitcnt lgkmcnt(10)
    v_mfma_f32_16x16x32_bf16 v[156:159], v[76:79], v[56:59], v[156:159]
    ds_read_b128 v[68:71], v14 offset:36864
    s_waitcnt lgkmcnt(9)
    v_mfma_f32_16x16x32_bf16 v[176:179], v[40:43], v[80:83], v[176:179]
    ds_read_b128 v[72:75], v14 offset:38912
    v_mfma_f32_16x16x32_bf16 v[112:115], v[80:83], v[44:47], v[112:115]
    ds_read_b64_tr_b16 v[96:97], v22 offset:57344
    v_mfma_f32_16x16x32_bf16 v[128:131], v[80:83], v[48:51], v[128:131]
    ds_read_b64_tr_b16 v[98:99], v22 offset:58368
    v_mfma_f32_16x16x32_bf16 v[144:147], v[80:83], v[52:55], v[144:147]
    ds_read_b64_tr_b16 v[100:101], v23 offset:57344
    v_mfma_f32_16x16x32_bf16 v[160:163], v[80:83], v[56:59], v[160:163]
    ds_read_b64_tr_b16 v[102:103], v23 offset:58368
    s_waitcnt lgkmcnt(12)
    v_mfma_f32_16x16x32_bf16 v[116:119], v[84:87], v[44:47], v[116:119]
    ds_read_b64_tr_b16 v[104:105], v24 offset:57344
    v_mfma_f32_16x16x32_bf16 v[132:135], v[84:87], v[48:51], v[132:135]
    ds_read_b64_tr_b16 v[106:107], v24 offset:58368
    v_mfma_f32_16x16x32_bf16 v[148:151], v[84:87], v[52:55], v[148:151]
    v_mfma_f32_16x16x32_bf16 v[164:167], v[84:87], v[56:59], v[164:167]
    s_waitcnt lgkmcnt(12)
    v_mfma_f32_16x16x32_bf16 v[120:123], v[88:91], v[44:47], v[120:123]
    v_mfma_f32_16x16x32_bf16 v[136:139], v[88:91], v[48:51], v[136:139]
    v_mfma_f32_16x16x32_bf16 v[152:155], v[88:91], v[52:55], v[152:155]
    v_mfma_f32_16x16x32_bf16 v[168:171], v[88:91], v[56:59], v[168:171]
    s_cmp_lg_u32 s24, 2
    s_cbranch_scc1 L_q_o5
    s_mov_b32 s28, 0
    s_waitcnt vmcnt(0)
L_qkv_xp0:
    v_cmp_ne_u32 vcc, 1, v247
    s_nop 4
    s_cbranch_vccz L_qkv_xo0
    s_sleep 8
    buffer_load_dword v247, v246, s[76:79], s27 offen sc1
    s_add_u32 s28, s28, 1
    s_cmp_lt_u32 s28, 100000
    s_waitcnt vmcnt(0)
    s_cbranch_scc1 L_qkv_xp0
L_qkv_xo0:
L_q_o5:
    s_barrier
    buffer_load_dwordx2 v[180:181], v31, s[20:23], s50 offen offset:0 sc1
    buffer_load_dwordx2 v[182:183], v31, s[20:23], s50 offen offset:128 sc1
    buffer_load_dwordx2 v[184:185], v31, s[20:23], s50 offen offset:256 sc1
    buffer_load_dwordx2 v[186:187], v31, s[20:23], s50 offen offset:384 sc1
    s_waitcnt lgkmcnt(10)
    v_mfma_f32_16x16x32_bf16 v[172:175], v[40:43], v[92:95], v[172:175]
    ds_read_b64_tr_b16 v[76:77], v25 offset:16384
    s_waitcnt lgkmcnt(10)
    v_mfma_f32_16x16x32_bf16 v[108:111], v[92:95], v[60:63], v[108:111]
    ds_read_b64_tr_b16 v[78:79], v25 offset:17408
    s_waitcnt lgkmcnt(10)
    v_mfma_f32_16x16x32_bf16 v[124:127], v[92:95], v[64:67], v[124:127]
    ds_read_b128 v[44:47], v15 offset:0
    s_waitcnt lgkmcnt(10)
    v_mfma_f32_16x16x32_bf16 v[140:143], v[92:95], v[68:71], v[140:143]
    ds_read_b128 v[48:51], v15 offset:2048
    s_waitcnt lgkmcnt(10)
    v_mfma_f32_16x16x32_bf16 v[156:159], v[92:95], v[72:75], v[156:159]
    ds_read_b128 v[52:55], v15 offset:4096
    s_waitcnt lgkmcnt(9)
    v_mfma_f32_16x16x32_bf16 v[176:179], v[40:43], v[96:99], v[176:179]
    ds_read_b128 v[56:59], v15 offset:6144
    v_mfma_f32_16x16x32_bf16 v[112:115], v[96:99], v[60:63], v[112:115]
    ds_read_b64_tr_b16 v[80:81], v26 offset:16384
    v_mfma_f32_16x16x32_bf16 v[128:131], v[96:99], v[64:67], v[128:131]
    ds_read_b64_tr_b16 v[82:83], v26 offset:17408
    v_mfma_f32_16x16x32_bf16 v[144:147], v[96:99], v[68:71], v[144:147]
    ds_read_b64_tr_b16 v[84:85], v27 offset:16384
    v_mfma_f32_16x16x32_bf16 v[160:163], v[96:99], v[72:75], v[160:163]
    ds_read_b64_tr_b16 v[86:87], v27 offset:17408
    s_waitcnt lgkmcnt(12)
    v_mfma_f32_16x16x32_bf16 v[116:119], v[100:103], v[60:63], v[116:119]
    ds_read_b64_tr_b16 v[88:89], v28 offset:16384
    v_mfma_f32_16x16x32_bf16 v[132:135], v[100:103], v[64:67], v[132:135]
    ds_read_b64_tr_b16 v[90:91], v28 offset:17408
    v_mfma_f32_16x16x32_bf16 v[148:151], v[100:103], v[68:71], v[148:151]
    v_mfma_f32_16x16x32_bf16 v[164:167], v[100:103], v[72:75], v[164:167]
    s_waitcnt lgkmcnt(12)
    v_mfma_f32_16x16x32_bf16 v[120:123], v[104:107], v[60:63], v[120:123]
    v_mfma_f32_16x16x32_bf16 v[136:139], v[104:107], v[64:67], v[136:139]
    v_mfma_f32_16x16x32_bf16 v[152:155], v[104:107], v[68:71], v[152:155]
    v_mfma_f32_16x16x32_bf16 v[168:171], v[104:107], v[72:75], v[168:171]
    s_waitcnt lgkmcnt(10)
    v_mfma_f32_16x16x32_bf16 v[172:175], v[40:43], v[76:79], v[172:175]
    ds_read_b64_tr_b16 v[92:93], v25 offset:24576
    s_waitcnt lgkmcnt(10)
    v_mfma_f32_16x16x32_bf16 v[108:111], v[76:79], v[44:47], v[108:111]
    ds_read_b64_tr_b16 v[94:95], v25 offset:25600
    s_waitcnt lgkmcnt(10)
    v_mfma_f32_16x16x32_bf16 v[124:127], v[76:79], v[48:51], v[124:127]
    ds_read_b128 v[60:63], v16 offset:0
    s_waitcnt lgkmcnt(10)
    v_mfma_f32_16x16x32_bf16 v[140:143], v[76:79], v[52:55], v[140:143]
    ds_read_b128 v[64:67], v16 offset:2048
    s_waitcnt lgkmcnt(10)
    v_mfma_f32_16x16x32_bf16 v[156:159], v[76:79], v[56:59], v[156:159]
    ds_read_b128 v[68:71], v16 offset:4096
    s_waitcnt lgkmcnt(9)
    v_mfma_f32_16x16x32_bf16 v[176:179], v[40:43], v[80:83], v[176:179]
    ds_read_b128 v[72:75], v16 offset:6144
    v_mfma_f32_16x16x32_bf16 v[112:115], v[80:83], v[44:47], v[112:115]
    ds_read_b64_tr_b16 v[96:97], v26 offset:24576
    v_mfma_f32_16x16x32_bf16 v[128:131], v[80:83], v[48:51], v[128:131]
    ds_read_b64_tr_b16 v[98:99], v26 offset:25600
    v_mfma_f32_16x16x32_bf16 v[144:147], v[80:83], v[52:55], v[144:147]
    ds_read_b64_tr_b16 v[100:101], v27 offset:24576
    v_mfma_f32_16x16x32_bf16 v[160:163], v[80:83], v[56:59], v[160:163]
    ds_read_b64_tr_b16 v[102:103], v27 offset:25600
    s_waitcnt lgkmcnt(12)
    v_mfma_f32_16x16x32_bf16 v[116:119], v[84:87], v[44:47], v[116:119]
    ds_read_b64_tr_b16 v[104:105], v28 offset:24576
    v_mfma_f32_16x16x32_bf16 v[132:135], v[84:87], v[48:51], v[132:135]
    ds_read_b64_tr_b16 v[106:107], v28 offset:25600
    v_mfma_f32_16x16x32_bf16 v[148:151], v[84:87], v[52:55], v[148:151]
    v_mfma_f32_16x16x32_bf16 v[164:167], v[84:87], v[56:59], v[164:167]
    s_waitcnt lgkmcnt(12)
    v_mfma_f32_16x16x32_bf16 v[120:123], v[88:91], v[44:47], v[120:123]
    v_mfma_f32_16x16x32_bf16 v[136:139], v[88:91], v[48:51], v[136:139]
    v_mfma_f32_16x16x32_bf16 v[152:155], v[88:91], v[52:55], v[152:155]
    v_mfma_f32_16x16x32_bf16 v[168:171], v[88:91], v[56:59], v[168:171]
    s_waitcnt lgkmcnt(10)
    v_mfma_f32_16x16x32_bf16 v[172:175], v[40:43], v[92:95], v[172:175]
    s_waitcnt lgkmcnt(9)
    v_mfma_f32_16x16x32_bf16 v[108:111], v[92:95], v[60:63], v[108:111]
    s_waitcnt lgkmcnt(8)
    v_mfma_f32_16x16x32_bf16 v[124:127], v[92:95], v[64:67], v[124:127]
    s_waitcnt lgkmcnt(7)
    v_mfma_f32_16x16x32_bf16 v[140:143], v[92:95], v[68:71], v[140:143]
    s_waitcnt lgkmcnt(6)
    v_mfma_f32_16x16x32_bf16 v[156:159], v[92:95], v[72:75], v[156:159]
    s_waitcnt lgkmcnt(4)
    v_mfma_f32_16x16x32_bf16 v[176:179], v[40:43], v[96:99], v[176:179]
    v_mfma_f32_16x16x32_bf16 v[112:115], v[96:99], v[60:63], v[112:115]
    v_mfma_f32_16x16x32_bf16 v[128:131], v[96:99], v[64:67], v[128:131]
    v_mfma_f32_16x16x32_bf16 v[144:147], v[96:99], v[68:71], v[144:147]
    v_mfma_f32_16x16x32_bf16 v[160:163], v[96:99], v[72:75], v[160:163]
    s_waitcnt lgkmcnt(2)
    v_mfma_f32_16x16x32_bf16 v[116:119], v[100:103], v[60:63], v[116:119]
    v_mfma_f32_16x16x32_bf16 v[132:135], v[100:103], v[64:67], v[132:135]
    v_mfma_f32_16x16x32_bf16 v[148:151], v[100:103], v[68:71], v[148:151]
    v_mfma_f32_16x16x32_bf16 v[164:167], v[100:103], v[72:75], v[164:167]
    s_mov_b64 exec, 0xffff
    ds_write_b32 v36, v172
    ds_write_b32 v36, v176 offset:64
    s_mov_b64 exec, -1
    s_waitcnt lgkmcnt(2)
    v_mfma_f32_16x16x32_bf16 v[120:123], v[104:107], v[60:63], v[120:123]
    v_mfma_f32_16x16x32_bf16 v[136:139], v[104:107], v[64:67], v[136:139]
    v_mfma_f32_16x16x32_bf16 v[152:155], v[104:107], v[68:71], v[152:155]
    v_mfma_f32_16x16x32_bf16 v[168:171], v[104:107], v[72:75], v[168:171]
    s_waitcnt lgkmcnt(0)
    s_barrier
    ds_read_b128 v[212:215], v32
    ds_read_b128 v[216:219], v33
    ds_read_b128 v[220:223], v34
    ds_read_b128 v[224:227], v35
    s_waitcnt vmcnt(0)
    v_mul_f32 v180, s34, v180
    v_mul_f32 v181, s34, v181
    v_mul_f32 v182, s34, v182
    v_mul_f32 v183, s34, v183
    v_mul_f32 v184, s34, v184
    v_mul_f32 v185, s34, v185
    v_mul_f32 v186, s34, v186
    v_mul_f32 v187, s34, v187
    s_waitcnt lgkmcnt(3)
    v_pk_mul_f32 v[108:109], v[108:109], v[180:181] op_sel_hi:[1,0]
    v_pk_mul_f32 v[110:111], v[110:111], v[180:181] op_sel_hi:[1,0]
    v_pk_mul_f32 v[124:125], v[124:125], v[182:183] op_sel_hi:[1,0]
    v_pk_mul_f32 v[126:127], v[126:127], v[182:183] op_sel_hi:[1,0]
    v_pk_mul_f32 v[140:141], v[140:141], v[184:185] op_sel_hi:[1,0]
    v_pk_mul_f32 v[142:143], v[142:143], v[184:185] op_sel_hi:[1,0]
    v_pk_mul_f32 v[156:157], v[156:157], v[186:187] op_sel_hi:[1,0]
    v_pk_mul_f32 v[158:159], v[158:159], v[186:187] op_sel_hi:[1,0]
    v_pk_fma_f32 v[108:109], v[212:213], v[180:181], v[108:109] op_sel:[0,1,0] op_sel_hi:[1,1,1]
    v_pk_fma_f32 v[110:111], v[214:215], v[180:181], v[110:111] op_sel:[0,1,0] op_sel_hi:[1,1,1]
    v_pk_fma_f32 v[124:125], v[212:213], v[182:183], v[124:125] op_sel:[0,1,0] op_sel_hi:[1,1,1]
    v_pk_fma_f32 v[126:127], v[214:215], v[182:183], v[126:127] op_sel:[0,1,0] op_sel_hi:[1,1,1]
    v_pk_fma_f32 v[140:141], v[212:213], v[184:185], v[140:141] op_sel:[0,1,0] op_sel_hi:[1,1,1]
    v_pk_fma_f32 v[142:143], v[214:215], v[184:185], v[142:143] op_sel:[0,1,0] op_sel_hi:[1,1,1]
    v_pk_fma_f32 v[156:157], v[212:213], v[186:187], v[156:157] op_sel:[0,1,0] op_sel_hi:[1,1,1]
    v_pk_fma_f32 v[158:159], v[214:215], v[186:187], v[158:159] op_sel:[0,1,0] op_sel_hi:[1,1,1]
    v_cvt_pk_bf16_f32 v44, v108, v109
    v_cvt_pk_bf16_f32 v45, v110, v111
    v_cvt_pk_bf16_f32 v46, v124, v125
    v_cvt_pk_bf16_f32 v47, v126, v127
    v_cvt_pk_bf16_f32 v48, v140, v141
    v_cvt_pk_bf16_f32 v49, v142, v143
    v_cvt_pk_bf16_f32 v50, v156, v157
    v_cvt_pk_bf16_f32 v51, v158, v159
    buffer_store_dwordx2 v[44:45], v29, s[20:23], s44 offen offset:0 sc1
    buffer_store_dwordx2 v[46:47], v29, s[20:23], s44 offen offset:128 sc1
    buffer_store_dwordx2 v[48:49], v30, s[20:23], s44 offen offset:0 sc1
    buffer_store_dwordx2 v[50:51], v30, s[20:23], s44 offen offset:128 sc1
    s_waitcnt lgkmcnt(2)
    v_pk_mul_f32 v[112:113], v[112:113], v[180:181] op_sel_hi:[1,0]
    v_pk_mul_f32 v[114:115], v[114:115], v[180:181] op_sel_hi:[1,0]
    v_pk_mul_f32 v[128:129], v[128:129], v[182:183] op_sel_hi:[1,0]
    v_pk_mul_f32 v[130:131], v[130:131], v[182:183] op_sel_hi:[1,0]
    v_pk_mul_f32 v[144:145], v[144:145], v[184:185] op_sel_hi:[1,0]
    v_pk_mul_f32 v[146:147], v[146:147], v[184:185] op_sel_hi:[1,0]
    v_pk_mul_f32 v[160:161], v[160:161], v[186:187] op_sel_hi:[1,0]
    v_pk_mul_f32 v[162:163], v[162:163], v[186:187] op_sel_hi:[1,0]
    v_pk_fma_f32 v[112:113], v[216:217], v[180:181], v[112:113] op_sel:[0,1,0] op_sel_hi:[1,1,1]
    v_pk_fma_f32 v[114:115], v[218:219], v[180:181], v[114:115] op_sel:[0,1,0] op_sel_hi:[1,1,1]
    v_pk_fma_f32 v[128:129], v[216:217], v[182:183], v[128:129] op_sel:[0,1,0] op_sel_hi:[1,1,1]
    v_pk_fma_f32 v[130:131], v[218:219], v[182:183], v[130:131] op_sel:[0,1,0] op_sel_hi:[1,1,1]
    v_pk_fma_f32 v[144:145], v[216:217], v[184:185], v[144:145] op_sel:[0,1,0] op_sel_hi:[1,1,1]
    v_pk_fma_f32 v[146:147], v[218:219], v[184:185], v[146:147] op_sel:[0,1,0] op_sel_hi:[1,1,1]
    v_pk_fma_f32 v[160:161], v[216:217], v[186:187], v[160:161] op_sel:[0,1,0] op_sel_hi:[1,1,1]
    v_pk_fma_f32 v[162:163], v[218:219], v[186:187], v[162:163] op_sel:[0,1,0] op_sel_hi:[1,1,1]
    v_cvt_pk_bf16_f32 v52, v112, v113
    v_cvt_pk_bf16_f32 v53, v114, v115
    v_cvt_pk_bf16_f32 v54, v128, v129
    v_cvt_pk_bf16_f32 v55, v130, v131
    v_cvt_pk_bf16_f32 v56, v144, v145
    v_cvt_pk_bf16_f32 v57, v146, v147
    v_cvt_pk_bf16_f32 v58, v160, v161
    v_cvt_pk_bf16_f32 v59, v162, v163
    buffer_store_dwordx2 v[52:53], v29, s[20:23], s45 offen offset:0 sc1
    buffer_store_dwordx2 v[54:55], v29, s[20:23], s45 offen offset:128 sc1
    buffer_store_dwordx2 v[56:57], v30, s[20:23], s45 offen offset:0 sc1
    buffer_store_dwordx2 v[58:59], v30, s[20:23], s45 offen offset:128 sc1
    s_waitcnt lgkmcnt(1)
    v_pk_mul_f32 v[116:117], v[116:117], v[180:181] op_sel_hi:[1,0]
    v_pk_mul_f32 v[118:119], v[118:119], v[180:181] op_sel_hi:[1,0]
    v_pk_mul_f32 v[132:133], v[132:133], v[182:183] op_sel_hi:[1,0]
    v_pk_mul_f32 v[134:135], v[134:135], v[182:183] op_sel_hi:[1,0]
    v_pk_mul_f32 v[148:149], v[148:149], v[184:185] op_sel_hi:[1,0]
    v_pk_mul_f32 v[150:151], v[150:151], v[184:185] op_sel_hi:[1,0]
    v_pk_mul_f32 v[164:165], v[164:165], v[186:187] op_sel_hi:[1,0]
    v_pk_mul_f32 v[166:167], v[166:167], v[186:187] op_sel_hi:[1,0]
    v_pk_fma_f32 v[116:117], v[220:221], v[180:181], v[116:117] op_sel:[0,1,0] op_sel_hi:[1,1,1]
    v_pk_fma_f32 v[118:119], v[222:223], v[180:181], v[118:119] op_sel:[0,1,0] op_sel_hi:[1,1,1]
    v_pk_fma_f32 v[132:133], v[220:221], v[182:183], v[132:133] op_sel:[0,1,0] op_sel_hi:[1,1,1]
    v_pk_fma_f32 v[134:135], v[222:223], v[182:183], v[134:135] op_sel:[0,1,0] op_sel_hi:[1,1,1]
    v_pk_fma_f32 v[148:149], v[220:221], v[184:185], v[148:149] op_sel:[0,1,0] op_sel_hi:[1,1,1]
    v_pk_fma_f32 v[150:151], v[222:223], v[184:185], v[150:151] op_sel:[0,1,0] op_sel_hi:[1,1,1]
    v_pk_fma_f32 v[164:165], v[220:221], v[186:187], v[164:165] op_sel:[0,1,0] op_sel_hi:[1,1,1]
    v_pk_fma_f32 v[166:167], v[222:223], v[186:187], v[166:167] op_sel:[0,1,0] op_sel_hi:[1,1,1]
    v_cvt_pk_bf16_f32 v76, v116, v117
    v_cvt_pk_bf16_f32 v77, v118, v119
    v_cvt_pk_bf16_f32 v78, v132, v133
    v_cvt_pk_bf16_f32 v79, v134, v135
    v_cvt_pk_bf16_f32 v80, v148, v149
    v_cvt_pk_bf16_f32 v81, v150, v151
    v_cvt_pk_bf16_f32 v82, v164, v165
    v_cvt_pk_bf16_f32 v83, v166, v167
    buffer_store_dwordx2 v[76:77], v29, s[20:23], s46 offen offset:0 sc1
    buffer_store_dwordx2 v[78:79], v29, s[20:23], s46 offen offset:128 sc1
    buffer_store_dwordx2 v[80:81], v30, s[20:23], s46 offen offset:0 sc1
    buffer_store_dwordx2 v[82:83], v30, s[20:23], s46 offen offset:128 sc1
    s_waitcnt lgkmcnt(0)
    v_pk_mul_f32 v[120:121], v[120:121], v[180:181] op_sel_hi:[1,0]
    v_pk_mul_f32 v[122:123], v[122:123], v[180:181] op_sel_hi:[1,0]
    v_pk_mul_f32 v[136:137], v[136:137], v[182:183] op_sel_hi:[1,0]
    v_pk_mul_f32 v[138:139], v[138:139], v[182:183] op_sel_hi:[1,0]
    v_pk_mul_f32 v[152:153], v[152:153], v[184:185] op_sel_hi:[1,0]
    v_pk_mul_f32 v[154:155], v[154:155], v[184:185] op_sel_hi:[1,0]
    v_pk_mul_f32 v[168:169], v[168:169], v[186:187] op_sel_hi:[1,0]
    v_pk_mul_f32 v[170:171], v[170:171], v[186:187] op_sel_hi:[1,0]
    v_pk_fma_f32 v[120:121], v[224:225], v[180:181], v[120:121] op_sel:[0,1,0] op_sel_hi:[1,1,1]
    v_pk_fma_f32 v[122:123], v[226:227], v[180:181], v[122:123] op_sel:[0,1,0] op_sel_hi:[1,1,1]
    v_pk_fma_f32 v[136:137], v[224:225], v[182:183], v[136:137] op_sel:[0,1,0] op_sel_hi:[1,1,1]
    v_pk_fma_f32 v[138:139], v[226:227], v[182:183], v[138:139] op_sel:[0,1,0] op_sel_hi:[1,1,1]
    v_pk_fma_f32 v[152:153], v[224:225], v[184:185], v[152:153] op_sel:[0,1,0] op_sel_hi:[1,1,1]
    v_pk_fma_f32 v[154:155], v[226:227], v[184:185], v[154:155] op_sel:[0,1,0] op_sel_hi:[1,1,1]
    v_pk_fma_f32 v[168:169], v[224:225], v[186:187], v[168:169] op_sel:[0,1,0] op_sel_hi:[1,1,1]
    v_pk_fma_f32 v[170:171], v[226:227], v[186:187], v[170:171] op_sel:[0,1,0] op_sel_hi:[1,1,1]
    v_cvt_pk_bf16_f32 v84, v120, v121
    v_cvt_pk_bf16_f32 v85, v122, v123
    v_cvt_pk_bf16_f32 v86, v136, v137
    v_cvt_pk_bf16_f32 v87, v138, v139
    v_cvt_pk_bf16_f32 v88, v152, v153
    v_cvt_pk_bf16_f32 v89, v154, v155
    v_cvt_pk_bf16_f32 v90, v168, v169
    v_cvt_pk_bf16_f32 v91, v170, v171
    buffer_store_dwordx2 v[84:85], v29, s[20:23], s47 offen offset:0 sc1
    buffer_store_dwordx2 v[86:87], v29, s[20:23], s47 offen offset:128 sc1
    buffer_store_dwordx2 v[88:89], v30, s[20:23], s47 offen offset:0 sc1
    buffer_store_dwordx2 v[90:91], v30, s[20:23], s47 offen offset:128 sc1
    s_branch L_qkv_fin
L_qkv_vpath:
    s_lshl_b32 s27, s26, 11
    s_add_u32 s33, s33, s27
    s_add_u32 s33, s33, 5746688
    s_xor_b32 s27, s39, 0
    s_lshl_b32 s28, s27, 8
    s_add_u32 s44, s28, s33
    v_xor_b32 v32, 0, v36
    s_xor_b32 s27, s39, 1
    s_lshl_b32 s28, s27, 8
    s_add_u32 s45, s28, s33
    v_xor_b32 v33, 64, v36
    s_xor_b32 s27, s39, 2
    s_lshl_b32 s28, s27, 8
    s_add_u32 s46, s28, s33
    v_xor_b32 v34, 128, v36
    s_xor_b32 s27, s39, 3
    s_lshl_b32 s28, s27, 8
    s_add_u32 s47, s28, s33
    v_xor_b32 v35, 192, v36
    v_mul_u32_u24 v29, 10240, v5
    v_lshl_add_u32 v29, v6, 4, v29
    v_add_u32 v30, 40960, v29
    s_lshl_b32 s27, s35, 9
    v_lshl_add_u32 v31, v5, 5, s27
    s_barrier
    ds_read_b64_tr_b16 v[76:77], v17 offset:16384
    ds_read_b64_tr_b16 v[78:79], v17 offset:17408
    ds_read_b128 v[44:47], v11 offset:0
    ds_read_b128 v[48:51], v11 offset:2048
    ds_read_b128 v[52:55], v11 offset:4096
    ds_read_b128 v[56:59], v11 offset:6144
    ds_read_b64_tr_b16 v[80:81], v18 offset:16384
    ds_read_b64_tr_b16 v[82:83], v18 offset:17408
    ds_read_b64_tr_b16 v[84:85], v19 offset:16384
    ds_read_b64_tr_b16 v[86:87], v19 offset:17408
    ds_read_b64_tr_b16 v[88:89], v20 offset:16384
    ds_read_b64_tr_b16 v[90:91], v20 offset:17408
    s_waitcnt lgkmcnt(10)
    v_mfma_f32_16x16x32_bf16 v[172:175], v[40:43], v[76:79], 0
    ds_read_b64_tr_b16 v[92:93], v17 offset:24576
    s_waitcnt lgkmcnt(10)
    v_mfma_f32_16x16x32_bf16 v[108:111], v[44:47], v[76:79], 0
    ds_read_b64_tr_b16 v[94:95], v17 offset:25600
    s_waitcnt lgkmcnt(10)
    v_mfma_f32_16x16x32_bf16 v[124:127], v[48:51], v[76:79], 0
    ds_read_b128 v[60:63], v12 offset:0
    s_waitcnt lgkmcnt(10)
    v_mfma_f32_16x16x32_bf16 v[140:143], v[52:55], v[76:79], 0
    ds_read_b128 v[64:67], v12 offset:2048
    s_waitcnt lgkmcnt(10)
    v_mfma_f32_16x16x32_bf16 v[156:159], v[56:59], v[76:79], 0
    ds_read_b128 v[68:71], v12 offset:4096
    s_waitcnt lgkmcnt(9)
    v_mfma_f32_16x16x32_bf16 v[176:179], v[40:43], v[80:83], 0
    ds_read_b128 v[72:75], v12 offset:6144
    v_mfma_f32_16x16x32_bf16 v[112:115], v[44:47], v[80:83], 0
    ds_read_b64_tr_b16 v[96:97], v18 offset:24576
    v_mfma_f32_16x16x32_bf16 v[128:131], v[48:51], v[80:83], 0
    ds_read_b64_tr_b16 v[98:99], v18 offset:25600
    v_mfma_f32_16x16x32_bf16 v[144:147], v[52:55], v[80:83], 0
    ds_read_b64_tr_b16 v[100:101], v19 offset:24576
    v_mfma_f32_16x16x32_bf16 v[160:163], v[56:59], v[80:83], 0
    ds_read_b64_tr_b16 v[102:103], v19 offset:25600
    s_waitcnt lgkmcnt(12)
    v_mfma_f32_16x16x32_bf16 v[116:119], v[44:47], v[84:87], 0
    ds_read_b64_tr_b16 v[104:105], v20 offset:24576
    v_mfma_f32_16x16x32_bf16 v[132:135], v[48:51], v[84:87], 0
    ds_read_b64_tr_b16 v[106:107], v20 offset:25600
    v_mfma_f32_16x16x32_bf16 v[148:151], v[52:55], v[84:87], 0
    v_mfma_f32_16x16x32_bf16 v[164:167], v[56:59], v[84:87], 0
    s_waitcnt lgkmcnt(12)
    v_mfma_f32_16x16x32_bf16 v[120:123], v[44:47], v[88:91], 0
    v_mfma_f32_16x16x32_bf16 v[136:139], v[48:51], v[88:91], 0
    v_mfma_f32_16x16x32_bf16 v[152:155], v[52:55], v[88:91], 0
    v_mfma_f32_16x16x32_bf16 v[168:171], v[56:59], v[88:91], 0
    s_barrier
    s_waitcnt lgkmcnt(10)
    v_mfma_f32_16x16x32_bf16 v[172:175], v[40:43], v[92:95], v[172:175]
    ds_read_b64_tr_b16 v[76:77], v17 offset:49152
    s_waitcnt lgkmcnt(10)
    v_mfma_f32_16x16x32_bf16 v[108:111], v[60:63], v[92:95], v[108:111]
    ds_read_b64_tr_b16 v[78:79], v17 offset:50176
    s_waitcnt lgkmcnt(10)
    v_mfma_f32_16x16x32_bf16 v[124:127], v[64:67], v[92:95], v[124:127]
    ds_read_b128 v[44:47], v11 offset:32768
    s_waitcnt lgkmcnt(10)
    v_mfma_f32_16x16x32_bf16 v[140:143], v[68:71], v[92:95], v[140:143]
    ds_read_b128 v[48:51], v11 offset:34816
    s_waitcnt lgkmcnt(10)
    v_mfma_f32_16x16x32_bf16 v[156:159], v[72:75], v[92:95], v[156:159]
    ds_read_b128 v[52:55], v11 offset:36864
    s_waitcnt lgkmcnt(9)
    v_mfma_f32_16x16x32_bf16 v[176:179], v[40:43], v[96:99], v[176:179]
    ds_read_b128 v[56:59], v11 offset:38912
    v_mfma_f32_16x16x32_bf16 v[112:115], v[60:63], v[96:99], v[112:115]
    ds_read_b64_tr_b16 v[80:81], v18 offset:49152
    v_mfma_f32_16x16x32_bf16 v[128:131], v[64:67], v[96:99], v[128:131]
    ds_read_b64_tr_b16 v[82:83], v18 offset:50176
    v_mfma_f32_16x16x32_bf16 v[144:147], v[68:71], v[96:99], v[144:147]
    ds_read_b64_tr_b16 v[84:85], v19 offset:49152
    v_mfma_f32_16x16x32_bf16 v[160:163], v[72:75], v[96:99], v[160:163]
    ds_read_b64_tr_b16 v[86:87], v19 offset:50176
    s_waitcnt lgkmcnt(12)
    v_mfma_f32_16x16x32_bf16 v[116:119], v[60:63], v[100:103], v[116:119]
    ds_read_b64_tr_b16 v[88:89], v20 offset:49152
    v_mfma_f32_16x16x32_bf16 v[132:135], v[64:67], v[100:103], v[132:135]
    ds_read_b64_tr_b16 v[90:91], v20 offset:50176
    v_mfma_f32_16x16x32_bf16 v[148:151], v[68:71], v[100:103], v[148:151]
    v_mfma_f32_16x16x32_bf16 v[164:167], v[72:75], v[100:103], v[164:167]
    s_waitcnt lgkmcnt(12)
    v_mfma_f32_16x16x32_bf16 v[120:123], v[60:63], v[104:107], v[120:123]
    v_mfma_f32_16x16x32_bf16 v[136:139], v[64:67], v[104:107], v[136:139]
    v_mfma_f32_16x16x32_bf16 v[152:155], v[68:71], v[104:107], v[152:155]
    v_mfma_f32_16x16x32_bf16 v[168:171], v[72:75], v[104:107], v[168:171]
    s_waitcnt lgkmcnt(10)
    v_mfma_f32_16x16x32_bf16 v[172:175], v[40:43], v[76:79], v[172:175]
    ds_read_b64_tr_b16 v[92:93], v17 offset:57344
    s_waitcnt lgkmcnt(10)
    v_mfma_f32_16x16x32_bf16 v[108:111], v[44:47], v[76:79], v[108:111]
    ds_read_b64_tr_b16 v[94:95], v17 offset:58368
    s_waitcnt lgkmcnt(10)
    v_mfma_f32_16x16x32_bf16 v[124:127], v[48:51], v[76:79], v[124:127]
    ds_read_b128 v[60:63], v12 offset:32768
    s_waitcnt lgkmcnt(10)
    v_mfma_f32_16x16x32_bf16 v[140:143], v[52:55], v[76:79], v[140:143]
    ds_read_b128 v[64:67], v12 offset:34816
    s_waitcnt lgkmcnt(10)
    v_mfma_f32_16x16x32_bf16 v[156:159], v[56:59], v[76:79], v[156:159]
    ds_read_b128 v[68:71], v12 offset:36864
    s_waitcnt lgkmcnt(9)
    v_mfma_f32_16x16x32_bf16 v[176:179], v[40:43], v[80:83], v[176:179]
    ds_read_b128 v[72:75], v12 offset:38912
    v_mfma_f32_16x16x32_bf16 v[112:115], v[44:47], v[80:83], v[112:115]
    ds_read_b64_tr_b16 v[96:97], v18 offset:57344
    v_mfma_f32_16x16x32_bf16 v[128:131], v[48:51], v[80:83], v[128:131]
    ds_read_b64_tr_b16 v[98:99], v18 offset:58368
    v_mfma_f32_16x16x32_bf16 v[144:147], v[52:55], v[80:83], v[144:147]
    ds_read_b64_tr_b16 v[100:101], v19 offset:57344
    v_mfma_f32_16x16x32_bf16 v[160:163], v[56:59], v[80:83], v[160:163]
    ds_read_b64_tr_b16 v[102:103], v19 offset:58368
    s_waitcnt lgkmcnt(12)
    v_mfma_f32_16x16x32_bf16 v[116:119], v[44:47], v[84:87], v[116:119]
    ds_read_b64_tr_b16 v[104:105], v20 offset:57344
    v_mfma_f32_16x16x32_bf16 v[132:135], v[48:51], v[84:87], v[132:135]
    ds_read_b64_tr_b16 v[106:107], v20 offset:58368
    v_mfma_f32_16x16x32_bf16 v[148:151], v[52:55], v[84:87], v[148:151]
    v_mfma_f32_16x16x32_bf16 v[164:167], v[56:59], v[84:87], v[164:167]
    s_waitcnt lgkmcnt(12)
    v_mfma_f32_16x16x32_bf16 v[120:123], v[44:47], v[88:91], v[120:123]
    v_mfma_f32_16x16x32_bf16 v[136:139], v[48:51], v[88:91], v[136:139]
    v_mfma_f32_16x16x32_bf16 v[152:155], v[52:55], v[88:91], v[152:155]
    v_mfma_f32_16x16x32_bf16 v[168:171], v[56:59], v[88:91], v[168:171]
    s_barrier
    s_waitcnt lgkmcnt(10)
    v_mfma_f32_16x16x32_bf16 v[172:175], v[40:43], v[92:95], v[172:175]
    ds_read_b64_tr_b16 v[76:77], v21 offset:16384
    s_waitcnt lgkmcnt(10)
    v_mfma_f32_16x16x32_bf16 v[108:111], v[60:63], v[92:95], v[108:111]
    ds_read_b64_tr_b16 v[78:79], v21 offset:17408
    s_waitcnt lgkmcnt(10)
    v_mfma_f32_16x16x32_bf16 v[124:127], v[64:67], v[92:95], v[124:127]
    ds_read_b128 v[44:47], v13 offset:0
    s_waitcnt lgkmcnt(10)
    v_mfma_f32_16x16x32_bf16 v[140:143], v[68:71], v[92:95], v[140:143]
    ds_read_b128 v[48:51], v13 offset:2048
    s_waitcnt lgkmcnt(10)
    v_mfma_f32_16x16x32_bf16 v[156:159], v[72:75], v[92:95], v[156:159]
    ds_read_b128 v[52:55], v13 offset:4096
    s_waitcnt lgkmcnt(9)
    v_mfma_f32_16x16x32_bf16 v[176:179], v[40:43], v[96:99], v[176:179]
    ds_read_b128 v[56:59], v13 offset:6144
    v_mfma_f32_16x16x32_bf16 v[112:115], v[60:63], v[96:99], v[112:115]
    ds_read_b64_tr_b16 v[80:81], v22 offset:16384
    v_mfma_f32_16x16x32_bf16 v[128:131], v[64:67], v[96:99], v[128:131]
    ds_read_b64_tr_b16 v[82:83], v22 offset:17408
    v_mfma_f32_16x16x32_bf16 v[144:147], v[68:71], v[96:99], v[144:147]
    ds_read_b64_tr_b16 v[84:85], v23 offset:16384
    v_mfma_f32_16x16x32_bf16 v[160:163], v[72:75], v[96:99], v[160:163]
    ds_read_b64_tr_b16 v[86:87], v23 offset:17408
    s_waitcnt lgkmcnt(12)
    v_mfma_f32_16x16x32_bf16 v[116:119], v[60:63], v[100:103], v[116:119]
    ds_read_b64_tr_b16 v[88:89], v24 offset:16384
    v_mfma_f32_16x16x32_bf16 v[132:135], v[64:67], v[100:103], v[132:135]
    ds_read_b64_tr_b16 v[90:91], v24 offset:17408
    v_mfma_f32_16x16x32_bf16 v[148:151], v[68:71], v[100:103], v[148:151]
    v_mfma_f32_16x16x32_bf16 v[164:167], v[72:75], v[100:103], v[164:167]
    s_waitcnt lgkmcnt(12)
    v_mfma_f32_16x16x32_bf16 v[120:123], v[60:63], v[104:107], v[120:123]
    v_mfma_f32_16x16x32_bf16 v[136:139], v[64:67], v[104:107], v[136:139]
    v_mfma_f32_16x16x32_bf16 v[152:155], v[68:71], v[104:107], v[152:155]
    v_mfma_f32_16x16x32_bf16 v[168:171], v[72:75], v[104:107], v[168:171]
    s_waitcnt lgkmcnt(10)
    v_mfma_f32_16x16x32_bf16 v[172:175], v[40:43], v[76:79], v[172:175]
    ds_read_b64_tr_b16 v[92:93], v21 offset:24576
    s_waitcnt lgkmcnt(10)
    v_mfma_f32_16x16x32_bf16 v[108:111], v[44:47], v[76:79], v[108:111]
    ds_read_b64_tr_b16 v[94:95], v21 offset:25600
    s_waitcnt lgkmcnt(10)
    v_mfma_f32_16x16x32_bf16 v[124:127], v[48:51], v[76:79], v[124:127]
    ds_read_b128 v[60:63], v14 offset:0
    s_waitcnt lgkmcnt(10)
    v_mfma_f32_16x16x32_bf16 v[140:143], v[52:55], v[76:79], v[140:143]
    ds_read_b128 v[64:67], v14 offset:2048
    s_waitcnt lgkmcnt(10)
    v_mfma_f32_16x16x32_bf16 v[156:159], v[56:59], v[76:79], v[156:159]
    ds_read_b128 v[68:71], v14 offset:4096
    s_waitcnt lgkmcnt(9)
    v_mfma_f32_16x16x32_bf16 v[176:179], v[40:43], v[80:83], v[176:179]
    ds_read_b128 v[72:75], v14 offset:6144
    v_mfma_f32_16x16x32_bf16 v[112:115], v[44:47], v[80:83], v[112:115]
    ds_read_b64_tr_b16 v[96:97], v22 offset:24576
    v_mfma_f32_16x16x32_bf16 v[128:131], v[48:51], v[80:83], v[128:131]
    ds_read_b64_tr_b16 v[98:99], v22 offset:25600
    v_mfma_f32_16x16x32_bf16 v[144:147], v[52:55], v[80:83], v[144:147]
    ds_read_b64_tr_b16 v[100:101], v23 offset:24576
    v_mfma_f32_16x16x32_bf16 v[160:163], v[56:59], v[80:83], v[160:163]
    ds_read_b64_tr_b16 v[102:103], v23 offset:25600
    s_waitcnt lgkmcnt(12)
    v_mfma_f32_16x16x32_bf16 v[116:119], v[44:47], v[84:87], v[116:119]
    ds_read_b64_tr_b16 v[104:105], v24 offset:24576
    v_mfma_f32_16x16x32_bf16 v[132:135], v[48:51], v[84:87], v[132:135]
    ds_read_b64_tr_b16 v[106:107], v24 offset:25600
    v_mfma_f32_16x16x32_bf16 v[148:151], v[52:55], v[84:87], v[148:151]
    v_mfma_f32_16x16x32_bf16 v[164:167], v[56:59], v[84:87], v[164:167]
    s_waitcnt lgkmcnt(12)
    v_mfma_f32_16x16x32_bf16 v[120:123], v[44:47], v[88:91], v[120:123]
    v_mfma_f32_16x16x32_bf16 v[136:139], v[48:51], v[88:91], v[136:139]
    v_mfma_f32_16x16x32_bf16 v[152:155], v[52:55], v[88:91], v[152:155]
    v_mfma_f32_16x16x32_bf16 v[168:171], v[56:59], v[88:91], v[168:171]
    s_barrier
    s_waitcnt lgkmcnt(10)
    v_mfma_f32_16x16x32_bf16 v[172:175], v[40:43], v[92:95], v[172:175]
    ds_read_b64_tr_b16 v[76:77], v21 offset:49152
    s_waitcnt lgkmcnt(10)
    v_mfma_f32_16x16x32_bf16 v[108:111], v[60:63], v[92:95], v[108:111]
    ds_read_b64_tr_b16 v[78:79], v21 offset:50176
    s_waitcnt lgkmcnt(10)
    v_mfma_f32_16x16x32_bf16 v[124:127], v[64:67], v[92:95], v[124:127]
    ds_read_b128 v[44:47], v13 offset:32768
    s_waitcnt lgkmcnt(10)
    v_mfma_f32_16x16x32_bf16 v[140:143], v[68:71], v[92:95], v[140:143]
    ds_read_b128 v[48:51], v13 offset:34816
    s_waitcnt lgkmcnt(10)
    v_mfma_f32_16x16x32_bf16 v[156:159], v[72:75], v[92:95], v[156:159]
    ds_read_b128 v[52:55], v13 offset:36864
    s_waitcnt lgkmcnt(9)
    v_mfma_f32_16x16x32_bf16 v[176:179], v[40:43], v[96:99], v[176:179]
    ds_read_b128 v[56:59], v13 offset:38912
    v_mfma_f32_16x16x32_bf16 v[112:115], v[60:63], v[96:99], v[112:115]
    ds_read_b64_tr_b16 v[80:81], v22 offset:49152
    v_mfma_f32_16x16x32_bf16 v[128:131], v[64:67], v[96:99], v[128:131]
    ds_read_b64_tr_b16 v[82:83], v22 offset:50176
    v_mfma_f32_16x16x32_bf16 v[144:147], v[68:71], v[96:99], v[144:147]
    ds_read_b64_tr_b16 v[84:85], v23 offset:49152
    v_mfma_f32_16x16x32_bf16 v[160:163], v[72:75], v[96:99], v[160:163]
    ds_read_b64_tr_b16 v[86:87], v23 offset:50176
    s_waitcnt lgkmcnt(12)
    v_mfma_f32_16x16x32_bf16 v[116:119], v[60:63], v[100:103], v[116:119]
    ds_read_b64_tr_b16 v[88:89], v24 offset:49152
    v_mfma_f32_16x16x32_bf16 v[132:135], v[64:67], v[100:103], v[132:135]
    ds_read_b64_tr_b16 v[90:91], v24 offset:50176
    v_mfma_f32_16x16x32_bf16 v[148:151], v[68:71], v[100:103], v[148:151]
    v_mfma_f32_16x16x32_bf16 v[164:167], v[72:75], v[100:103], v[164:167]
    s_waitcnt lgkmcnt(12)
    v_mfma_f32_16x16x32_bf16 v[120:123], v[60:63], v[104:107], v[120:123]
    v_mfma_f32_16x16x32_bf16 v[136:139], v[64:67], v[104:107], v[136:139]
    v_mfma_f32_16x16x32_bf16 v[152:155], v[68:71], v[104:107], v[152:155]
    v_mfma_f32_16x16x32_bf16 v[168:171], v[72:75], v[104:107], v[168:171]
    s_waitcnt lgkmcnt(10)
    v_mfma_f32_16x16x32_bf16 v[172:175], v[40:43], v[76:79], v[172:175]
    ds_read_b64_tr_b16 v[92:93], v21 offset:57344
    s_waitcnt lgkmcnt(10)
    v_mfma_f32_16x16x32_bf16 v[108:111], v[44:47], v[76:79], v[108:111]
    ds_read_b64_tr_b16 v[94:95], v21 offset:58368
    s_waitcnt lgkmcnt(10)
    v_mfma_f32_16x16x32_bf16 v[124:127], v[48:51], v[76:79], v[124:127]
    ds_read_b128 v[60:63], v14 offset:32768
    s_waitcnt lgkmcnt(10)
    v_mfma_f32_16x16x32_bf16 v[140:143], v[52:55], v[76:79], v[140:143]
    ds_read_b128 v[64:67], v14 offset:34816
    s_waitcnt lgkmcnt(10)
    v_mfma_f32_16x16x32_bf16 v[156:159], v[56:59], v[76:79], v[156:159]
    ds_read_b128 v[68:71], v14 offset:36864
    s_waitcnt lgkmcnt(9)
    v_mfma_f32_16x16x32_bf16 v[176:179], v[40:43], v[80:83], v[176:179]
    ds_read_b128 v[72:75], v14 offset:38912
    v_mfma_f32_16x16x32_bf16 v[112:115], v[44:47], v[80:83], v[112:115]
    ds_read_b64_tr_b16 v[96:97], v22 offset:57344
    v_mfma_f32_16x16x32_bf16 v[128:131], v[48:51], v[80:83], v[128:131]
    ds_read_b64_tr_b16 v[98:99], v22 offset:58368
    v_mfma_f32_16x16x32_bf16 v[144:147], v[52:55], v[80:83], v[144:147]
    ds_read_b64_tr_b16 v[100:101], v23 offset:57344
    v_mfma_f32_16x16x32_bf16 v[160:163], v[56:59], v[80:83], v[160:163]
    ds_read_b64_tr_b16 v[102:103], v23 offset:58368
    s_waitcnt lgkmcnt(12)
    v_mfma_f32_16x16x32_bf16 v[116:119], v[44:47], v[84:87], v[116:119]
    ds_read_b64_tr_b16 v[104:105], v24 offset:57344
    v_mfma_f32_16x16x32_bf16 v[132:135], v[48:51], v[84:87], v[132:135]
    ds_read_b64_tr_b16 v[106:107], v24 offset:58368
    v_mfma_f32_16x16x32_bf16 v[148:151], v[52:55], v[84:87], v[148:151]
    v_mfma_f32_16x16x32_bf16 v[164:167], v[56:59], v[84:87], v[164:167]
    s_waitcnt lgkmcnt(12)
    v_mfma_f32_16x16x32_bf16 v[120:123], v[44:47], v[88:91], v[120:123]
    v_mfma_f32_16x16x32_bf16 v[136:139], v[48:51], v[88:91], v[136:139]
    v_mfma_f32_16x16x32_bf16 v[152:155], v[52:55], v[88:91], v[152:155]
    v_mfma_f32_16x16x32_bf16 v[168:171], v[56:59], v[88:91], v[168:171]
    s_barrier
    s_waitcnt lgkmcnt(10)
    v_mfma_f32_16x16x32_bf16 v[172:175], v[40:43], v[92:95], v[172:175]
    ds_read_b64_tr_b16 v[76:77], v25 offset:16384
    s_waitcnt lgkmcnt(10)
    v_mfma_f32_16x16x32_bf16 v[108:111], v[60:63], v[92:95], v[108:111]
    ds_read_b64_tr_b16 v[78:79], v25 offset:17408
    s_waitcnt lgkmcnt(10)
    v_mfma_f32_16x16x32_bf16 v[124:127], v[64:67], v[92:95], v[124:127]
    ds_read_b128 v[44:47], v15 offset:0
    s_waitcnt lgkmcnt(10)
    v_mfma_f32_16x16x32_bf16 v[140:143], v[68:71], v[92:95], v[140:143]
    ds_read_b128 v[48:51], v15 offset:2048
    s_waitcnt lgkmcnt(10)
    v_mfma_f32_16x16x32_bf16 v[156:159], v[72:75], v[92:95], v[156:159]
    ds_read_b128 v[52:55], v15 offset:4096
    s_waitcnt lgkmcnt(9)
    v_mfma_f32_16x16x32_bf16 v[176:179], v[40:43], v[96:99], v[176:179]
    ds_read_b128 v[56:59], v15 offset:6144
    v_mfma_f32_16x16x32_bf16 v[112:115], v[60:63], v[96:99], v[112:115]
    ds_read_b64_tr_b16 v[80:81], v26 offset:16384
    v_mfma_f32_16x16x32_bf16 v[128:131], v[64:67], v[96:99], v[128:131]
    ds_read_b64_tr_b16 v[82:83], v26 offset:17408
    v_mfma_f32_16x16x32_bf16 v[144:147], v[68:71], v[96:99], v[144:147]
    ds_read_b64_tr_b16 v[84:85], v27 offset:16384
    v_mfma_f32_16x16x32_bf16 v[160:163], v[72:75], v[96:99], v[160:163]
    ds_read_b64_tr_b16 v[86:87], v27 offset:17408
    s_waitcnt lgkmcnt(12)
    v_mfma_f32_16x16x32_bf16 v[116:119], v[60:63], v[100:103], v[116:119]
    ds_read_b64_tr_b16 v[88:89], v28 offset:16384
    v_mfma_f32_16x16x32_bf16 v[132:135], v[64:67], v[100:103], v[132:135]
    ds_read_b64_tr_b16 v[90:91], v28 offset:17408
    v_mfma_f32_16x16x32_bf16 v[148:151], v[68:71], v[100:103], v[148:151]
    v_mfma_f32_16x16x32_bf16 v[164:167], v[72:75], v[100:103], v[164:167]
    s_waitcnt lgkmcnt(12)
    v_mfma_f32_16x16x32_bf16 v[120:123], v[60:63], v[104:107], v[120:123]
    v_mfma_f32_16x16x32_bf16 v[136:139], v[64:67], v[104:107], v[136:139]
    v_mfma_f32_16x16x32_bf16 v[152:155], v[68:71], v[104:107], v[152:155]
    v_mfma_f32_16x16x32_bf16 v[168:171], v[72:75], v[104:107], v[168:171]
    s_waitcnt lgkmcnt(10)
    v_mfma_f32_16x16x32_bf16 v[172:175], v[40:43], v[76:79], v[172:175]
    ds_read_b64_tr_b16 v[92:93], v25 offset:24576
    s_waitcnt lgkmcnt(10)
    v_mfma_f32_16x16x32_bf16 v[108:111], v[44:47], v[76:79], v[108:111]
    ds_read_b64_tr_b16 v[94:95], v25 offset:25600
    s_waitcnt lgkmcnt(10)
    v_mfma_f32_16x16x32_bf16 v[124:127], v[48:51], v[76:79], v[124:127]
    ds_read_b128 v[60:63], v16 offset:0
    s_waitcnt lgkmcnt(10)
    v_mfma_f32_16x16x32_bf16 v[140:143], v[52:55], v[76:79], v[140:143]
    ds_read_b128 v[64:67], v16 offset:2048
    s_waitcnt lgkmcnt(10)
    v_mfma_f32_16x16x32_bf16 v[156:159], v[56:59], v[76:79], v[156:159]
    ds_read_b128 v[68:71], v16 offset:4096
    s_waitcnt lgkmcnt(9)
    v_mfma_f32_16x16x32_bf16 v[176:179], v[40:43], v[80:83], v[176:179]
    ds_read_b128 v[72:75], v16 offset:6144
    v_mfma_f32_16x16x32_bf16 v[112:115], v[44:47], v[80:83], v[112:115]
    ds_read_b64_tr_b16 v[96:97], v26 offset:24576
    v_mfma_f32_16x16x32_bf16 v[128:131], v[48:51], v[80:83], v[128:131]
    ds_read_b64_tr_b16 v[98:99], v26 offset:25600
    v_mfma_f32_16x16x32_bf16 v[144:147], v[52:55], v[80:83], v[144:147]
    ds_read_b64_tr_b16 v[100:101], v27 offset:24576
    v_mfma_f32_16x16x32_bf16 v[160:163], v[56:59], v[80:83], v[160:163]
    ds_read_b64_tr_b16 v[102:103], v27 offset:25600
    s_waitcnt lgkmcnt(12)
    v_mfma_f32_16x16x32_bf16 v[116:119], v[44:47], v[84:87], v[116:119]
    ds_read_b64_tr_b16 v[104:105], v28 offset:24576
    v_mfma_f32_16x16x32_bf16 v[132:135], v[48:51], v[84:87], v[132:135]
    ds_read_b64_tr_b16 v[106:107], v28 offset:25600
    v_mfma_f32_16x16x32_bf16 v[148:151], v[52:55], v[84:87], v[148:151]
    v_mfma_f32_16x16x32_bf16 v[164:167], v[56:59], v[84:87], v[164:167]
    s_waitcnt lgkmcnt(12)
    v_mfma_f32_16x16x32_bf16 v[120:123], v[44:47], v[88:91], v[120:123]
    v_mfma_f32_16x16x32_bf16 v[136:139], v[48:51], v[88:91], v[136:139]
    v_mfma_f32_16x16x32_bf16 v[152:155], v[52:55], v[88:91], v[152:155]
    v_mfma_f32_16x16x32_bf16 v[168:171], v[56:59], v[88:91], v[168:171]
    s_cmp_lg_u32 s24, 3
    s_cbranch_scc1 L_q_o6
    s_waitcnt vmcnt(0)
    s_and_b32 s27, s2, 31
    s_lshl_b32 s27, s27, 2
    s_add_u32 s27, s27, 128
    v_mov_b32 v245, 1
    s_mov_b64 exec, 1
    buffer_atomic_add v245, v246, s[76:79], s27 offen sc1
    s_mov_b64 exec, -1
L_q_o6:
    s_barrier
    s_waitcnt lgkmcnt(10)
    v_mfma_f32_16x16x32_bf16 v[172:175], v[40:43], v[92:95], v[172:175]
    ds_read_b64_tr_b16 v[76:77], v17 offset:16384
    s_waitcnt lgkmcnt(10)
    v_mfma_f32_16x16x32_bf16 v[108:111], v[60:63], v[92:95], v[108:111]
    ds_read_b64_tr_b16 v[78:79], v17 offset:17408
    s_waitcnt lgkmcnt(10)
    v_mfma_f32_16x16x32_bf16 v[124:127], v[64:67], v[92:95], v[124:127]
    ds_read_b128 v[44:47], v11 offset:0
    s_waitcnt lgkmcnt(10)
    v_mfma_f32_16x16x32_bf16 v[140:143], v[68:71], v[92:95], v[140:143]
    ds_read_b128 v[48:51], v11 offset:2048
    s_waitcnt lgkmcnt(10)
    v_mfma_f32_16x16x32_bf16 v[156:159], v[72:75], v[92:95], v[156:159]
    ds_read_b128 v[52:55], v11 offset:4096
    s_waitcnt lgkmcnt(9)
    v_mfma_f32_16x16x32_bf16 v[176:179], v[40:43], v[96:99], v[176:179]
    ds_read_b128 v[56:59], v11 offset:6144
    v_mfma_f32_16x16x32_bf16 v[112:115], v[60:63], v[96:99], v[112:115]
    ds_read_b64_tr_b16 v[80:81], v18 offset:16384
    v_mfma_f32_16x16x32_bf16 v[128:131], v[64:67], v[96:99], v[128:131]
    ds_read_b64_tr_b16 v[82:83], v18 offset:17408
    v_mfma_f32_16x16x32_bf16 v[144:147], v[68:71], v[96:99], v[144:147]
    ds_read_b64_tr_b16 v[84:85], v19 offset:16384
    v_mfma_f32_16x16x32_bf16 v[160:163], v[72:75], v[96:99], v[160:163]
    ds_read_b64_tr_b16 v[86:87], v19 offset:17408
    s_waitcnt lgkmcnt(12)
    v_mfma_f32_16x16x32_bf16 v[116:119], v[60:63], v[100:103], v[116:119]
    ds_read_b64_tr_b16 v[88:89], v20 offset:16384
    v_mfma_f32_16x16x32_bf16 v[132:135], v[64:67], v[100:103], v[132:135]
    ds_read_b64_tr_b16 v[90:91], v20 offset:17408
    v_mfma_f32_16x16x32_bf16 v[148:151], v[68:71], v[100:103], v[148:151]
    v_mfma_f32_16x16x32_bf16 v[164:167], v[72:75], v[100:103], v[164:167]
    s_waitcnt lgkmcnt(12)
    v_mfma_f32_16x16x32_bf16 v[120:123], v[60:63], v[104:107], v[120:123]
    v_mfma_f32_16x16x32_bf16 v[136:139], v[64:67], v[104:107], v[136:139]
    v_mfma_f32_16x16x32_bf16 v[152:155], v[68:71], v[104:107], v[152:155]
    v_mfma_f32_16x16x32_bf16 v[168:171], v[72:75], v[104:107], v[168:171]
    s_waitcnt lgkmcnt(10)
    v_mfma_f32_16x16x32_bf16 v[172:175], v[40:43], v[76:79], v[172:175]
    ds_read_b64_tr_b16 v[92:93], v17 offset:24576
    s_waitcnt lgkmcnt(10)
    v_mfma_f32_16x16x32_bf16 v[108:111], v[44:47], v[76:79], v[108:111]
    ds_read_b64_tr_b16 v[94:95], v17 offset:25600
    s_waitcnt lgkmcnt(10)
    v_mfma_f32_16x16x32_bf16 v[124:127], v[48:51], v[76:79], v[124:127]
    ds_read_b128 v[60:63], v12 offset:0
    s_waitcnt lgkmcnt(10)
    v_mfma_f32_16x16x32_bf16 v[140:143], v[52:55], v[76:79], v[140:143]
    ds_read_b128 v[64:67], v12 offset:2048
    s_waitcnt lgkmcnt(10)
    v_mfma_f32_16x16x32_bf16 v[156:159], v[56:59], v[76:79], v[156:159]
    ds_read_b128 v[68:71], v12 offset:4096
    s_waitcnt lgkmcnt(9)
    v_mfma_f32_16x16x32_bf16 v[176:179], v[40:43], v[80:83], v[176:179]
    ds_read_b128 v[72:75], v12 offset:6144
    v_mfma_f32_16x16x32_bf16 v[112:115], v[44:47], v[80:83], v[112:115]
    ds_read_b64_tr_b16 v[96:97], v18 offset:24576
    v_mfma_f32_16x16x32_bf16 v[128:131], v[48:51], v[80:83], v[128:131]
    ds_read_b64_tr_b16 v[98:99], v18 offset:25600
    v_mfma_f32_16x16x32_bf16 v[144:147], v[52:55], v[80:83], v[144:147]
    ds_read_b64_tr_b16 v[100:101], v19 offset:24576
    v_mfma_f32_16x16x32_bf16 v[160:163], v[56:59], v[80:83], v[160:163]
    ds_read_b64_tr_b16 v[102:103], v19 offset:25600
    s_waitcnt lgkmcnt(12)
    v_mfma_f32_16x16x32_bf16 v[116:119], v[44:47], v[84:87], v[116:119]
    ds_read_b64_tr_b16 v[104:105], v20 offset:24576
    v_mfma_f32_16x16x32_bf16 v[132:135], v[48:51], v[84:87], v[132:135]
    ds_read_b64_tr_b16 v[106:107], v20 offset:25600
    v_mfma_f32_16x16x32_bf16 v[148:151], v[52:55], v[84:87], v[148:151]
    v_mfma_f32_16x16x32_bf16 v[164:167], v[56:59], v[84:87], v[164:167]
    s_waitcnt lgkmcnt(12)
    v_mfma_f32_16x16x32_bf16 v[120:123], v[44:47], v[88:91], v[120:123]
    v_mfma_f32_16x16x32_bf16 v[136:139], v[48:51], v[88:91], v[136:139]
    v_mfma_f32_16x16x32_bf16 v[152:155], v[52:55], v[88:91], v[152:155]
    v_mfma_f32_16x16x32_bf16 v[168:171], v[56:59], v[88:91], v[168:171]
    s_barrier
    s_waitcnt lgkmcnt(10)
    v_mfma_f32_16x16x32_bf16 v[172:175], v[40:43], v[92:95], v[172:175]
    ds_read_b64_tr_b16 v[76:77], v17 offset:49152
    s_waitcnt lgkmcnt(10)
    v_mfma_f32_16x16x32_bf16 v[108:111], v[60:63], v[92:95], v[108:111]
    ds_read_b64_tr_b16 v[78:79], v17 offset:50176
    s_waitcnt lgkmcnt(10)
    v_mfma_f32_16x16x32_bf16 v[124:127], v[64:67], v[92:95], v[124:127]
    ds_read_b128 v[44:47], v11 offset:32768
    s_waitcnt lgkmcnt(10)
    v_mfma_f32_16x16x32_bf16 v[140:143], v[68:71], v[92:95], v[140:143]
    ds_read_b128 v[48:51], v11 offset:34816
    s_waitcnt lgkmcnt(10)
    v_mfma_f32_16x16x32_bf16 v[156:159], v[72:75], v[92:95], v[156:159]
    ds_read_b128 v[52:55], v11 offset:36864
    s_waitcnt lgkmcnt(9)
    v_mfma_f32_16x16x32_bf16 v[176:179], v[40:43], v[96:99], v[176:179]
    ds_read_b128 v[56:59], v11 offset:38912
    v_mfma_f32_16x16x32_bf16 v[112:115], v[60:63], v[96:99], v[112:115]
    ds_read_b64_tr_b16 v[80:81], v18 offset:49152
    v_mfma_f32_16x16x32_bf16 v[128:131], v[64:67], v[96:99], v[128:131]
    ds_read_b64_tr_b16 v[82:83], v18 offset:50176
    v_mfma_f32_16x16x32_bf16 v[144:147], v[68:71], v[96:99], v[144:147]
    ds_read_b64_tr_b16 v[84:85], v19 offset:49152
    v_mfma_f32_16x16x32_bf16 v[160:163], v[72:75], v[96:99], v[160:163]
    ds_read_b64_tr_b16 v[86:87], v19 offset:50176
    s_waitcnt lgkmcnt(12)
    v_mfma_f32_16x16x32_bf16 v[116:119], v[60:63], v[100:103], v[116:119]
    ds_read_b64_tr_b16 v[88:89], v20 offset:49152
    v_mfma_f32_16x16x32_bf16 v[132:135], v[64:67], v[100:103], v[132:135]
    ds_read_b64_tr_b16 v[90:91], v20 offset:50176
    v_mfma_f32_16x16x32_bf16 v[148:151], v[68:71], v[100:103], v[148:151]
    v_mfma_f32_16x16x32_bf16 v[164:167], v[72:75], v[100:103], v[164:167]
    s_waitcnt lgkmcnt(12)
    v_mfma_f32_16x16x32_bf16 v[120:123], v[60:63], v[104:107], v[120:123]
    v_mfma_f32_16x16x32_bf16 v[136:139], v[64:67], v[104:107], v[136:139]
    v_mfma_f32_16x16x32_bf16 v[152:155], v[68:71], v[104:107], v[152:155]
    v_mfma_f32_16x16x32_bf16 v[168:171], v[72:75], v[104:107], v[168:171]
    s_waitcnt lgkmcnt(10)
    v_mfma_f32_16x16x32_bf16 v[172:175], v[40:43], v[76:79], v[172:175]
    ds_read_b64_tr_b16 v[92:93], v17 offset:57344
    s_waitcnt lgkmcnt(10)
    v_mfma_f32_16x16x32_bf16 v[108:111], v[44:47], v[76:79], v[108:111]
    ds_read_b64_tr_b16 v[94:95], v17 offset:58368
    s_waitcnt lgkmcnt(10)
    v_mfma_f32_16x16x32_bf16 v[124:127], v[48:51], v[76:79], v[124:127]
    ds_read_b128 v[60:63], v12 offset:32768
    s_waitcnt lgkmcnt(10)
    v_mfma_f32_16x16x32_bf16 v[140:143], v[52:55], v[76:79], v[140:143]
    ds_read_b128 v[64:67], v12 offset:34816
    s_waitcnt lgkmcnt(10)
    v_mfma_f32_16x16x32_bf16 v[156:159], v[56:59], v[76:79], v[156:159]
    ds_read_b128 v[68:71], v12 offset:36864
    s_waitcnt lgkmcnt(9)
    v_mfma_f32_16x16x32_bf16 v[176:179], v[40:43], v[80:83], v[176:179]
    ds_read_b128 v[72:75], v12 offset:38912
    v_mfma_f32_16x16x32_bf16 v[112:115], v[44:47], v[80:83], v[112:115]
    ds_read_b64_tr_b16 v[96:97], v18 offset:57344
    v_mfma_f32_16x16x32_bf16 v[128:131], v[48:51], v[80:83], v[128:131]
    ds_read_b64_tr_b16 v[98:99], v18 offset:58368
    v_mfma_f32_16x16x32_bf16 v[144:147], v[52:55], v[80:83], v[144:147]
    ds_read_b64_tr_b16 v[100:101], v19 offset:57344
    v_mfma_f32_16x16x32_bf16 v[160:163], v[56:59], v[80:83], v[160:163]
    ds_read_b64_tr_b16 v[102:103], v19 offset:58368
    s_waitcnt lgkmcnt(12)
    v_mfma_f32_16x16x32_bf16 v[116:119], v[44:47], v[84:87], v[116:119]
    ds_read_b64_tr_b16 v[104:105], v20 offset:57344
    v_mfma_f32_16x16x32_bf16 v[132:135], v[48:51], v[84:87], v[132:135]
    ds_read_b64_tr_b16 v[106:107], v20 offset:58368
    v_mfma_f32_16x16x32_bf16 v[148:151], v[52:55], v[84:87], v[148:151]
    v_mfma_f32_16x16x32_bf16 v[164:167], v[56:59], v[84:87], v[164:167]
    s_waitcnt lgkmcnt(12)
    v_mfma_f32_16x16x32_bf16 v[120:123], v[44:47], v[88:91], v[120:123]
    v_mfma_f32_16x16x32_bf16 v[136:139], v[48:51], v[88:91], v[136:139]
    v_mfma_f32_16x16x32_bf16 v[152:155], v[52:55], v[88:91], v[152:155]
    v_mfma_f32_16x16x32_bf16 v[168:171], v[56:59], v[88:91], v[168:171]
    s_barrier
    s_waitcnt lgkmcnt(10)
    v_mfma_f32_16x16x32_bf16 v[172:175], v[40:43], v[92:95], v[172:175]
    ds_read_b64_tr_b16 v[76:77], v21 offset:16384
    s_waitcnt lgkmcnt(10)
    v_mfma_f32_16x16x32_bf16 v[108:111], v[60:63], v[92:95], v[108:111]
    ds_read_b64_tr_b16 v[78:79], v21 offset:17408
    s_waitcnt lgkmcnt(10)
    v_mfma_f32_16x16x32_bf16 v[124:127], v[64:67], v[92:95], v[124:127]
    ds_read_b128 v[44:47], v13 offset:0
    s_waitcnt lgkmcnt(10)
    v_mfma_f32_16x16x32_bf16 v[140:143], v[68:71], v[92:95], v[140:143]
    ds_read_b128 v[48:51], v13 offset:2048
    s_waitcnt lgkmcnt(10)
    v_mfma_f32_16x16x32_bf16 v[156:159], v[72:75], v[92:95], v[156:159]
    ds_read_b128 v[52:55], v13 offset:4096
    s_waitcnt lgkmcnt(9)
    v_mfma_f32_16x16x32_bf16 v[176:179], v[40:43], v[96:99], v[176:179]
    ds_read_b128 v[56:59], v13 offset:6144
    v_mfma_f32_16x16x32_bf16 v[112:115], v[60:63], v[96:99], v[112:115]
    ds_read_b64_tr_b16 v[80:81], v22 offset:16384
    v_mfma_f32_16x16x32_bf16 v[128:131], v[64:67], v[96:99], v[128:131]
    ds_read_b64_tr_b16 v[82:83], v22 offset:17408
    v_mfma_f32_16x16x32_bf16 v[144:147], v[68:71], v[96:99], v[144:147]
    ds_read_b64_tr_b16 v[84:85], v23 offset:16384
    v_mfma_f32_16x16x32_bf16 v[160:163], v[72:75], v[96:99], v[160:163]
    ds_read_b64_tr_b16 v[86:87], v23 offset:17408
    s_waitcnt lgkmcnt(12)
    v_mfma_f32_16x16x32_bf16 v[116:119], v[60:63], v[100:103], v[116:119]
    ds_read_b64_tr_b16 v[88:89], v24 offset:16384
    v_mfma_f32_16x16x32_bf16 v[132:135], v[64:67], v[100:103], v[132:135]
    ds_read_b64_tr_b16 v[90:91], v24 offset:17408
    v_mfma_f32_16x16x32_bf16 v[148:151], v[68:71], v[100:103], v[148:151]
    v_mfma_f32_16x16x32_bf16 v[164:167], v[72:75], v[100:103], v[164:167]
    s_waitcnt lgkmcnt(12)
    v_mfma_f32_16x16x32_bf16 v[120:123], v[60:63], v[104:107], v[120:123]
    v_mfma_f32_16x16x32_bf16 v[136:139], v[64:67], v[104:107], v[136:139]
    v_mfma_f32_16x16x32_bf16 v[152:155], v[68:71], v[104:107], v[152:155]
    v_mfma_f32_16x16x32_bf16 v[168:171], v[72:75], v[104:107], v[168:171]
    s_cmp_lg_u32 s24, 2
    s_cbranch_scc1 L_q_o7
    s_lshl_b32 s27, s25, 2
    buffer_load_dword v247, v246, s[76:79], s27 offen sc1
L_q_o7:
    s_waitcnt lgkmcnt(10)
    v_mfma_f32_16x16x32_bf16 v[172:175], v[40:43], v[76:79], v[172:175]
    ds_read_b64_tr_b16 v[92:93], v21 offset:24576
    s_waitcnt lgkmcnt(10)
    v_mfma_f32_16x16x32_bf16 v[108:111], v[44:47], v[76:79], v[108:111]
    ds_read_b64_tr_b16 v[94:95], v21 offset:25600
    s_waitcnt lgkmcnt(10)
    v_mfma_f32_16x16x32_bf16 v[124:127], v[48:51], v[76:79], v[124:127]
    ds_read_b128 v[60:63], v14 offset:0
    s_waitcnt lgkmcnt(10)
    v_mfma_f32_16x16x32_bf16 v[140:143], v[52:55], v[76:79], v[140:143]
    ds_read_b128 v[64:67], v14 offset:2048
    s_waitcnt lgkmcnt(10)
    v_mfma_f32_16x16x32_bf16 v[156:159], v[56:59], v[76:79], v[156:159]
    ds_read_b128 v[68:71], v14 offset:4096
    s_waitcnt lgkmcnt(9)
    v_mfma_f32_16x16x32_bf16 v[176:179], v[40:43], v[80:83], v[176:179]
    ds_read_b128 v[72:75], v14 offset:6144
    v_mfma_f32_16x16x32_bf16 v[112:115], v[44:47], v[80:83], v[112:115]
    ds_read_b64_tr_b16 v[96:97], v22 offset:24576
    v_mfma_f32_16x16x32_bf16 v[128:131], v[48:51], v[80:83], v[128:131]
    ds_read_b64_tr_b16 v[98:99], v22 offset:25600
    v_mfma_f32_16x16x32_bf16 v[144:147], v[52:55], v[80:83], v[144:147]
    ds_read_b64_tr_b16 v[100:101], v23 offset:24576
    v_mfma_f32_16x16x32_bf16 v[160:163], v[56:59], v[80:83], v[160:163]
    ds_read_b64_tr_b16 v[102:103], v23 offset:25600
    s_waitcnt lgkmcnt(12)
    v_mfma_f32_16x16x32_bf16 v[116:119], v[44:47], v[84:87], v[116:119]
    ds_read_b64_tr_b16 v[104:105], v24 offset:24576
    v_mfma_f32_16x16x32_bf16 v[132:135], v[48:51], v[84:87], v[132:135]
    ds_read_b64_tr_b16 v[106:107], v24 offset:25600
    v_mfma_f32_16x16x32_bf16 v[148:151], v[52:55], v[84:87], v[148:151]
    v_mfma_f32_16x16x32_bf16 v[164:167], v[56:59], v[84:87], v[164:167]
    s_waitcnt lgkmcnt(12)
    v_mfma_f32_16x16x32_bf16 v[120:123], v[44:47], v[88:91], v[120:123]
    v_mfma_f32_16x16x32_bf16 v[136:139], v[48:51], v[88:91], v[136:139]
    v_mfma_f32_16x16x32_bf16 v[152:155], v[52:55], v[88:91], v[152:155]
    v_mfma_f32_16x16x32_bf16 v[168:171], v[56:59], v[88:91], v[168:171]
    s_barrier
    s_waitcnt lgkmcnt(10)
    v_mfma_f32_16x16x32_bf16 v[172:175], v[40:43], v[92:95], v[172:175]
    ds_read_b64_tr_b16 v[76:77], v21 offset:49152
    s_waitcnt lgkmcnt(10)
    v_mfma_f32_16x16x32_bf16 v[108:111], v[60:63], v[92:95], v[108:111]
    ds_read_b64_tr_b16 v[78:79], v21 offset:50176
    s_waitcnt lgkmcnt(10)
    v_mfma_f32_16x16x32_bf16 v[124:127], v[64:67], v[92:95], v[124:127]
    ds_read_b128 v[44:47], v13 offset:32768
    s_waitcnt lgkmcnt(10)
    v_mfma_f32_16x16x32_bf16 v[140:143], v[68:71], v[92:95], v[140:143]
    ds_read_b128 v[48:51], v13 offset:34816
    s_waitcnt lgkmcnt(10)
    v_mfma_f32_16x16x32_bf16 v[156:159], v[72:75], v[92:95], v[156:159]
    ds_read_b128 v[52:55], v13 offset:36864
    s_waitcnt lgkmcnt(9)
    v_mfma_f32_16x16x32_bf16 v[176:179], v[40:43], v[96:99], v[176:179]
    ds_read_b128 v[56:59], v13 offset:38912
    v_mfma_f32_16x16x32_bf16 v[112:115], v[60:63], v[96:99], v[112:115]
    ds_read_b64_tr_b16 v[80:81], v22 offset:49152
    v_mfma_f32_16x16x32_bf16 v[128:131], v[64:67], v[96:99], v[128:131]
    ds_read_b64_tr_b16 v[82:83], v22 offset:50176
    v_mfma_f32_16x16x32_bf16 v[144:147], v[68:71], v[96:99], v[144:147]
    ds_read_b64_tr_b16 v[84:85], v23 offset:49152
    v_mfma_f32_16x16x32_bf16 v[160:163], v[72:75], v[96:99], v[160:163]
    ds_read_b64_tr_b16 v[86:87], v23 offset:50176
    s_waitcnt lgkmcnt(12)
    v_mfma_f32_16x16x32_bf16 v[116:119], v[60:63], v[100:103], v[116:119]
    ds_read_b64_tr_b16 v[88:89], v24 offset:49152
    v_mfma_f32_16x16x32_bf16 v[132:135], v[64:67], v[100:103], v[132:135]
    ds_read_b64_tr_b16 v[90:91], v24 offset:50176
    v_mfma_f32_16x16x32_bf16 v[148:151], v[68:71], v[100:103], v[148:151]
    v_mfma_f32_16x16x32_bf16 v[164:167], v[72:75], v[100:103], v[164:167]
    s_waitcnt lgkmcnt(12)
    v_mfma_f32_16x16x32_bf16 v[120:123], v[60:63], v[104:107], v[120:123]
    v_mfma_f32_16x16x32_bf16 v[136:139], v[64:67], v[104:107], v[136:139]
    v_mfma_f32_16x16x32_bf16 v[152:155], v[68:71], v[104:107], v[152:155]
    v_mfma_f32_16x16x32_bf16 v[168:171], v[72:75], v[104:107], v[168:171]
    s_waitcnt lgkmcnt(10)
    v_mfma_f32_16x16x32_bf16 v[172:175], v[40:43], v[76:79], v[172:175]
    ds_read_b64_tr_b16 v[92:93], v21 offset:57344
    s_waitcnt lgkmcnt(10)
    v_mfma_f32_16x16x32_bf16 v[108:111], v[44:47], v[76:79], v[108:111]
    ds_read_b64_tr_b16 v[94:95], v21 offset:58368
    s_waitcnt lgkmcnt(10)
    v_mfma_f32_16x16x32_bf16 v[124:127], v[48:51], v[76:79], v[124:127]
    ds_read_b128 v[60:63], v14 offset:32768
    s_waitcnt lgkmcnt(10)
    v_mfma_f32_16x16x32_bf16 v[140:143], v[52:55], v[76:79], v[140:143]
    ds_read_b128 v[64:67], v14 offset:34816
    s_waitcnt lgkmcnt(10)
    v_mfma_f32_16x16x32_bf16 v[156:159], v[56:59], v[76:79], v[156:159]
    ds_read_b128 v[68:71], v14 offset:36864
    s_waitcnt lgkmcnt(9)
    v_mfma_f32_16x16x32_bf16 v[176:179], v[40:43], v[80:83], v[176:179]
    ds_read_b128 v[72:75], v14 offset:38912
    v_mfma_f32_16x16x32_bf16 v[112:115], v[44:47], v[80:83], v[112:115]
    ds_read_b64_tr_b16 v[96:97], v22 offset:57344
    v_mfma_f32_16x16x32_bf16 v[128:131], v[48:51], v[80:83], v[128:131]
    ds_read_b64_tr_b16 v[98:99], v22 offset:58368
    v_mfma_f32_16x16x32_bf16 v[144:147], v[52:55], v[80:83], v[144:147]
    ds_read_b64_tr_b16 v[100:101], v23 offset:57344
    v_mfma_f32_16x16x32_bf16 v[160:163], v[56:59], v[80:83], v[160:163]
    ds_read_b64_tr_b16 v[102:103], v23 offset:58368
    s_waitcnt lgkmcnt(12)
    v_mfma_f32_16x16x32_bf16 v[116:119], v[44:47], v[84:87], v[116:119]
    ds_read_b64_tr_b16 v[104:105], v24 offset:57344
    v_mfma_f32_16x16x32_bf16 v[132:135], v[48:51], v[84:87], v[132:135]
    ds_read_b64_tr_b16 v[106:107], v24 offset:58368
    v_mfma_f32_16x16x32_bf16 v[148:151], v[52:55], v[84:87], v[148:151]
    v_mfma_f32_16x16x32_bf16 v[164:167], v[56:59], v[84:87], v[164:167]
    s_waitcnt lgkmcnt(12)
    v_mfma_f32_16x16x32_bf16 v[120:123], v[44:47], v[88:91], v[120:123]
    v_mfma_f32_16x16x32_bf16 v[136:139], v[48:51], v[88:91], v[136:139]
    v_mfma_f32_16x16x32_bf16 v[152:155], v[52:55], v[88:91], v[152:155]
    v_mfma_f32_16x16x32_bf16 v[168:171], v[56:59], v[88:91], v[168:171]
    s_cmp_lg_u32 s24, 2
    s_cbranch_scc1 L_q_o8
    s_mov_b32 s28, 0
    s_waitcnt vmcnt(0)
L_qkv_xp1:
    v_cmp_ne_u32 vcc, 1, v247
    s_nop 4
    s_cbranch_vccz L_qkv_xo1
    s_sleep 8
    buffer_load_dword v247, v246, s[76:79], s27 offen sc1
    s_add_u32 s28, s28, 1
    s_cmp_lt_u32 s28, 100000
    s_waitcnt vmcnt(0)
    s_cbranch_scc1 L_qkv_xp1
L_qkv_xo1:
L_q_o8:
    s_barrier
    buffer_load_dwordx4 v[180:183], v31, s[20:23], s50 offen offset:0 sc1
    buffer_load_dwordx4 v[184:187], v31, s[20:23], s50 offen offset:16 sc1
    buffer_load_dwordx4 v[188:191], v31, s[20:23], s50 offen offset:128 sc1
    buffer_load_dwordx4 v[192:195], v31, s[20:23], s50 offen offset:144 sc1
    buffer_load_dwordx4 v[196:199], v31, s[20:23], s50 offen offset:256 sc1
    buffer_load_dwordx4 v[200:203], v31, s[20:23], s50 offen offset:272 sc1
    buffer_load_dwordx4 v[204:207], v31, s[20:23], s50 offen offset:384 sc1
    buffer_load_dwordx4 v[208:211], v31, s[20:23], s50 offen offset:400 sc1
    s_waitcnt lgkmcnt(10)
    v_mfma_f32_16x16x32_bf16 v[172:175], v[40:43], v[92:95], v[172:175]
    ds_read_b64_tr_b16 v[76:77], v25 offset:16384
    s_waitcnt lgkmcnt(10)
    v_mfma_f32_16x16x32_bf16 v[108:111], v[60:63], v[92:95], v[108:111]
    ds_read_b64_tr_b16 v[78:79], v25 offset:17408
    s_waitcnt lgkmcnt(10)
    v_mfma_f32_16x16x32_bf16 v[124:127], v[64:67], v[92:95], v[124:127]
    ds_read_b128 v[44:47], v15 offset:0
    s_waitcnt lgkmcnt(10)
    v_mfma_f32_16x16x32_bf16 v[140:143], v[68:71], v[92:95], v[140:143]
    ds_read_b128 v[48:51], v15 offset:2048
    s_waitcnt lgkmcnt(10)
    v_mfma_f32_16x16x32_bf16 v[156:159], v[72:75], v[92:95], v[156:159]
    ds_read_b128 v[52:55], v15 offset:4096
    s_waitcnt lgkmcnt(9)
    v_mfma_f32_16x16x32_bf16 v[176:179], v[40:43], v[96:99], v[176:179]
    ds_read_b128 v[56:59], v15 offset:6144
    v_mfma_f32_16x16x32_bf16 v[112:115], v[60:63], v[96:99], v[112:115]
    ds_read_b64_tr_b16 v[80:81], v26 offset:16384
    v_mfma_f32_16x16x32_bf16 v[128:131], v[64:67], v[96:99], v[128:131]
    ds_read_b64_tr_b16 v[82:83], v26 offset:17408
    v_mfma_f32_16x16x32_bf16 v[144:147], v[68:71], v[96:99], v[144:147]
    ds_read_b64_tr_b16 v[84:85], v27 offset:16384
    v_mfma_f32_16x16x32_bf16 v[160:163], v[72:75], v[96:99], v[160:163]
    ds_read_b64_tr_b16 v[86:87], v27 offset:17408
    s_waitcnt lgkmcnt(12)
    v_mfma_f32_16x16x32_bf16 v[116:119], v[60:63], v[100:103], v[116:119]
    ds_read_b64_tr_b16 v[88:89], v28 offset:16384
    v_mfma_f32_16x16x32_bf16 v[132:135], v[64:67], v[100:103], v[132:135]
    ds_read_b64_tr_b16 v[90:91], v28 offset:17408
    v_mfma_f32_16x16x32_bf16 v[148:151], v[68:71], v[100:103], v[148:151]
    v_mfma_f32_16x16x32_bf16 v[164:167], v[72:75], v[100:103], v[164:167]
    s_waitcnt lgkmcnt(12)
    v_mfma_f32_16x16x32_bf16 v[120:123], v[60:63], v[104:107], v[120:123]
    v_mfma_f32_16x16x32_bf16 v[136:139], v[64:67], v[104:107], v[136:139]
    v_mfma_f32_16x16x32_bf16 v[152:155], v[68:71], v[104:107], v[152:155]
    v_mfma_f32_16x16x32_bf16 v[168:171], v[72:75], v[104:107], v[168:171]
    s_waitcnt lgkmcnt(10)
    v_mfma_f32_16x16x32_bf16 v[172:175], v[40:43], v[76:79], v[172:175]
    ds_read_b64_tr_b16 v[92:93], v25 offset:24576
    s_waitcnt lgkmcnt(10)
    v_mfma_f32_16x16x32_bf16 v[108:111], v[44:47], v[76:79], v[108:111]
    ds_read_b64_tr_b16 v[94:95], v25 offset:25600
    s_waitcnt lgkmcnt(10)
    v_mfma_f32_16x16x32_bf16 v[124:127], v[48:51], v[76:79], v[124:127]
    ds_read_b128 v[60:63], v16 offset:0
    s_waitcnt lgkmcnt(10)
    v_mfma_f32_16x16x32_bf16 v[140:143], v[52:55], v[76:79], v[140:143]
    ds_read_b128 v[64:67], v16 offset:2048
    s_waitcnt lgkmcnt(10)
    v_mfma_f32_16x16x32_bf16 v[156:159], v[56:59], v[76:79], v[156:159]
    ds_read_b128 v[68:71], v16 offset:4096
    s_waitcnt lgkmcnt(9)
    v_mfma_f32_16x16x32_bf16 v[176:179], v[40:43], v[80:83], v[176:179]
    ds_read_b128 v[72:75], v16 offset:6144
    v_mfma_f32_16x16x32_bf16 v[112:115], v[44:47], v[80:83], v[112:115]
    ds_read_b64_tr_b16 v[96:97], v26 offset:24576
    v_mfma_f32_16x16x32_bf16 v[128:131], v[48:51], v[80:83], v[128:131]
    ds_read_b64_tr_b16 v[98:99], v26 offset:25600
    v_mfma_f32_16x16x32_bf16 v[144:147], v[52:55], v[80:83], v[144:147]
    ds_read_b64_tr_b16 v[100:101], v27 offset:24576
    v_mfma_f32_16x16x32_bf16 v[160:163], v[56:59], v[80:83], v[160:163]
    ds_read_b64_tr_b16 v[102:103], v27 offset:25600
    s_waitcnt lgkmcnt(12)
    v_mfma_f32_16x16x32_bf16 v[116:119], v[44:47], v[84:87], v[116:119]
    ds_read_b64_tr_b16 v[104:105], v28 offset:24576
    v_mfma_f32_16x16x32_bf16 v[132:135], v[48:51], v[84:87], v[132:135]
    ds_read_b64_tr_b16 v[106:107], v28 offset:25600
    v_mfma_f32_16x16x32_bf16 v[148:151], v[52:55], v[84:87], v[148:151]
    v_mfma_f32_16x16x32_bf16 v[164:167], v[56:59], v[84:87], v[164:167]
    s_waitcnt lgkmcnt(12)
    v_mfma_f32_16x16x32_bf16 v[120:123], v[44:47], v[88:91], v[120:123]
    v_mfma_f32_16x16x32_bf16 v[136:139], v[48:51], v[88:91], v[136:139]
    v_mfma_f32_16x16x32_bf16 v[152:155], v[52:55], v[88:91], v[152:155]
    v_mfma_f32_16x16x32_bf16 v[168:171], v[56:59], v[88:91], v[168:171]
    s_waitcnt lgkmcnt(10)
    v_mfma_f32_16x16x32_bf16 v[172:175], v[40:43], v[92:95], v[172:175]
    s_waitcnt lgkmcnt(9)
    v_mfma_f32_16x16x32_bf16 v[108:111], v[60:63], v[92:95], v[108:111]
    s_waitcnt lgkmcnt(8)
    v_mfma_f32_16x16x32_bf16 v[124:127], v[64:67], v[92:95], v[124:127]
    s_waitcnt lgkmcnt(7)
    v_mfma_f32_16x16x32_bf16 v[140:143], v[68:71], v[92:95], v[140:143]
    s_waitcnt lgkmcnt(6)
    v_mfma_f32_16x16x32_bf16 v[156:159], v[72:75], v[92:95], v[156:159]
    s_waitcnt lgkmcnt(4)
    v_mfma_f32_16x16x32_bf16 v[176:179], v[40:43], v[96:99], v[176:179]
    v_mfma_f32_16x16x32_bf16 v[112:115], v[60:63], v[96:99], v[112:115]
    v_mfma_f32_16x16x32_bf16 v[128:131], v[64:67], v[96:99], v[128:131]
    v_mfma_f32_16x16x32_bf16 v[144:147], v[68:71], v[96:99], v[144:147]
    v_mfma_f32_16x16x32_bf16 v[160:163], v[72:75], v[96:99], v[160:163]
    s_waitcnt lgkmcnt(2)
    v_mfma_f32_16x16x32_bf16 v[116:119], v[60:63], v[100:103], v[116:119]
    v_mfma_f32_16x16x32_bf16 v[132:135], v[64:67], v[100:103], v[132:135]
    v_mfma_f32_16x16x32_bf16 v[148:151], v[68:71], v[100:103], v[148:151]
    v_mfma_f32_16x16x32_bf16 v[164:167], v[72:75], v[100:103], v[164:167]
    s_mov_b64 exec, 0xffff
    ds_write_b32 v36, v172
    ds_write_b32 v36, v176 offset:64
    s_mov_b64 exec, -1
    s_waitcnt lgkmcnt(2)
    v_mfma_f32_16x16x32_bf16 v[120:123], v[60:63], v[104:107], v[120:123]
    v_mfma_f32_16x16x32_bf16 v[136:139], v[64:67], v[104:107], v[136:139]
    v_mfma_f32_16x16x32_bf16 v[152:155], v[68:71], v[104:107], v[152:155]
    v_mfma_f32_16x16x32_bf16 v[168:171], v[72:75], v[104:107], v[168:171]
    s_waitcnt lgkmcnt(0)
    s_barrier
    ds_read_b32 v212, v32
    ds_read_b32 v213, v33
    ds_read_b32 v214, v34
    ds_read_b32 v215, v35
    s_waitcnt vmcnt(0)
    s_waitcnt lgkmcnt(3)
    v_mul_f32 v108, v180, v108
    v_mul_f32 v109, v182, v109
    v_mul_f32 v110, v184, v110
    v_mul_f32 v111, v186, v111
    v_mul_f32 v124, v188, v124
    v_mul_f32 v125, v190, v125
    v_mul_f32 v126, v192, v126
    v_mul_f32 v127, v194, v127
    v_mul_f32 v140, v196, v140
    v_mul_f32 v141, v198, v141
    v_mul_f32 v142, v200, v142
    v_mul_f32 v143, v202, v143
    v_mul_f32 v156, v204, v156
    v_mul_f32 v157, v206, v157
    v_mul_f32 v158, v208, v158
    v_mul_f32 v159, v210, v159
    v_fmac_f32 v108, v181, v212
    v_fmac_f32 v109, v183, v212
    v_fmac_f32 v110, v185, v212
    v_fmac_f32 v111, v187, v212
    v_fmac_f32 v124, v189, v212
    v_fmac_f32 v125, v191, v212
    v_fmac_f32 v126, v193, v212
    v_fmac_f32 v127, v195, v212
    v_fmac_f32 v140, v197, v212
    v_fmac_f32 v141, v199, v212
    v_fmac_f32 v142, v201, v212
    v_fmac_f32 v143, v203, v212
    v_fmac_f32 v156, v205, v212
    v_fmac_f32 v157, v207, v212
    v_fmac_f32 v158, v209, v212
    v_fmac_f32 v159, v211, v212
    v_cvt_pk_bf16_f32 v44, v108, v109
    v_cvt_pk_bf16_f32 v45, v110, v111
    v_cvt_pk_bf16_f32 v46, v124, v125
    v_cvt_pk_bf16_f32 v47, v126, v127
    v_cvt_pk_bf16_f32 v48, v140, v141
    v_cvt_pk_bf16_f32 v49, v142, v143
    v_cvt_pk_bf16_f32 v50, v156, v157
    v_cvt_pk_bf16_f32 v51, v158, v159
    buffer_store_dwordx4 v[44:47], v29, s[20:23], s44 offen sc1
    buffer_store_dwordx4 v[48:51], v30, s[20:23], s44 offen sc1
    s_waitcnt lgkmcnt(2)
    v_mul_f32 v112, v180, v112
    v_mul_f32 v113, v182, v113
    v_mul_f32 v114, v184, v114
    v_mul_f32 v115, v186, v115
    v_mul_f32 v128, v188, v128
    v_mul_f32 v129, v190, v129
    v_mul_f32 v130, v192, v130
    v_mul_f32 v131, v194, v131
    v_mul_f32 v144, v196, v144
    v_mul_f32 v145, v198, v145
    v_mul_f32 v146, v200, v146
    v_mul_f32 v147, v202, v147
    v_mul_f32 v160, v204, v160
    v_mul_f32 v161, v206, v161
    v_mul_f32 v162, v208, v162
    v_mul_f32 v163, v210, v163
    v_fmac_f32 v112, v181, v213
    v_fmac_f32 v113, v183, v213
    v_fmac_f32 v114, v185, v213
    v_fmac_f32 v115, v187, v213
    v_fmac_f32 v128, v189, v213
    v_fmac_f32 v129, v191, v213
    v_fmac_f32 v130, v193, v213
    v_fmac_f32 v131, v195, v213
    v_fmac_f32 v144, v197, v213
    v_fmac_f32 v145, v199, v213
    v_fmac_f32 v146, v201, v213
    v_fmac_f32 v147, v203, v213
    v_fmac_f32 v160, v205, v213
    v_fmac_f32 v161, v207, v213
    v_fmac_f32 v162, v209, v213
    v_fmac_f32 v163, v211, v213
    v_cvt_pk_bf16_f32 v52, v112, v113
    v_cvt_pk_bf16_f32 v53, v114, v115
    v_cvt_pk_bf16_f32 v54, v128, v129
    v_cvt_pk_bf16_f32 v55, v130, v131
    v_cvt_pk_bf16_f32 v56, v144, v145
    v_cvt_pk_bf16_f32 v57, v146, v147
    v_cvt_pk_bf16_f32 v58, v160, v161
    v_cvt_pk_bf16_f32 v59, v162, v163
    buffer_store_dwordx4 v[52:55], v29, s[20:23], s45 offen sc1
    buffer_store_dwordx4 v[56:59], v30, s[20:23], s45 offen sc1
    s_waitcnt lgkmcnt(1)
    v_mul_f32 v116, v180, v116
    v_mul_f32 v117, v182, v117
    v_mul_f32 v118, v184, v118
    v_mul_f32 v119, v186, v119
    v_mul_f32 v132, v188, v132
    v_mul_f32 v133, v190, v133
    v_mul_f32 v134, v192, v134
    v_mul_f32 v135, v194, v135
    v_mul_f32 v148, v196, v148
    v_mul_f32 v149, v198, v149
    v_mul_f32 v150, v200, v150
    v_mul_f32 v151, v202, v151
    v_mul_f32 v164, v204, v164
    v_mul_f32 v165, v206, v165
    v_mul_f32 v166, v208, v166
    v_mul_f32 v167, v210, v167
    v_fmac_f32 v116, v181, v214
    v_fmac_f32 v117, v183, v214
    v_fmac_f32 v118, v185, v214
    v_fmac_f32 v119, v187, v214
    v_fmac_f32 v132, v189, v214
    v_fmac_f32 v133, v191, v214
    v_fmac_f32 v134, v193, v214
    v_fmac_f32 v135, v195, v214
    v_fmac_f32 v148, v197, v214
    v_fmac_f32 v149, v199, v214
    v_fmac_f32 v150, v201, v214
    v_fmac_f32 v151, v203, v214
    v_fmac_f32 v164, v205, v214
    v_fmac_f32 v165, v207, v214
    v_fmac_f32 v166, v209, v214
    v_fmac_f32 v167, v211, v214
    v_cvt_pk_bf16_f32 v76, v116, v117
    v_cvt_pk_bf16_f32 v77, v118, v119
    v_cvt_pk_bf16_f32 v78, v132, v133
    v_cvt_pk_bf16_f32 v79, v134, v135
    v_cvt_pk_bf16_f32 v80, v148, v149
    v_cvt_pk_bf16_f32 v81, v150, v151
    v_cvt_pk_bf16_f32 v82, v164, v165
    v_cvt_pk_bf16_f32 v83, v166, v167
    buffer_store_dwordx4 v[76:79], v29, s[20:23], s46 offen sc1
    buffer_store_dwordx4 v[80:83], v30, s[20:23], s46 offen sc1
    s_waitcnt lgkmcnt(0)
    v_mul_f32 v120, v180, v120
    v_mul_f32 v121, v182, v121
    v_mul_f32 v122, v184, v122
    v_mul_f32 v123, v186, v123
    v_mul_f32 v136, v188, v136
    v_mul_f32 v137, v190, v137
    v_mul_f32 v138, v192, v138
    v_mul_f32 v139, v194, v139
    v_mul_f32 v152, v196, v152
    v_mul_f32 v153, v198, v153
    v_mul_f32 v154, v200, v154
    v_mul_f32 v155, v202, v155
    v_mul_f32 v168, v204, v168
    v_mul_f32 v169, v206, v169
    v_mul_f32 v170, v208, v170
    v_mul_f32 v171, v210, v171
    v_fmac_f32 v120, v181, v215
    v_fmac_f32 v121, v183, v215
    v_fmac_f32 v122, v185, v215
    v_fmac_f32 v123, v187, v215
    v_fmac_f32 v136, v189, v215
    v_fmac_f32 v137, v191, v215
    v_fmac_f32 v138, v193, v215
    v_fmac_f32 v139, v195, v215
    v_fmac_f32 v152, v197, v215
    v_fmac_f32 v153, v199, v215
    v_fmac_f32 v154, v201, v215
    v_fmac_f32 v155, v203, v215
    v_fmac_f32 v168, v205, v215
    v_fmac_f32 v169, v207, v215
    v_fmac_f32 v170, v209, v215
    v_fmac_f32 v171, v211, v215
    v_cvt_pk_bf16_f32 v84, v120, v121
    v_cvt_pk_bf16_f32 v85, v122, v123
    v_cvt_pk_bf16_f32 v86, v136, v137
    v_cvt_pk_bf16_f32 v87, v138, v139
    v_cvt_pk_bf16_f32 v88, v152, v153
    v_cvt_pk_bf16_f32 v89, v154, v155
    v_cvt_pk_bf16_f32 v90, v168, v169
    v_cvt_pk_bf16_f32 v91, v170, v171
    buffer_store_dwordx4 v[84:87], v29, s[20:23], s47 offen sc1
    buffer_store_dwordx4 v[88:91], v30, s[20:23], s47 offen sc1
L_qkv_fin:
L_qkv_join:
    s_lshl_b32 s27, s2, 10
    s_add_u32 s27, s27, 32505856
    v_mov_b32 v241, 1
    s_cmp_lt_u32 s24, 6
    s_cbranch_scc1 L_qkv_nchk
    v_and_b32 v242, 31, v1
    v_lshlrev_b32 v242, 2, v242
    s_mov_b32 s28, 0
    s_cmp_lt_u32 s26, 15
    s_cbranch_scc1 L_qkv_cq
L_qkv_cp:
    s_sleep 85
L_qkv_cq:
    buffer_load_dword v243, v242, s[76:79], 0 offen offset:128 sc1
    s_add_u32 s28, s28, 1
    s_cmp_gt_u32 s28, 20000
    s_waitcnt vmcnt(0)
    s_cbranch_scc1 L_qkv_nchk
    v_cmp_gt_u32 vcc, 8, v243
    s_nop 4
    s_cbranch_vccnz L_qkv_cp
L_qkv_nchk:
    s_waitcnt vmcnt(0) lgkmcnt(0)
    s_barrier
    s_cmp_lg_u32 s24, 5
    s_cbranch_scc1 L_q_o9
    s_mov_b64 exec, 1
    buffer_store_dword v241, v246, s[20:23], s27 offen sc1
    s_mov_b64 exec, -1
L_q_o9:
    s_load_dwordx2 s[4:5], s[0:1], 80
    s_load_dwordx2 s[6:7], s[0:1], 0
    s_load_dwordx4 s[28:31], s[0:1], 56
    s_load_dwordx2 s[52:53], s[0:1], 16
    s_load_dwordx2 s[54:55], s[0:1], 32
    s_load_dwordx2 s[56:57], s[0:1], 48
    v_and_b32 v1, 63, v0
    v_lshrrev_b32 v2, 6, v0
    s_and_b32 s50, s2, 7
    v_readfirstlane_b32 s32, v2
    s_lshr_b32 s51, s2, 3
    s_lshl_b32 s33, s50, 2
    s_and_b32 s35, s51, 3
    s_add_u32 s33, s33, s35
    s_lshr_b32 s34, s51, 2
    s_lshr_b32 s40, s32, 2
    s_and_b32 s41, s32, 3
    v_lshlrev_b32 v5, 4, v1
    v_and_b32 v2, 31, v1
    v_lshlrev_b32 v25, 3, v2
    v_mov_b32 v44, 0
    v_mov_b32 v45, 0
    v_mov_b32 v46, 0
    v_mov_b32 v47, 0
    s_mul_i32 s35, s33, 1280
    s_lshl_b32 s39, s34, 3
    s_lshl_b32 s43, s41, 1
    s_add_u32 s43, s43, s39
    s_add_u32 s43, s43, s40
    s_mul_i32 s39, s43, 40960
    s_add_u32 s47, s35, s39
    s_xor_b32 s39, s43, 1
    s_mul_i32 s39, s39, 40960
    s_add_u32 s46, s35, s39
    s_add_u32 s36, s35, 3145728
    s_mul_i32 s37, s32, 2560
    s_mul_i32 s42, s32, 40960
    s_add_u32 s42, s42, 3145728
    v_lshlrev_b32 v10, 3, v1
    v_add_u32 v32, s35, v5
    s_mul_i32 s39, s33, 320
    s_add_u32 s3, s39, 5767168
    v_add_u32 v3, -16, v1
    v_mul_u32_u24 v4, 3277, v3
    v_lshrrev_b32 v4, 16, v4
    v_mul_u32_u24 v4, 9920, v4
    v_lshl_add_u32 v4, v3, 4, v4
    v_add_u32 v4, s39, v4
    v_add_u32 v33, 2620416, v4
    v_add_u32 v3, 48, v1
    v_mul_u32_u24 v4, 3277, v3
    v_lshrrev_b32 v4, 16, v4
    v_mul_u32_u24 v4, 9920, v4
    v_lshl_add_u32 v4, v3, 4, v4
    v_add_u32 v4, s39, v4
    v_add_u32 v34, 2619392, v4
    v_cmp_gt_u32 vcc, 16, v1
    s_nop 1
    v_cndmask_b32 v33, v33, v32, vcc
    s_mov_b32 s44, 0x000fffff
    s_mov_b32 s45, 0x000fffff
    s_waitcnt lgkmcnt(0)
    s_mov_b32 s8, s4
    s_mov_b32 s9, s5
    s_mov_b32 s10, 35651584
    s_mov_b32 s11, 0x00020000
    v_mov_b32 v6, 0
    v_mov_b32 v7, 1
    v_lshrrev_b32 v8, 4, v1
    v_and_b32 v9, 15, v1
    s_lshl_b32 s100, s2, 10
    s_add_u32 s100, s100, 32505856
    s_mul_i32 s35, s33, 20
    s_lshr_b32 s39, s35, 7
    s_add_u32 s35, s35, 19
    s_lshr_b32 s35, s35, 7
    s_sub_u32 s35, s35, s39
    v_and_b32 v72, 1, v8
    v_mul_u32_u24 v72, s35, v72
    v_add_u32 v72, s39, v72
    v_lshrrev_b32 v73, 1, v8
    v_mul_u32_u24 v73, 5, v73
    v_add_u32 v73, 5, v73
    v_mov_b32 v74, v9
    s_cmp_eq_u32 s32, 6
    s_cbranch_scc1 L_f_s0kv
    v_mov_b32 v73, 0
    v_and_b32 v74, 1, v1
    s_lshl_b32 s35, s34, 1
    v_add_u32 v74, s35, v74
L_f_s0kv:
    v_add_u32 v72, v72, v73
    v_and_b32 v73, 7, v72
    v_lshlrev_b32 v73, 5, v73
    v_lshrrev_b32 v72, 3, v72
    v_add_u32 v72, v72, v73
    v_and_b32 v73, 3, v74
    v_lshl_add_u32 v72, v73, 3, v72
    v_lshrrev_b32 v73, 2, v74
    v_lshl_add_u32 v72, v73, 1, v72
    v_lshlrev_b32 v72, 10, v72
    s_mov_b32 s68, 32505856
    s_lshl_b32 s35, s32, 15
    v_lshl_add_u32 v35, v2, 10, s35
    s_lshl_b32 s60, s32, 8
    s_add_u32 s60, s60, s2
    s_mov_b32 s92, s52
    s_mov_b32 s93, s53
    s_mov_b32 s94, 819200
    s_mov_b32 s95, 0x00020000
    s_cmp_lt_u32 s32, 5
    s_cbranch_scc1 L_t_go
    s_mov_b32 s94, 0
    s_mov_b32 s26, 0
    s_mov_b32 s27, 0
    s_mov_b32 s38, 0
    s_mul_i32 s35, s2, 7168
    s_add_u32 s35, s35, 28366848
    s_cmp_lt_u32 s60, 1300
    s_cselect_b32 s35, s35, 0x7f000000
    s_add_u32 s96, s35, 0
    s_add_u32 s97, s35, 1024
    s_add_u32 s98, s35, 2048
    s_add_u32 s99, s35, 3072
    s_mov_b32 s25, 0x7f000000
    v_mov_b32 v188, 0
    s_branch L_t_fin
L_t_go:
    s_movk_i32 s58, 1280
    s_mov_b32 s59, 5
    s_mov_b32 s61, 20
    s_mov_b32 s62, 25165824
    s_movk_i32 s63, 6554
    s_mov_b32 s64, 10
    s_movk_i32 s26, 13108
    s_cmp_lt_u32 s60, 200
    s_cbranch_scc1 L_t_sel
    s_sub_u32 s60, s60, 200
    s_mov_b32 s92, s56
    s_mov_b32 s93, s57
    s_mov_b32 s94, 2211840
    s_mov_b32 s61, 54
    s_mov_b32 s62, 29360128
    s_cmp_lt_u32 s60, 540
    s_cbranch_scc1 L_t_sel
    s_sub_u32 s60, s60, 540
    s_mov_b32 s92, s54
    s_mov_b32 s93, s55
    s_movk_i32 s58, 3456
    s_mov_b32 s59, 7
    s_mov_b32 s61, 20
    s_mov_b32 s62, 26214400
    s_movk_i32 s63, 2428
    s_mov_b32 s64, 27
    s_movk_i32 s26, 9363
L_t_sel:
    s_mul_i32 s63, s63, s60
    s_lshr_b32 s63, s63, 16
    s_mul_i32 s64, s64, s63
    s_sub_u32 s64, s60, s64
    s_mul_i32 s25, s63, 6912
    s_lshl_b32 s35, s64, 8
    s_add_u32 s25, s25, s35
    s_add_u32 s25, s25, 16252928
    s_cmp_lg_u32 s59, 7
    s_cselect_b32 s25, 0x7f000000, s25
    s_mov_b32 s65, s63
    s_cmp_lg_u32 s61, 54
    s_cbranch_scc1 L_t_pos
    s_mul_i32 s35, s63, 9363
    s_lshr_b32 s35, s35, 16
    s_mul_i32 s39, s35, 7
    s_sub_u32 s39, s63, s39
    s_lshl_b32 s65, s35, 2
    s_add_u32 s65, s65, s39
    s_cmp_le_u32 s39, 1
    s_cbranch_scc1 L_t_pos
    s_sub_u32 s65, s65, 2
    s_lshl_b32 s60, s35, 1
    s_add_u32 s60, s60, 30
    s_cmp_eq_u32 s39, 2
    s_cselect_b32 s65, s60, s65
    s_add_u32 s60, s60, 1
    s_cmp_eq_u32 s39, 6
    s_cselect_b32 s65, s60, s65
    s_add_u32 s60, s35, 46
    s_cmp_eq_u32 s39, 3
    s_cselect_b32 s65, s60, s65
    s_cmp_eq_u32 s63, 53
    s_cselect_b32 s65, 45, s65
L_t_pos:
    s_lshl_b32 s35, s64, 2
    s_mul_i32 s39, s35, s26
    s_lshr_b32 s39, s39, 16
    s_mul_i32 s60, s39, s59
    s_sub_u32 s35, s35, s60
    s_and_b32 s60, s39, 1
    s_sub_u32 s35, s35, s60
    s_cselect_b32 s60, s59, 0
    s_add_u32 s35, s35, s60
    s_mul_i32 s39, s39, s61
    s_add_u32 s39, s39, s65
    s_mul_i32 s39, s39, s59
    s_add_u32 s39, s39, s35
    s_lshl_b32 s39, s39, 10
    s_add_u32 s96, s39, s62
    s_lshl_b32 s35, s64, 2
    s_add_u32 s35, s35, 1
    s_mul_i32 s39, s35, s26
    s_lshr_b32 s39, s39, 16
    s_mul_i32 s60, s39, s59
    s_sub_u32 s35, s35, s60
    s_and_b32 s60, s39, 1
    s_sub_u32 s35, s35, s60
    s_cselect_b32 s60, s59, 0
    s_add_u32 s35, s35, s60
    s_mul_i32 s39, s39, s61
    s_add_u32 s39, s39, s65
    s_mul_i32 s39, s39, s59
    s_add_u32 s39, s39, s35
    s_lshl_b32 s39, s39, 10
    s_add_u32 s97, s39, s62
    s_lshl_b32 s35, s64, 2
    s_add_u32 s35, s35, 2
    s_mul_i32 s39, s35, s26
    s_lshr_b32 s39, s39, 16
    s_mul_i32 s60, s39, s59
    s_sub_u32 s35, s35, s60
    s_and_b32 s60, s39, 1
    s_sub_u32 s35, s35, s60
    s_cselect_b32 s60, s59, 0
    s_add_u32 s35, s35, s60
    s_mul_i32 s39, s39, s61
    s_add_u32 s39, s39, s65
    s_mul_i32 s39, s39, s59
    s_add_u32 s39, s39, s35
    s_lshl_b32 s39, s39, 10
    s_add_u32 s98, s39, s62
    s_lshl_b32 s35, s64, 2
    s_add_u32 s35, s35, 3
    s_mul_i32 s39, s35, s26
    s_lshr_b32 s39, s39, 16
    s_mul_i32 s60, s39, s59
    s_sub_u32 s35, s35, s60
    s_and_b32 s60, s39, 1
    s_sub_u32 s35, s35, s60
    s_cselect_b32 s60, s59, 0
    s_add_u32 s35, s35, s60
    s_mul_i32 s39, s39, s61
    s_add_u32 s39, s39, s65
    s_mul_i32 s39, s39, s59
    s_add_u32 s39, s39, s35
    s_lshl_b32 s39, s39, 10
    s_add_u32 s99, s39, s62
    s_mov_b32 s27, 16
    s_mov_b32 s38, 8
    s_mov_b32 s66, 4
    s_lshl_b32 s26, s63, 5
    s_cmp_lg_u32 s62, 25165824
    s_cbranch_scc1 L_t_map
    s_mov_b32 s27, 8
    s_mov_b32 s38, 20
    s_mul_i32 s26, s63, 40
    s_cmp_lt_u32 s63, 16
    s_cbranch_scc1 L_t_map
    s_mov_b32 s27, 20
    s_movk_i32 s38, 80
    s_mov_b32 s66, 40
    s_mul_i32 s26, s63, 160
    s_sub_u32 s26, s26, 2544
L_t_map:
    s_mul_i32 s26, s26, s58
    s_lshl_b32 s35, s64, 7
    s_add_u32 s26, s26, s35
    s_mul_i32 s27, s27, s58
    s_mul_i32 s38, s38, s58
    v_lshrrev_b32 v3, 5, v1
    v_mul_lo_u32 v3, v3, s66
    v_bfe_u32 v4, v1, 3, 2
    v_add_u32 v3, v3, v4
    v_mul_lo_u32 v3, v3, s58
    v_and_b32 v4, 7, v1
    v_lshl_add_u32 v188, v4, 4, v3
    s_sub_u32 s27, s27, s38
L_t_fin:
    s_lshl_b32 s60, s32, 12
    s_add_u32 s60, s60, 131072
    v_lshrrev_b32 v3, 2, v1
    v_lshlrev_b32 v3, 7, v3
    v_and_b32 v4, 3, v1
    v_lshl_add_u32 v3, v4, 3, v3
    v_add_u32 v189, s60, v3
    s_cmp_lt_u32 s32, 6
    s_cbranch_scc1 L_f_s0done
    s_mov_b32 s69, 0
    s_branch L_f_q1
L_f_p1:
    s_sleep 4
L_f_q1:
    buffer_load_dword v74, v72, s[8:11], s68 offen sc1
    s_add_u32 s69, s69, 1
    s_cmp_gt_u32 s69, 100000
    s_waitcnt vmcnt(0)
    s_cbranch_scc1 L_f_x1
    v_cmp_ne_u32 vcc, 1, v74
    s_nop 4
    s_cbranch_vccnz L_f_p1
L_f_x1:
L_f_s0done:
    s_barrier
    s_and_b32 s35, s43, 7
    s_mul_i32 s35, s35, 1280
    s_add_u32 m0, s35, 65536
    s_xor_b32 s39, s43, 1
    buffer_load_dwordx4 v5, s[8:11], s47 offen sc1 lds
    s_mov_b64 exec, 0xffff
    buffer_load_dwordx4 v5, s[8:11], s47 offen offset:1024 sc1 lds
    s_mov_b64 exec, -1
    s_and_b32 s39, s39, 7
    s_mul_i32 s39, s39, 1280
    s_add_u32 s39, s39, 65536
    v_add_u32 v88, s39, v10
    s_add_u32 s35, s35, 65536
    v_add_u32 v89, s35, v10
    s_add_u32 m0, s37, 0
    s_nop 0
    buffer_load_dwordx4 v32, s[8:11], s42 offen sc1 lds
    buffer_load_dwordx4 v33, s[8:11], s42 offen offset:1024 sc1 lds
    s_mov_b32 exec_hi, 0
    buffer_load_dwordx4 v34, s[8:11], s42 offen offset:2048 sc1 lds
    s_mov_b32 exec_hi, -1
    s_add_u32 s42, s42, 327680
    s_mul_i32 s35, s40, 2560
    v_add_u32 v22, s35, v10
    v_add_u32 v23, s35, v25
    v_add_u32 v23, 1024, v23
    v_lshrrev_b32 v4, 5, v1
    v_mul_u32_u24 v24, 320, v4
    v_lshl_add_u32 v24, v2, 4, v24
    v_add_u32 v24, s35, v24
    v_add_u32 v24, 1280, v24
    v_mov_b32 v56, 0x3f803f80
    v_mov_b32 v60, 0x3f803f80
    v_mov_b32 v57, 0x3f803f80
    v_mov_b32 v61, 0x3f803f80
    v_mov_b32 v58, 0x3f803f80
    v_mov_b32 v62, 0x3f803f80
    v_mov_b32 v59, 0x3f803f80
    v_mov_b32 v63, 0x3f803f80
    s_mov_b32 exec_lo, 0xeef00000
    s_mov_b32 exec_hi, 0xeef00000
    v_mov_b32 v56, 0
    v_mov_b32 v60, 0
    v_mov_b32 v57, 0
    v_mov_b32 v61, 0
    v_mov_b32 v58, 0
    v_mov_b32 v62, 0
    v_mov_b32 v59, 0
    v_mov_b32 v63, 0
    s_mov_b64 exec, -1
    v_mov_b32 v52, 0x3f80
    v_mov_b32 v53, 0
    s_mov_b32 s12, s6
    s_mov_b32 s13, s7
    s_mov_b32 s14, 2621440
    s_mov_b32 s15, 0x00020000
    s_mov_b32 s16, s28
    s_mov_b32 s17, s29
    s_mov_b32 s18, 1280
    s_mov_b32 s19, 0x00020000
    s_mov_b32 s20, s30
    s_mov_b32 s21, s31
    s_mov_b32 s22, 2621440
    s_mov_b32 s23, 0x00020000
    s_mov_b32 s56, s33
    s_mov_b32 s57, s34
    s_lshl_b32 s58, s50, 1
    s_and_b32 s35, s51, 1
    s_add_u32 s58, s58, s35
    s_lshr_b32 s59, s51, 1
    s_lshl_b32 s61, s56, 2
    s_add_u32 s61, s61, s41
    s_mul_i32 s52, s57, 102400
    s_add_u32 s52, s52, 25165824
    s_lshl_b32 s53, s32, 11
    s_mul_i32 s35, s59, 143360
    s_add_u32 s35, s35, 26214400
    s_mul_i32 s49, s41, 14336
    s_add_u32 s48, s49, s35
    s_mul_i32 s91, s41, 10240
    s_movk_i32 s89, 1024
    s_cmp_eq_u32 s40, 0
    s_cbranch_scc1 L_f_sbc
    s_mul_i32 s91, s41, 11264
    s_add_u32 s91, s91, 40960
    s_mul_i32 s48, s57, 276480
    s_lshl_b32 s39, s41, 10
    s_add_u32 s48, s48, s39
    s_add_u32 s48, s48, 29564928
    s_movk_i32 s89, 4096
L_f_sbc:
    s_add_u32 s90, s91, s35
    s_add_u32 s90, s90, 57344
    s_add_u32 s91, s91, 61440
    s_mul_i32 s54, s57, 276480
    s_and_b32 s35, s51, 3
    s_mul_i32 s35, s35, 19456
    s_add_u32 s54, s54, s35
    s_mul_i32 s35, s32, 1280
    s_add_u32 s54, s54, s35
    s_add_u32 s54, s54, 29487104
    v_min_u32 v26, 9, v1
    v_lshlrev_b32 v26, 7, v26
    v_mul_u32_u24 v30, 1280, v9
    v_lshl_add_u32 v30, v8, 3, v30
    s_mul_i32 s55, s61, 20480
    s_mul_i32 s35, s57, 160
    s_add_u32 s55, s55, s35
    s_and_b32 s68, s57, 1
    s_and_b32 s69, s59, 1
    s_lshl_b32 s35, s68, 5
    s_add_u32 s66, s55, s35
    s_lshl_b32 s35, s68, 7
    s_sub_u32 s67, s55, s35
    s_add_u32 s67, s67, 128
    v_lshlrev_b32 v31, 3, v8
    s_mul_i32 s88, s57, 160
    s_sub_u32 s35, s66, s55
    s_add_u32 s101, s88, s35
    s_sub_u32 s35, s67, s55
    s_add_u32 s88, s88, s35
    v_and_b32 v2, 31, v1
    v_lshrrev_b32 v4, 5, v1
    v_lshrrev_b32 v3, 4, v2
    v_mul_u32_u24 v3, 20480, v3
    v_lshl_add_u32 v29, v9, 3, v3
    v_lshl_add_u32 v28, v9, 4, v3
    v_lshl_add_u32 v28, v4, 8, v28
    s_mul_i32 s35, s43, 40960
    s_add_u32 s35, s35, 9437184
    s_lshl_b32 s62, s33, 9
    s_add_u32 s62, s62, s35
    s_lshr_b32 s63, s33, 3
    s_lshl_b32 s63, s63, 10
    s_add_u32 s63, s63, s35
    s_and_b32 s39, s33, 1
    s_lshl_b32 s39, s39, 9
    s_add_u32 s63, s63, s39
    s_bfe_u32 s39, s33, 0x20001
    s_lshl_b32 s39, s39, 7
    s_add_u32 s63, s63, s39
    s_add_u32 s63, s63, 16384
    s_mul_i32 s35, s40, 40960
    s_mul_i32 s39, s41, 3328
    s_add_u32 s64, s35, s39
    s_sub_u32 s35, 40960, s35
    s_add_u32 s65, s35, s39
    v_add_u32 v4, 1024, v25
    s_waitcnt vmcnt(0)
    s_barrier
    ds_read2st64_b64 v[48:51], v10 offset0:0 offset1:1
    ds_read2st64_b64 v[36:39], v88 offset0:0 offset1:1
    ds_read2st64_b64 v[40:43], v89 offset0:0 offset1:1
    s_mov_b32 exec_hi, 0
    ds_read_b64 v[44:45], v88 offset:1024
    ds_read_b64 v[46:47], v89 offset:1024
    ds_read_b64 v[52:53], v4
    s_mov_b32 exec_hi, -1
    s_add_u32 m0, s37, 20480
    s_nop 0
    buffer_load_dwordx4 v32, s[8:11], s42 offen sc1 lds
    buffer_load_dwordx4 v33, s[8:11], s42 offen offset:1024 sc1 lds
    s_mov_b32 exec_hi, 0
    buffer_load_dwordx4 v34, s[8:11], s42 offen offset:2048 sc1 lds
    s_mov_b32 exec_hi, -1
    s_add_u32 s42, s42, 327680
    s_waitcnt lgkmcnt(0)
    v_mfma_f32_32x32x8_bf16 v[72:87], v[52:53], v[44:45], 0
    v_mfma_f32_32x32x16_bf16 v[72:87], v[48:51], v[36:39], v[72:87]
    v_mfma_f32_32x32x8_bf16 v[88:103], v[52:53], v[46:47], 0
    v_mfma_f32_32x32x16_bf16 v[88:103], v[48:51], v[40:43], v[88:103]
    s_mov_b32 exec_hi, 0
    ds_read_b64 v[52:53], v23 offset:0
    s_mov_b32 exec_hi, -1
    ds_read2st64_b64 v[48:51], v22 offset0:0 offset1:1
    s_mov_b64 exec, s[44:45]
    ds_read_b128 v[56:59], v24 offset:0
    s_mov_b64 exec, -1
    s_nop 2
    v_max3_f32 v2, v72, v73, v74
    v_max3_f32 v2, v2, v75, v76
    v_max3_f32 v2, v2, v77, v78
    v_max3_f32 v2, v2, v79, v80
    v_max3_f32 v2, v2, v81, v82
    v_max3_f32 v2, v2, v83, v84
    v_max3_f32 v2, v2, v85, v86
    v_max_f32 v2, v2, v87
    v_max3_f32 v3, v88, v89, v90
    v_max3_f32 v3, v3, v91, v92
    v_max3_f32 v3, v3, v93, v94
    v_max3_f32 v3, v3, v95, v96
    v_max3_f32 v3, v3, v97, v98
    v_max3_f32 v3, v3, v99, v100
    v_max3_f32 v3, v3, v101, v102
    v_max_f32 v3, v3, v103
    s_nop 1
    v_permlane32_swap_b32 v2, v3
    v_max_f32 v2, v2, v3
    v_cvt_pk_bf16_f32 v2, -v2, 0
    v_mov_b32 v3, v2
    s_nop 1
    v_permlane32_swap_b32 v2, v3
    s_mov_b32 exec_lo, 0
    v_mov_b32 v44, v2
    v_mov_b32 v46, v3
    s_mov_b32 exec_lo, -1
    s_waitcnt lgkmcnt(0)
    v_mfma_f32_32x32x8_bf16 v[72:87], v[52:53], v[44:45], 0
    v_mfma_f32_32x32x16_bf16 v[72:87], v[48:51], v[36:39], v[72:87]
    s_setprio 2
    v_mfma_f32_32x32x8_bf16 v[88:103], v[52:53], v[46:47], 0
    s_mov_b32 exec_hi, 0
    ds_read_b64 v[52:53], v23 offset:5120
    s_mov_b32 exec_hi, -1
    s_nop 6
    v_exp_f32 v72, v72
    v_exp_f32 v73, v73
    v_exp_f32 v74, v74
    v_exp_f32 v75, v75
    v_exp_f32 v80, v80
    s_mov_b64 exec, s[44:45]
    ds_read_b128 v[60:63], v24 offset:640
    s_mov_b64 exec, -1
    v_exp_f32 v81, v81
    v_exp_f32 v82, v82
    v_exp_f32 v83, v83
    v_cvt_pk_bf16_f32 v64, v72, v73
    v_cvt_pk_bf16_f32 v65, v74, v75
    v_cvt_pk_bf16_f32 v66, v80, v81
    v_cvt_pk_bf16_f32 v67, v82, v83
    v_mfma_f32_32x32x16_bf16 v[88:103], v[48:51], v[40:43], v[88:103]
    ds_read2st64_b64 v[48:51], v22 offset0:10 offset1:11
    v_exp_f32 v76, v76
    v_exp_f32 v77, v77
    v_exp_f32 v78, v78
    v_exp_f32 v79, v79
    v_exp_f32 v84, v84
    s_waitcnt lgkmcnt(3)
    v_mfma_f32_32x32x16_bf16 v[104:119], v[56:59], v[64:67], 0
    v_exp_f32 v85, v85
    v_exp_f32 v86, v86
    v_exp_f32 v87, v87
    v_cvt_pk_bf16_f32 v68, v76, v77
    v_cvt_pk_bf16_f32 v69, v78, v79
    v_cvt_pk_bf16_f32 v70, v84, v85
    v_cvt_pk_bf16_f32 v71, v86, v87
    s_waitcnt lgkmcnt(2)
    v_mfma_f32_32x32x8_bf16 v[72:87], v[52:53], v[44:45], 0
    s_add_u32 m0, s60, 0
    s_nop 0
    buffer_load_dwordx4 v188, s[92:95], s26 offen lds
    s_add_u32 s26, s26, s38
    v_exp_f32 v88, v88
    v_exp_f32 v89, v89
    v_exp_f32 v90, v90
    v_exp_f32 v91, v91
    v_exp_f32 v96, v96
    s_waitcnt lgkmcnt(1)
    v_mfma_f32_32x32x16_bf16 v[104:119], v[60:63], v[68:71], v[104:119]
    s_add_u32 m0, s60, 1024
    s_nop 0
    buffer_load_dwordx4 v188, s[92:95], s26 offen lds
    s_add_u32 s26, s26, s27
    v_exp_f32 v97, v97
    v_exp_f32 v98, v98
    v_exp_f32 v99, v99
    v_cvt_pk_bf16_f32 v64, v88, v89
    v_cvt_pk_bf16_f32 v65, v90, v91
    v_cvt_pk_bf16_f32 v66, v96, v97
    v_cvt_pk_bf16_f32 v67, v98, v99
    s_waitcnt lgkmcnt(0)
    v_mfma_f32_32x32x16_bf16 v[72:87], v[48:51], v[36:39], v[72:87]
    v_exp_f32 v92, v92
    v_exp_f32 v93, v93
    v_exp_f32 v94, v94
    v_exp_f32 v95, v95
    v_exp_f32 v100, v100
    v_mfma_f32_32x32x16_bf16 v[120:135], v[56:59], v[64:67], 0
    s_mov_b64 exec, s[44:45]
    ds_read_b128 v[56:59], v24 offset:5120
    s_mov_b64 exec, -1
    v_exp_f32 v101, v101
    v_exp_f32 v102, v102
    v_exp_f32 v103, v103
    v_cvt_pk_bf16_f32 v68, v92, v93
    v_cvt_pk_bf16_f32 v69, v94, v95
    v_cvt_pk_bf16_f32 v70, v100, v101
    v_cvt_pk_bf16_f32 v71, v102, v103
    s_setprio 1
    v_mfma_f32_32x32x8_bf16 v[88:103], v[52:53], v[46:47], 0
    s_mov_b32 exec_hi, 0
    ds_read_b64 v[52:53], v23 offset:10240
    s_mov_b32 exec_hi, -1
    v_exp_f32 v72, v72
    v_exp_f32 v73, v73
    v_exp_f32 v74, v74
    v_exp_f32 v75, v75
    v_exp_f32 v80, v80
    v_mfma_f32_32x32x16_bf16 v[120:135], v[60:63], v[68:71], v[120:135]
    s_mov_b64 exec, s[44:45]
    ds_read_b128 v[60:63], v24 offset:5760
    s_mov_b64 exec, -1
    v_exp_f32 v81, v81
    v_exp_f32 v82, v82
    v_exp_f32 v83, v83
    v_cvt_pk_bf16_f32 v64, v72, v73
    v_cvt_pk_bf16_f32 v65, v74, v75
    v_cvt_pk_bf16_f32 v66, v80, v81
    v_cvt_pk_bf16_f32 v67, v82, v83
    v_mfma_f32_32x32x16_bf16 v[88:103], v[48:51], v[40:43], v[88:103]
    ds_read2st64_b64 v[48:51], v22 offset0:20 offset1:21
    v_exp_f32 v76, v76
    v_exp_f32 v77, v77
    v_exp_f32 v78, v78
    v_exp_f32 v79, v79
    v_exp_f32 v84, v84
    s_waitcnt lgkmcnt(3)
    v_mfma_f32_32x32x16_bf16 v[104:119], v[56:59], v[64:67], v[104:119]
    v_exp_f32 v85, v85
    v_exp_f32 v86, v86
    v_exp_f32 v87, v87
    v_cvt_pk_bf16_f32 v68, v76, v77
    v_cvt_pk_bf16_f32 v69, v78, v79
    v_cvt_pk_bf16_f32 v70, v84, v85
    v_cvt_pk_bf16_f32 v71, v86, v87
    s_waitcnt lgkmcnt(2)
    v_mfma_f32_32x32x8_bf16 v[72:87], v[52:53], v[44:45], 0
    s_add_u32 m0, s60, 2048
    s_nop 0
    buffer_load_dwordx4 v188, s[92:95], s26 offen lds
    s_add_u32 s26, s26, s38
    v_exp_f32 v88, v88
    v_exp_f32 v89, v89
    v_exp_f32 v90, v90
    v_exp_f32 v91, v91
    v_exp_f32 v96, v96
    s_waitcnt lgkmcnt(1)
    v_mfma_f32_32x32x16_bf16 v[104:119], v[60:63], v[68:71], v[104:119]
    s_add_u32 m0, s60, 3072
    s_nop 0
    buffer_load_dwordx4 v188, s[92:95], s26 offen lds
    s_add_u32 s26, s26, s38
    v_exp_f32 v97, v97
    v_exp_f32 v98, v98
    v_exp_f32 v99, v99
    v_cvt_pk_bf16_f32 v64, v88, v89
    v_cvt_pk_bf16_f32 v65, v90, v91
    v_cvt_pk_bf16_f32 v66, v96, v97
    v_cvt_pk_bf16_f32 v67, v98, v99
    s_waitcnt lgkmcnt(0)
    v_mfma_f32_32x32x16_bf16 v[72:87], v[48:51], v[36:39], v[72:87]
    v_exp_f32 v92, v92
    v_exp_f32 v93, v93
    v_exp_f32 v94, v94
    v_exp_f32 v95, v95
    v_exp_f32 v100, v100
    v_mfma_f32_32x32x16_bf16 v[120:135], v[56:59], v[64:67], v[120:135]
    s_mov_b64 exec, s[44:45]
    ds_read_b128 v[56:59], v24 offset:10240
    s_mov_b64 exec, -1
    v_exp_f32 v101, v101
    v_exp_f32 v102, v102
    v_exp_f32 v103, v103
    v_cvt_pk_bf16_f32 v68, v92, v93
    v_cvt_pk_bf16_f32 v69, v94, v95
    v_cvt_pk_bf16_f32 v70, v100, v101
    v_cvt_pk_bf16_f32 v71, v102, v103
    s_setprio 0
    v_mfma_f32_32x32x8_bf16 v[88:103], v[52:53], v[46:47], 0
    s_mov_b32 exec_hi, 0
    ds_read_b64 v[52:53], v23 offset:15360
    s_mov_b32 exec_hi, -1
    v_exp_f32 v72, v72
    v_exp_f32 v73, v73
    v_exp_f32 v74, v74
    v_exp_f32 v75, v75
    v_exp_f32 v80, v80
    v_mfma_f32_32x32x16_bf16 v[120:135], v[60:63], v[68:71], v[120:135]
    s_mov_b64 exec, s[44:45]
    ds_read_b128 v[60:63], v24 offset:10880
    s_mov_b64 exec, -1
    v_exp_f32 v81, v81
    v_exp_f32 v82, v82
    v_exp_f32 v83, v83
    v_cvt_pk_bf16_f32 v64, v72, v73
    v_cvt_pk_bf16_f32 v65, v74, v75
    v_cvt_pk_bf16_f32 v66, v80, v81
    v_cvt_pk_bf16_f32 v67, v82, v83
    v_mfma_f32_32x32x16_bf16 v[88:103], v[48:51], v[40:43], v[88:103]
    ds_read2st64_b64 v[48:51], v22 offset0:30 offset1:31
    v_exp_f32 v76, v76
    v_exp_f32 v77, v77
    v_exp_f32 v78, v78
    v_exp_f32 v79, v79
    v_exp_f32 v84, v84
    s_waitcnt lgkmcnt(3)
    v_mfma_f32_32x32x16_bf16 v[104:119], v[56:59], v[64:67], v[104:119]
    v_exp_f32 v85, v85
    v_exp_f32 v86, v86
    v_exp_f32 v87, v87
    v_cvt_pk_bf16_f32 v68, v76, v77
    v_cvt_pk_bf16_f32 v69, v78, v79
    v_cvt_pk_bf16_f32 v70, v84, v85
    v_cvt_pk_bf16_f32 v71, v86, v87
    s_waitcnt lgkmcnt(2)
    v_mfma_f32_32x32x8_bf16 v[72:87], v[52:53], v[44:45], 0
    v_exp_f32 v88, v88
    v_exp_f32 v89, v89
    v_exp_f32 v90, v90
    v_exp_f32 v91, v91
    v_exp_f32 v96, v96
    s_waitcnt lgkmcnt(1)
    v_mfma_f32_32x32x16_bf16 v[104:119], v[60:63], v[68:71], v[104:119]
    v_exp_f32 v97, v97
    v_exp_f32 v98, v98
    v_exp_f32 v99, v99
    v_cvt_pk_bf16_f32 v64, v88, v89
    v_cvt_pk_bf16_f32 v65, v90, v91
    v_cvt_pk_bf16_f32 v66, v96, v97
    v_cvt_pk_bf16_f32 v67, v98, v99
    s_waitcnt lgkmcnt(0)
    v_mfma_f32_32x32x16_bf16 v[72:87], v[48:51], v[36:39], v[72:87]
    v_exp_f32 v92, v92
    v_exp_f32 v93, v93
    v_exp_f32 v94, v94
    v_exp_f32 v95, v95
    v_exp_f32 v100, v100
    v_mfma_f32_32x32x16_bf16 v[120:135], v[56:59], v[64:67], v[120:135]
    s_mov_b64 exec, s[44:45]
    ds_read_b128 v[56:59], v24 offset:15360
    s_mov_b64 exec, -1
    v_exp_f32 v101, v101
    v_exp_f32 v102, v102
    v_exp_f32 v103, v103
    v_cvt_pk_bf16_f32 v68, v92, v93
    v_cvt_pk_bf16_f32 v69, v94, v95
    v_cvt_pk_bf16_f32 v70, v100, v101
    v_cvt_pk_bf16_f32 v71, v102, v103
    s_waitcnt vmcnt(4)
    s_barrier
    s_setprio 3
    v_mfma_f32_32x32x8_bf16 v[88:103], v[52:53], v[46:47], 0
    s_mov_b32 exec_hi, 0
    ds_read_b64 v[52:53], v23 offset:20480
    s_mov_b32 exec_hi, -1
    v_exp_f32 v72, v72
    v_exp_f32 v73, v73
    v_exp_f32 v74, v74
    v_exp_f32 v75, v75
    v_exp_f32 v80, v80
    v_mfma_f32_32x32x16_bf16 v[120:135], v[60:63], v[68:71], v[120:135]
    s_mov_b64 exec, s[44:45]
    ds_read_b128 v[60:63], v24 offset:16000
    s_mov_b64 exec, -1
    v_exp_f32 v81, v81
    v_exp_f32 v82, v82
    v_exp_f32 v83, v83
    v_cvt_pk_bf16_f32 v64, v72, v73
    v_cvt_pk_bf16_f32 v65, v74, v75
    v_cvt_pk_bf16_f32 v66, v80, v81
    v_cvt_pk_bf16_f32 v67, v82, v83
    v_mfma_f32_32x32x16_bf16 v[88:103], v[48:51], v[40:43], v[88:103]
    ds_read2st64_b64 v[48:51], v22 offset0:40 offset1:41
    v_exp_f32 v76, v76
    v_exp_f32 v77, v77
    v_exp_f32 v78, v78
    v_exp_f32 v79, v79
    v_exp_f32 v84, v84
    s_waitcnt lgkmcnt(3)
    v_mfma_f32_32x32x16_bf16 v[104:119], v[56:59], v[64:67], v[104:119]
    s_add_u32 m0, s37, 40960
    s_nop 0
    buffer_load_dwordx4 v32, s[8:11], s42 offen sc1 lds
    buffer_load_dwordx4 v33, s[8:11], s42 offen offset:1024 sc1 lds
    s_mov_b32 exec_hi, 0
    buffer_load_dwordx4 v34, s[8:11], s42 offen offset:2048 sc1 lds
    s_mov_b32 exec_hi, -1
    s_add_u32 s42, s42, 327680
    v_exp_f32 v85, v85
    v_exp_f32 v86, v86
    v_exp_f32 v87, v87
    v_cvt_pk_bf16_f32 v68, v76, v77
    v_cvt_pk_bf16_f32 v69, v78, v79
    v_cvt_pk_bf16_f32 v70, v84, v85
    v_cvt_pk_bf16_f32 v71, v86, v87
    s_waitcnt lgkmcnt(2)
    v_mfma_f32_32x32x8_bf16 v[72:87], v[52:53], v[44:45], 0
    v_exp_f32 v88, v88
    v_exp_f32 v89, v89
    v_exp_f32 v90, v90
    v_exp_f32 v91, v91
    v_exp_f32 v96, v96
    s_waitcnt lgkmcnt(1)
    v_mfma_f32_32x32x16_bf16 v[104:119], v[60:63], v[68:71], v[104:119]
    v_exp_f32 v97, v97
    v_exp_f32 v98, v98
    v_exp_f32 v99, v99
    v_cvt_pk_bf16_f32 v64, v88, v89
    v_cvt_pk_bf16_f32 v65, v90, v91
    v_cvt_pk_bf16_f32 v66, v96, v97
    v_cvt_pk_bf16_f32 v67, v98, v99
    s_waitcnt lgkmcnt(0)
    v_mfma_f32_32x32x16_bf16 v[72:87], v[48:51], v[36:39], v[72:87]
    v_exp_f32 v92, v92
    v_exp_f32 v93, v93
    v_exp_f32 v94, v94
    v_exp_f32 v95, v95
    v_exp_f32 v100, v100
    v_mfma_f32_32x32x16_bf16 v[120:135], v[56:59], v[64:67], v[120:135]
    s_mov_b64 exec, s[44:45]
    ds_read_b128 v[56:59], v24 offset:20480
    s_mov_b64 exec, -1
    v_exp_f32 v101, v101
    v_exp_f32 v102, v102
    v_exp_f32 v103, v103
    v_cvt_pk_bf16_f32 v68, v92, v93
    v_cvt_pk_bf16_f32 v69, v94, v95
    v_cvt_pk_bf16_f32 v70, v100, v101
    v_cvt_pk_bf16_f32 v71, v102, v103
    s_setprio 2
    v_mfma_f32_32x32x8_bf16 v[88:103], v[52:53], v[46:47], 0
    s_mov_b32 exec_hi, 0
    ds_read_b64 v[52:53], v23 offset:25600
    s_mov_b32 exec_hi, -1
    v_exp_f32 v72, v72
    v_exp_f32 v73, v73
    v_exp_f32 v74, v74
    v_exp_f32 v75, v75
    v_exp_f32 v80, v80
    v_mfma_f32_32x32x16_bf16 v[120:135], v[60:63], v[68:71], v[120:135]
    s_mov_b64 exec, s[44:45]
    ds_read_b128 v[60:63], v24 offset:21120
    s_mov_b64 exec, -1
    v_exp_f32 v81, v81
    v_exp_f32 v82, v82
    v_exp_f32 v83, v83
    v_cvt_pk_bf16_f32 v64, v72, v73
    v_cvt_pk_bf16_f32 v65, v74, v75
    v_cvt_pk_bf16_f32 v66, v80, v81
    v_cvt_pk_bf16_f32 v67, v82, v83
    v_mfma_f32_32x32x16_bf16 v[88:103], v[48:51], v[40:43], v[88:103]
    ds_read2st64_b64 v[48:51], v22 offset0:50 offset1:51
    v_exp_f32 v76, v76
    v_exp_f32 v77, v77
    v_exp_f32 v78, v78
    v_exp_f32 v79, v79
    v_exp_f32 v84, v84
    s_waitcnt lgkmcnt(3)
    v_mfma_f32_32x32x16_bf16 v[104:119], v[56:59], v[64:67], v[104:119]
    v_exp_f32 v85, v85
    v_exp_f32 v86, v86
    v_exp_f32 v87, v87
    v_cvt_pk_bf16_f32 v68, v76, v77
    v_cvt_pk_bf16_f32 v69, v78, v79
    v_cvt_pk_bf16_f32 v70, v84, v85
    v_cvt_pk_bf16_f32 v71, v86, v87
    s_waitcnt lgkmcnt(2)
    v_mfma_f32_32x32x8_bf16 v[72:87], v[52:53], v[44:45], 0
    v_exp_f32 v88, v88
    v_exp_f32 v89, v89
    v_exp_f32 v90, v90
    v_exp_f32 v91, v91
    v_exp_f32 v96, v96
    s_waitcnt lgkmcnt(1)
    v_mfma_f32_32x32x16_bf16 v[104:119], v[60:63], v[68:71], v[104:119]
    v_exp_f32 v97, v97
    v_exp_f32 v98, v98
    v_exp_f32 v99, v99
    v_cvt_pk_bf16_f32 v64, v88, v89
    v_cvt_pk_bf16_f32 v65, v90, v91
    v_cvt_pk_bf16_f32 v66, v96, v97
    v_cvt_pk_bf16_f32 v67, v98, v99
    s_waitcnt lgkmcnt(0)
    v_mfma_f32_32x32x16_bf16 v[72:87], v[48:51], v[36:39], v[72:87]
    v_exp_f32 v92, v92
    v_exp_f32 v93, v93
    v_exp_f32 v94, v94
    v_exp_f32 v95, v95
    v_exp_f32 v100, v100
    v_mfma_f32_32x32x16_bf16 v[120:135], v[56:59], v[64:67], v[120:135]
    s_mov_b64 exec, s[44:45]
    ds_read_b128 v[56:59], v24 offset:25600
    s_mov_b64 exec, -1
    v_exp_f32 v101, v101
    v_exp_f32 v102, v102
    v_exp_f32 v103, v103
    v_cvt_pk_bf16_f32 v68, v92, v93
    v_cvt_pk_bf16_f32 v69, v94, v95
    v_cvt_pk_bf16_f32 v70, v100, v101
    v_cvt_pk_bf16_f32 v71, v102, v103
    s_setprio 1
    v_mfma_f32_32x32x8_bf16 v[88:103], v[52:53], v[46:47], 0
    s_mov_b32 exec_hi, 0
    ds_read_b64 v[52:53], v23 offset:30720
    s_mov_b32 exec_hi, -1
    v_exp_f32 v72, v72
    v_exp_f32 v73, v73
    v_exp_f32 v74, v74
    v_exp_f32 v75, v75
    v_exp_f32 v80, v80
    v_mfma_f32_32x32x16_bf16 v[120:135], v[60:63], v[68:71], v[120:135]
    s_mov_b64 exec, s[44:45]
    ds_read_b128 v[60:63], v24 offset:26240
    s_mov_b64 exec, -1
    v_exp_f32 v81, v81
    v_exp_f32 v82, v82
    v_exp_f32 v83, v83
    v_cvt_pk_bf16_f32 v64, v72, v73
    v_cvt_pk_bf16_f32 v65, v74, v75
    v_cvt_pk_bf16_f32 v66, v80, v81
    v_cvt_pk_bf16_f32 v67, v82, v83
    v_mfma_f32_32x32x16_bf16 v[88:103], v[48:51], v[40:43], v[88:103]
    ds_read2st64_b64 v[48:51], v22 offset0:60 offset1:61
    v_exp_f32 v76, v76
    v_exp_f32 v77, v77
    v_exp_f32 v78, v78
    v_exp_f32 v79, v79
    v_exp_f32 v84, v84
    s_waitcnt lgkmcnt(3)
    v_mfma_f32_32x32x16_bf16 v[104:119], v[56:59], v[64:67], v[104:119]
    v_exp_f32 v85, v85
    v_exp_f32 v86, v86
    v_exp_f32 v87, v87
    v_cvt_pk_bf16_f32 v68, v76, v77
    v_cvt_pk_bf16_f32 v69, v78, v79
    v_cvt_pk_bf16_f32 v70, v84, v85
    v_cvt_pk_bf16_f32 v71, v86, v87
    s_waitcnt lgkmcnt(2)
    v_mfma_f32_32x32x8_bf16 v[72:87], v[52:53], v[44:45], 0
    s_waitcnt vmcnt(3)
    ds_read_b64_tr_b16 v[172:173], v189 offset:0
    ds_read_b64_tr_b16 v[174:175], v189 offset:2048
    ds_read_b64_tr_b16 v[176:177], v189 offset:32
    ds_read_b64_tr_b16 v[178:179], v189 offset:2080
    ds_read_b64_tr_b16 v[180:181], v189 offset:64
    ds_read_b64_tr_b16 v[182:183], v189 offset:2112
    ds_read_b64_tr_b16 v[184:185], v189 offset:96
    ds_read_b64_tr_b16 v[186:187], v189 offset:2144
    v_exp_f32 v88, v88
    v_exp_f32 v89, v89
    v_exp_f32 v90, v90
    v_exp_f32 v91, v91
    v_exp_f32 v96, v96
    s_waitcnt lgkmcnt(1)
    v_mfma_f32_32x32x16_bf16 v[104:119], v[60:63], v[68:71], v[104:119]
    v_exp_f32 v97, v97
    v_exp_f32 v98, v98
    v_exp_f32 v99, v99
    v_cvt_pk_bf16_f32 v64, v88, v89
    v_cvt_pk_bf16_f32 v65, v90, v91
    v_cvt_pk_bf16_f32 v66, v96, v97
    v_cvt_pk_bf16_f32 v67, v98, v99
    s_waitcnt lgkmcnt(0)
    v_mfma_f32_32x32x16_bf16 v[72:87], v[48:51], v[36:39], v[72:87]
    s_waitcnt lgkmcnt(0)
    buffer_store_dwordx4 v[172:175], v5, s[8:11], s96 offen sc1
    v_mov_b32 v208, 0x3f803f80
    v_mov_b32 v209, 0x3f803f80
    v_mov_b32 v210, 0x3f803f80
    v_mov_b32 v211, 0x3f803f80
    v_lshlrev_b32 v212, 2, v1
    s_nop 0
    v_mfma_f32_16x16x32_bf16 v[192:195], v[208:211], v[172:175], 0
    v_mfma_f32_16x16x32_bf16 v[196:199], v[208:211], v[176:179], 0
    v_mfma_f32_16x16x32_bf16 v[200:203], v[208:211], v[180:183], 0
    v_mfma_f32_16x16x32_bf16 v[204:207], v[208:211], v[184:187], 0
    v_exp_f32 v92, v92
    v_exp_f32 v93, v93
    v_exp_f32 v94, v94
    v_exp_f32 v95, v95
    v_exp_f32 v100, v100
    v_mfma_f32_32x32x16_bf16 v[120:135], v[56:59], v[64:67], v[120:135]
    s_mov_b64 exec, s[44:45]
    ds_read_b128 v[56:59], v24 offset:30720
    s_mov_b64 exec, -1
    v_exp_f32 v101, v101
    v_exp_f32 v102, v102
    v_exp_f32 v103, v103
    v_cvt_pk_bf16_f32 v68, v92, v93
    v_cvt_pk_bf16_f32 v69, v94, v95
    v_cvt_pk_bf16_f32 v70, v100, v101
    v_cvt_pk_bf16_f32 v71, v102, v103
    s_setprio 0
    v_mfma_f32_32x32x8_bf16 v[88:103], v[52:53], v[46:47], 0
    s_mov_b32 exec_hi, 0
    ds_read_b64 v[52:53], v23 offset:35840
    s_mov_b32 exec_hi, -1
    v_exp_f32 v72, v72
    v_exp_f32 v73, v73
    v_exp_f32 v74, v74
    v_exp_f32 v75, v75
    v_exp_f32 v80, v80
    v_mfma_f32_32x32x16_bf16 v[120:135], v[60:63], v[68:71], v[120:135]
    s_mov_b64 exec, s[44:45]
    ds_read_b128 v[60:63], v24 offset:31360
    s_mov_b64 exec, -1
    v_exp_f32 v81, v81
    v_exp_f32 v82, v82
    v_exp_f32 v83, v83
    v_cvt_pk_bf16_f32 v64, v72, v73
    v_cvt_pk_bf16_f32 v65, v74, v75
    v_cvt_pk_bf16_f32 v66, v80, v81
    v_cvt_pk_bf16_f32 v67, v82, v83
    v_mfma_f32_32x32x16_bf16 v[88:103], v[48:51], v[40:43], v[88:103]
    ds_read2st64_b64 v[48:51], v22 offset0:70 offset1:71
    v_exp_f32 v76, v76
    v_exp_f32 v77, v77
    v_exp_f32 v78, v78
    v_exp_f32 v79, v79
    v_exp_f32 v84, v84
    s_waitcnt lgkmcnt(3)
    v_mfma_f32_32x32x16_bf16 v[104:119], v[56:59], v[64:67], v[104:119]
    v_exp_f32 v85, v85
    v_exp_f32 v86, v86
    v_exp_f32 v87, v87
    v_cvt_pk_bf16_f32 v68, v76, v77
    v_cvt_pk_bf16_f32 v69, v78, v79
    v_cvt_pk_bf16_f32 v70, v84, v85
    v_cvt_pk_bf16_f32 v71, v86, v87
    s_waitcnt lgkmcnt(2)
    v_mfma_f32_32x32x8_bf16 v[72:87], v[52:53], v[44:45], 0
    buffer_store_dwordx4 v[176:179], v5, s[8:11], s97 offen sc1
    s_mov_b32 exec_lo, 0xffff0000
    s_mov_b32 exec_hi, 0x0
    v_mov_b32 v192, v196
    s_mov_b32 exec_lo, 0x0
    s_mov_b32 exec_hi, 0xffff
    v_mov_b32 v192, v200
    s_mov_b32 exec_lo, 0x0
    s_mov_b32 exec_hi, 0xffff0000
    v_mov_b32 v192, v204
    s_mov_b64 exec, -1
    buffer_store_dword v192, v212, s[8:11], s25 offen sc1
    v_exp_f32 v88, v88
    v_exp_f32 v89, v89
    v_exp_f32 v90, v90
    v_exp_f32 v91, v91
    v_exp_f32 v96, v96
    s_waitcnt lgkmcnt(1)
    v_mfma_f32_32x32x16_bf16 v[104:119], v[60:63], v[68:71], v[104:119]
    buffer_store_dwordx4 v[180:183], v5, s[8:11], s98 offen sc1
    v_exp_f32 v97, v97
    v_exp_f32 v98, v98
    v_exp_f32 v99, v99
    v_cvt_pk_bf16_f32 v64, v88, v89
    v_cvt_pk_bf16_f32 v65, v90, v91
    v_cvt_pk_bf16_f32 v66, v96, v97
    v_cvt_pk_bf16_f32 v67, v98, v99
    s_waitcnt lgkmcnt(0)
    v_mfma_f32_32x32x16_bf16 v[72:87], v[48:51], v[36:39], v[72:87]
    buffer_store_dwordx4 v[184:187], v5, s[8:11], s99 offen sc1
    v_exp_f32 v92, v92
    v_exp_f32 v93, v93
    v_exp_f32 v94, v94
    v_exp_f32 v95, v95
    v_exp_f32 v100, v100
    v_mfma_f32_32x32x16_bf16 v[120:135], v[56:59], v[64:67], v[120:135]
    s_mov_b64 exec, s[44:45]
    ds_read_b128 v[56:59], v24 offset:35840
    s_mov_b64 exec, -1
    v_exp_f32 v101, v101
    v_exp_f32 v102, v102
    v_exp_f32 v103, v103
    v_cvt_pk_bf16_f32 v68, v92, v93
    v_cvt_pk_bf16_f32 v69, v94, v95
    v_cvt_pk_bf16_f32 v70, v100, v101
    v_cvt_pk_bf16_f32 v71, v102, v103
    s_waitcnt vmcnt(5)
    s_barrier
    s_setprio 3
    v_mfma_f32_32x32x8_bf16 v[88:103], v[52:53], v[46:47], 0
    s_mov_b32 exec_hi, 0
    ds_read_b64 v[52:53], v23 offset:40960
    s_mov_b32 exec_hi, -1
    v_exp_f32 v72, v72
    v_exp_f32 v73, v73
    v_exp_f32 v74, v74
    v_exp_f32 v75, v75
    v_exp_f32 v80, v80
    v_mfma_f32_32x32x16_bf16 v[120:135], v[60:63], v[68:71], v[120:135]
    s_mov_b64 exec, s[44:45]
    ds_read_b128 v[60:63], v24 offset:36480
    s_mov_b64 exec, -1
    v_exp_f32 v81, v81
    v_exp_f32 v82, v82
    v_exp_f32 v83, v83
    v_cvt_pk_bf16_f32 v64, v72, v73
    v_cvt_pk_bf16_f32 v65, v74, v75
    v_cvt_pk_bf16_f32 v66, v80, v81
    v_cvt_pk_bf16_f32 v67, v82, v83
    v_mfma_f32_32x32x16_bf16 v[88:103], v[48:51], v[40:43], v[88:103]
    ds_read2st64_b64 v[48:51], v22 offset0:80 offset1:81
    v_exp_f32 v76, v76
    v_exp_f32 v77, v77
    v_exp_f32 v78, v78
    v_exp_f32 v79, v79
    v_exp_f32 v84, v84
    s_waitcnt lgkmcnt(3)
    v_mfma_f32_32x32x16_bf16 v[104:119], v[56:59], v[64:67], v[104:119]
    s_add_u32 m0, s37, 0
    s_nop 0
    buffer_load_dwordx4 v32, s[8:11], s42 offen sc1 lds
    buffer_load_dwordx4 v33, s[8:11], s42 offen offset:1024 sc1 lds
    s_mov_b32 exec_hi, 0
    buffer_load_dwordx4 v34, s[8:11], s42 offen offset:2048 sc1 lds
    s_mov_b32 exec_hi, -1
    s_add_u32 s42, s42, 327680
    v_exp_f32 v85, v85
    v_exp_f32 v86, v86
    v_exp_f32 v87, v87
    v_cvt_pk_bf16_f32 v68, v76, v77
    v_cvt_pk_bf16_f32 v69, v78, v79
    v_cvt_pk_bf16_f32 v70, v84, v85
    v_cvt_pk_bf16_f32 v71, v86, v87
    s_waitcnt lgkmcnt(2)
    v_mfma_f32_32x32x8_bf16 v[72:87], v[52:53], v[44:45], 0
    v_exp_f32 v88, v88
    v_exp_f32 v89, v89
    v_exp_f32 v90, v90
    v_exp_f32 v91, v91
    v_exp_f32 v96, v96
    s_waitcnt lgkmcnt(1)
    v_mfma_f32_32x32x16_bf16 v[104:119], v[60:63], v[68:71], v[104:119]
    v_exp_f32 v97, v97
    v_exp_f32 v98, v98
    v_exp_f32 v99, v99
    v_cvt_pk_bf16_f32 v64, v88, v89
    v_cvt_pk_bf16_f32 v65, v90, v91
    v_cvt_pk_bf16_f32 v66, v96, v97
    v_cvt_pk_bf16_f32 v67, v98, v99
    s_waitcnt lgkmcnt(0)
    v_mfma_f32_32x32x16_bf16 v[72:87], v[48:51], v[36:39], v[72:87]
    v_exp_f32 v92, v92
    v_exp_f32 v93, v93
    v_exp_f32 v94, v94
    v_exp_f32 v95, v95
    v_exp_f32 v100, v100
    v_mfma_f32_32x32x16_bf16 v[120:135], v[56:59], v[64:67], v[120:135]
    s_mov_b64 exec, s[44:45]
    ds_read_b128 v[56:59], v24 offset:40960
    s_mov_b64 exec, -1
    v_exp_f32 v101, v101
    v_exp_f32 v102, v102
    v_exp_f32 v103, v103
    v_cvt_pk_bf16_f32 v68, v92, v93
    v_cvt_pk_bf16_f32 v69, v94, v95
    v_cvt_pk_bf16_f32 v70, v100, v101
    v_cvt_pk_bf16_f32 v71, v102, v103
    s_setprio 2
    v_mfma_f32_32x32x8_bf16 v[88:103], v[52:53], v[46:47], 0
    s_mov_b32 exec_hi, 0
    ds_read_b64 v[52:53], v23 offset:46080
    s_mov_b32 exec_hi, -1
    v_exp_f32 v72, v72
    v_exp_f32 v73, v73
    v_exp_f32 v74, v74
    v_exp_f32 v75, v75
    v_exp_f32 v80, v80
    v_mfma_f32_32x32x16_bf16 v[120:135], v[60:63], v[68:71], v[120:135]
    s_mov_b64 exec, s[44:45]
    ds_read_b128 v[60:63], v24 offset:41600
    s_mov_b64 exec, -1
    v_exp_f32 v81, v81
    v_exp_f32 v82, v82
    v_exp_f32 v83, v83
    v_cvt_pk_bf16_f32 v64, v72, v73
    v_cvt_pk_bf16_f32 v65, v74, v75
    v_cvt_pk_bf16_f32 v66, v80, v81
    v_cvt_pk_bf16_f32 v67, v82, v83
    v_mfma_f32_32x32x16_bf16 v[88:103], v[48:51], v[40:43], v[88:103]
    ds_read2st64_b64 v[48:51], v22 offset0:90 offset1:91
    v_exp_f32 v76, v76
    v_exp_f32 v77, v77
    v_exp_f32 v78, v78
    v_exp_f32 v79, v79
    v_exp_f32 v84, v84
    s_waitcnt lgkmcnt(3)
    v_mfma_f32_32x32x16_bf16 v[104:119], v[56:59], v[64:67], v[104:119]
    v_exp_f32 v85, v85
    v_exp_f32 v86, v86
    v_exp_f32 v87, v87
    v_cvt_pk_bf16_f32 v68, v76, v77
    v_cvt_pk_bf16_f32 v69, v78, v79
    v_cvt_pk_bf16_f32 v70, v84, v85
    v_cvt_pk_bf16_f32 v71, v86, v87
    s_waitcnt lgkmcnt(2)
    v_mfma_f32_32x32x8_bf16 v[72:87], v[52:53], v[44:45], 0
    v_exp_f32 v88, v88
    v_exp_f32 v89, v89
    v_exp_f32 v90, v90
    v_exp_f32 v91, v91
    v_exp_f32 v96, v96
    s_waitcnt lgkmcnt(1)
    v_mfma_f32_32x32x16_bf16 v[104:119], v[60:63], v[68:71], v[104:119]
    v_exp_f32 v97, v97
    v_exp_f32 v98, v98
    v_exp_f32 v99, v99
    v_cvt_pk_bf16_f32 v64, v88, v89
    v_cvt_pk_bf16_f32 v65, v90, v91
    v_cvt_pk_bf16_f32 v66, v96, v97
    v_cvt_pk_bf16_f32 v67, v98, v99
    s_waitcnt lgkmcnt(0)
    v_mfma_f32_32x32x16_bf16 v[72:87], v[48:51], v[36:39], v[72:87]
    v_exp_f32 v92, v92
    v_exp_f32 v93, v93
    v_exp_f32 v94, v94
    v_exp_f32 v95, v95
    v_exp_f32 v100, v100
    v_mfma_f32_32x32x16_bf16 v[120:135], v[56:59], v[64:67], v[120:135]
    s_mov_b64 exec, s[44:45]
    ds_read_b128 v[56:59], v24 offset:46080
    s_mov_b64 exec, -1
    v_exp_f32 v101, v101
    v_exp_f32 v102, v102
    v_exp_f32 v103, v103
    v_cvt_pk_bf16_f32 v68, v92, v93
    v_cvt_pk_bf16_f32 v69, v94, v95
    v_cvt_pk_bf16_f32 v70, v100, v101
    v_cvt_pk_bf16_f32 v71, v102, v103
    s_waitcnt vmcnt(0)
    s_barrier
    s_add_u32 s60, s100, 4
    s_cmp_lg_u32 s32, 2
    s_cbranch_scc1 L_f_o2
    s_mov_b64 exec, 1
    buffer_store_dword v7, v6, s[8:11], s60 offen sc1
    s_mov_b64 exec, -1
L_f_o2:
    s_setprio 1
    v_mfma_f32_32x32x8_bf16 v[88:103], v[52:53], v[46:47], 0
    s_mov_b32 exec_hi, 0
    ds_read_b64 v[52:53], v23 offset:51200
    s_mov_b32 exec_hi, -1
    v_exp_f32 v72, v72
    v_exp_f32 v73, v73
    v_exp_f32 v74, v74
    v_exp_f32 v75, v75
    v_exp_f32 v80, v80
    v_mfma_f32_32x32x16_bf16 v[120:135], v[60:63], v[68:71], v[120:135]
    s_mov_b64 exec, s[44:45]
    ds_read_b128 v[60:63], v24 offset:46720
    s_mov_b64 exec, -1
    v_exp_f32 v81, v81
    v_exp_f32 v82, v82
    v_exp_f32 v83, v83
    v_cvt_pk_bf16_f32 v64, v72, v73
    v_cvt_pk_bf16_f32 v65, v74, v75
    v_cvt_pk_bf16_f32 v66, v80, v81
    v_cvt_pk_bf16_f32 v67, v82, v83
    v_mfma_f32_32x32x16_bf16 v[88:103], v[48:51], v[40:43], v[88:103]
    ds_read2st64_b64 v[48:51], v22 offset0:100 offset1:101
    v_exp_f32 v76, v76
    v_exp_f32 v77, v77
    v_exp_f32 v78, v78
    v_exp_f32 v79, v79
    v_exp_f32 v84, v84
    s_waitcnt lgkmcnt(3)
    v_mfma_f32_32x32x16_bf16 v[104:119], v[56:59], v[64:67], v[104:119]
    v_exp_f32 v85, v85
    v_exp_f32 v86, v86
    v_exp_f32 v87, v87
    v_cvt_pk_bf16_f32 v68, v76, v77
    v_cvt_pk_bf16_f32 v69, v78, v79
    v_cvt_pk_bf16_f32 v70, v84, v85
    v_cvt_pk_bf16_f32 v71, v86, v87
    s_waitcnt lgkmcnt(2)
    v_mfma_f32_32x32x8_bf16 v[72:87], v[52:53], v[44:45], 0
    v_exp_f32 v88, v88
    v_exp_f32 v89, v89
    v_exp_f32 v90, v90
    v_exp_f32 v91, v91
    v_exp_f32 v96, v96
    s_waitcnt lgkmcnt(1)
    v_mfma_f32_32x32x16_bf16 v[104:119], v[60:63], v[68:71], v[104:119]
    v_exp_f32 v97, v97
    v_exp_f32 v98, v98
    v_exp_f32 v99, v99
    v_cvt_pk_bf16_f32 v64, v88, v89
    v_cvt_pk_bf16_f32 v65, v90, v91
    v_cvt_pk_bf16_f32 v66, v96, v97
    v_cvt_pk_bf16_f32 v67, v98, v99
    s_waitcnt lgkmcnt(0)
    v_mfma_f32_32x32x16_bf16 v[72:87], v[48:51], v[36:39], v[72:87]
    v_exp_f32 v92, v92
    v_exp_f32 v93, v93
    v_exp_f32 v94, v94
    v_exp_f32 v95, v95
    v_exp_f32 v100, v100
    v_mfma_f32_32x32x16_bf16 v[120:135], v[56:59], v[64:67], v[120:135]
    s_mov_b64 exec, s[44:45]
    ds_read_b128 v[56:59], v24 offset:51200
    s_mov_b64 exec, -1
    v_exp_f32 v101, v101
    v_exp_f32 v102, v102
    v_exp_f32 v103, v103
    v_cvt_pk_bf16_f32 v68, v92, v93
    v_cvt_pk_bf16_f32 v69, v94, v95
    v_cvt_pk_bf16_f32 v70, v100, v101
    v_cvt_pk_bf16_f32 v71, v102, v103
    s_setprio 0
    v_mfma_f32_32x32x8_bf16 v[88:103], v[52:53], v[46:47], 0
    s_mov_b32 exec_hi, 0
    ds_read_b64 v[52:53], v23 offset:56320
    s_mov_b32 exec_hi, -1
    v_exp_f32 v72, v72
    v_exp_f32 v73, v73
    v_exp_f32 v74, v74
    v_exp_f32 v75, v75
    v_exp_f32 v80, v80
    v_mfma_f32_32x32x16_bf16 v[120:135], v[60:63], v[68:71], v[120:135]
    s_mov_b64 exec, s[44:45]
    ds_read_b128 v[60:63], v24 offset:51840
    s_mov_b64 exec, -1
    v_exp_f32 v81, v81
    v_exp_f32 v82, v82
    v_exp_f32 v83, v83
    v_cvt_pk_bf16_f32 v64, v72, v73
    v_cvt_pk_bf16_f32 v65, v74, v75
    v_cvt_pk_bf16_f32 v66, v80, v81
    v_cvt_pk_bf16_f32 v67, v82, v83
    v_mfma_f32_32x32x16_bf16 v[88:103], v[48:51], v[40:43], v[88:103]
    ds_read2st64_b64 v[48:51], v22 offset0:110 offset1:111
    v_exp_f32 v76, v76
    v_exp_f32 v77, v77
    v_exp_f32 v78, v78
    v_exp_f32 v79, v79
    v_exp_f32 v84, v84
    s_waitcnt lgkmcnt(3)
    v_mfma_f32_32x32x16_bf16 v[104:119], v[56:59], v[64:67], v[104:119]
    v_exp_f32 v85, v85
    v_exp_f32 v86, v86
    v_exp_f32 v87, v87
    v_cvt_pk_bf16_f32 v68, v76, v77
    v_cvt_pk_bf16_f32 v69, v78, v79
    v_cvt_pk_bf16_f32 v70, v84, v85
    v_cvt_pk_bf16_f32 v71, v86, v87
    s_waitcnt lgkmcnt(2)
    v_mfma_f32_32x32x8_bf16 v[72:87], v[52:53], v[44:45], 0
    v_exp_f32 v88, v88
    v_exp_f32 v89, v89
    v_exp_f32 v90, v90
    v_exp_f32 v91, v91
    v_exp_f32 v96, v96
    s_waitcnt lgkmcnt(1)
    v_mfma_f32_32x32x16_bf16 v[104:119], v[60:63], v[68:71], v[104:119]
    v_exp_f32 v97, v97
    v_exp_f32 v98, v98
    v_exp_f32 v99, v99
    v_cvt_pk_bf16_f32 v64, v88, v89
    v_cvt_pk_bf16_f32 v65, v90, v91
    v_cvt_pk_bf16_f32 v66, v96, v97
    v_cvt_pk_bf16_f32 v67, v98, v99
    s_waitcnt lgkmcnt(0)
    v_mfma_f32_32x32x16_bf16 v[72:87], v[48:51], v[36:39], v[72:87]
    v_exp_f32 v92, v92
    v_exp_f32 v93, v93
    v_exp_f32 v94, v94
    v_exp_f32 v95, v95
    v_exp_f32 v100, v100
    v_mfma_f32_32x32x16_bf16 v[120:135], v[56:59], v[64:67], v[120:135]
    s_mov_b64 exec, s[44:45]
    ds_read_b128 v[56:59], v24 offset:56320
    s_mov_b64 exec, -1
    v_exp_f32 v101, v101
    v_exp_f32 v102, v102
    v_exp_f32 v103, v103
    v_cvt_pk_bf16_f32 v68, v92, v93
    v_cvt_pk_bf16_f32 v69, v94, v95
    v_cvt_pk_bf16_f32 v70, v100, v101
    v_cvt_pk_bf16_f32 v71, v102, v103
    s_waitcnt vmcnt(0)
    s_barrier
    s_setprio 3
    v_mfma_f32_32x32x8_bf16 v[88:103], v[52:53], v[46:47], 0
    s_mov_b32 exec_hi, 0
    ds_read_b64 v[52:53], v23 offset:0
    s_mov_b32 exec_hi, -1
    v_exp_f32 v72, v72
    v_exp_f32 v73, v73
    v_exp_f32 v74, v74
    v_exp_f32 v75, v75
    v_exp_f32 v80, v80
    v_mfma_f32_32x32x16_bf16 v[120:135], v[60:63], v[68:71], v[120:135]
    s_mov_b64 exec, s[44:45]
    ds_read_b128 v[60:63], v24 offset:56960
    s_mov_b64 exec, -1
    v_exp_f32 v81, v81
    v_exp_f32 v82, v82
    v_exp_f32 v83, v83
    v_cvt_pk_bf16_f32 v64, v72, v73
    v_cvt_pk_bf16_f32 v65, v74, v75
    v_cvt_pk_bf16_f32 v66, v80, v81
    v_cvt_pk_bf16_f32 v67, v82, v83
    v_mfma_f32_32x32x16_bf16 v[88:103], v[48:51], v[40:43], v[88:103]
    ds_read2st64_b64 v[48:51], v22 offset0:0 offset1:1
    v_exp_f32 v76, v76
    v_exp_f32 v77, v77
    v_exp_f32 v78, v78
    v_exp_f32 v79, v79
    v_exp_f32 v84, v84
    s_waitcnt lgkmcnt(3)
    v_mfma_f32_32x32x16_bf16 v[104:119], v[56:59], v[64:67], v[104:119]
    s_add_u32 m0, s37, 20480
    s_nop 0
    buffer_load_dwordx4 v32, s[8:11], s42 offen sc1 lds
    buffer_load_dwordx4 v33, s[8:11], s42 offen offset:1024 sc1 lds
    s_mov_b32 exec_hi, 0
    buffer_load_dwordx4 v34, s[8:11], s42 offen offset:2048 sc1 lds
    s_mov_b32 exec_hi, -1
    s_add_u32 s42, s42, 327680
    v_exp_f32 v85, v85
    v_exp_f32 v86, v86
    v_exp_f32 v87, v87
    v_cvt_pk_bf16_f32 v68, v76, v77
    v_cvt_pk_bf16_f32 v69, v78, v79
    v_cvt_pk_bf16_f32 v70, v84, v85
    v_cvt_pk_bf16_f32 v71, v86, v87
    s_waitcnt lgkmcnt(2)
    v_mfma_f32_32x32x8_bf16 v[72:87], v[52:53], v[44:45], 0
    v_exp_f32 v88, v88
    v_exp_f32 v89, v89
    v_exp_f32 v90, v90
    v_exp_f32 v91, v91
    v_exp_f32 v96, v96
    s_waitcnt lgkmcnt(1)
    v_mfma_f32_32x32x16_bf16 v[104:119], v[60:63], v[68:71], v[104:119]
    v_exp_f32 v97, v97
    v_exp_f32 v98, v98
    v_exp_f32 v99, v99
    v_cvt_pk_bf16_f32 v64, v88, v89
    v_cvt_pk_bf16_f32 v65, v90, v91
    v_cvt_pk_bf16_f32 v66, v96, v97
    v_cvt_pk_bf16_f32 v67, v98, v99
    s_waitcnt lgkmcnt(0)
    v_mfma_f32_32x32x16_bf16 v[72:87], v[48:51], v[36:39], v[72:87]
    v_exp_f32 v92, v92
    v_exp_f32 v93, v93
    v_exp_f32 v94, v94
    v_exp_f32 v95, v95
    v_exp_f32 v100, v100
    v_mfma_f32_32x32x16_bf16 v[120:135], v[56:59], v[64:67], v[120:135]
    s_mov_b64 exec, s[44:45]
    ds_read_b128 v[56:59], v24 offset:0
    s_mov_b64 exec, -1
    v_exp_f32 v101, v101
    v_exp_f32 v102, v102
    v_exp_f32 v103, v103
    v_cvt_pk_bf16_f32 v68, v92, v93
    v_cvt_pk_bf16_f32 v69, v94, v95
    v_cvt_pk_bf16_f32 v70, v100, v101
    v_cvt_pk_bf16_f32 v71, v102, v103
    s_setprio 2
    v_mfma_f32_32x32x8_bf16 v[88:103], v[52:53], v[46:47], 0
    s_mov_b32 exec_hi, 0
    ds_read_b64 v[52:53], v23 offset:5120
    s_mov_b32 exec_hi, -1
    v_exp_f32 v72, v72
    v_exp_f32 v73, v73
    v_exp_f32 v74, v74
    v_exp_f32 v75, v75
    v_exp_f32 v80, v80
    v_mfma_f32_32x32x16_bf16 v[120:135], v[60:63], v[68:71], v[120:135]
    s_mov_b64 exec, s[44:45]
    ds_read_b128 v[60:63], v24 offset:640
    s_mov_b64 exec, -1
    v_exp_f32 v81, v81
    v_exp_f32 v82, v82
    v_exp_f32 v83, v83
    v_cvt_pk_bf16_f32 v64, v72, v73
    v_cvt_pk_bf16_f32 v65, v74, v75
    v_cvt_pk_bf16_f32 v66, v80, v81
    v_cvt_pk_bf16_f32 v67, v82, v83
    v_mfma_f32_32x32x16_bf16 v[88:103], v[48:51], v[40:43], v[88:103]
    ds_read2st64_b64 v[48:51], v22 offset0:10 offset1:11
    v_exp_f32 v76, v76
    v_exp_f32 v77, v77
    v_exp_f32 v78, v78
    v_exp_f32 v79, v79
    v_exp_f32 v84, v84
    s_waitcnt lgkmcnt(3)
    v_mfma_f32_32x32x16_bf16 v[104:119], v[56:59], v[64:67], v[104:119]
    v_exp_f32 v85, v85
    v_exp_f32 v86, v86
    v_exp_f32 v87, v87
    v_cvt_pk_bf16_f32 v68, v76, v77
    v_cvt_pk_bf16_f32 v69, v78, v79
    v_cvt_pk_bf16_f32 v70, v84, v85
    v_cvt_pk_bf16_f32 v71, v86, v87
    s_waitcnt lgkmcnt(2)
    v_mfma_f32_32x32x8_bf16 v[72:87], v[52:53], v[44:45], 0
    s_mov_b32 s60, 32505860
    buffer_load_dword v27, v35, s[8:11], s60 offen sc1
    v_exp_f32 v88, v88
    v_exp_f32 v89, v89
    v_exp_f32 v90, v90
    v_exp_f32 v91, v91
    v_exp_f32 v96, v96
    s_waitcnt lgkmcnt(1)
    v_mfma_f32_32x32x16_bf16 v[104:119], v[60:63], v[68:71], v[104:119]
    v_exp_f32 v97, v97
    v_exp_f32 v98, v98
    v_exp_f32 v99, v99
    v_cvt_pk_bf16_f32 v64, v88, v89
    v_cvt_pk_bf16_f32 v65, v90, v91
    v_cvt_pk_bf16_f32 v66, v96, v97
    v_cvt_pk_bf16_f32 v67, v98, v99
    s_waitcnt lgkmcnt(0)
    v_mfma_f32_32x32x16_bf16 v[72:87], v[48:51], v[36:39], v[72:87]
    v_exp_f32 v92, v92
    v_exp_f32 v93, v93
    v_exp_f32 v94, v94
    v_exp_f32 v95, v95
    v_exp_f32 v100, v100
    v_mfma_f32_32x32x16_bf16 v[120:135], v[56:59], v[64:67], v[120:135]
    s_mov_b64 exec, s[44:45]
    ds_read_b128 v[56:59], v24 offset:5120
    s_mov_b64 exec, -1
    v_exp_f32 v101, v101
    v_exp_f32 v102, v102
    v_exp_f32 v103, v103
    v_cvt_pk_bf16_f32 v68, v92, v93
    v_cvt_pk_bf16_f32 v69, v94, v95
    v_cvt_pk_bf16_f32 v70, v100, v101
    v_cvt_pk_bf16_f32 v71, v102, v103
    s_setprio 1
    v_mfma_f32_32x32x8_bf16 v[88:103], v[52:53], v[46:47], 0
    s_mov_b32 exec_hi, 0
    ds_read_b64 v[52:53], v23 offset:10240
    s_mov_b32 exec_hi, -1
    v_exp_f32 v72, v72
    v_exp_f32 v73, v73
    v_exp_f32 v74, v74
    v_exp_f32 v75, v75
    v_exp_f32 v80, v80
    v_mfma_f32_32x32x16_bf16 v[120:135], v[60:63], v[68:71], v[120:135]
    s_mov_b64 exec, s[44:45]
    ds_read_b128 v[60:63], v24 offset:5760
    s_mov_b64 exec, -1
    v_exp_f32 v81, v81
    v_exp_f32 v82, v82
    v_exp_f32 v83, v83
    v_cvt_pk_bf16_f32 v64, v72, v73
    v_cvt_pk_bf16_f32 v65, v74, v75
    v_cvt_pk_bf16_f32 v66, v80, v81
    v_cvt_pk_bf16_f32 v67, v82, v83
    v_mfma_f32_32x32x16_bf16 v[88:103], v[48:51], v[40:43], v[88:103]
    ds_read2st64_b64 v[48:51], v22 offset0:20 offset1:21
    v_exp_f32 v76, v76
    v_exp_f32 v77, v77
    v_exp_f32 v78, v78
    v_exp_f32 v79, v79
    v_exp_f32 v84, v84
    s_waitcnt lgkmcnt(3)
    v_mfma_f32_32x32x16_bf16 v[104:119], v[56:59], v[64:67], v[104:119]
    v_exp_f32 v85, v85
    v_exp_f32 v86, v86
    v_exp_f32 v87, v87
    v_cvt_pk_bf16_f32 v68, v76, v77
    v_cvt_pk_bf16_f32 v69, v78, v79
    v_cvt_pk_bf16_f32 v70, v84, v85
    v_cvt_pk_bf16_f32 v71, v86, v87
    s_waitcnt lgkmcnt(2)
    v_mfma_f32_32x32x8_bf16 v[72:87], v[52:53], v[44:45], 0
    v_exp_f32 v88, v88
    v_exp_f32 v89, v89
    v_exp_f32 v90, v90
    v_exp_f32 v91, v91
    v_exp_f32 v96, v96
    s_waitcnt lgkmcnt(1)
    v_mfma_f32_32x32x16_bf16 v[104:119], v[60:63], v[68:71], v[104:119]
    v_exp_f32 v97, v97
    v_exp_f32 v98, v98
    v_exp_f32 v99, v99
    v_cvt_pk_bf16_f32 v64, v88, v89
    v_cvt_pk_bf16_f32 v65, v90, v91
    v_cvt_pk_bf16_f32 v66, v96, v97
    v_cvt_pk_bf16_f32 v67, v98, v99
    s_waitcnt lgkmcnt(0)
    v_mfma_f32_32x32x16_bf16 v[72:87], v[48:51], v[36:39], v[72:87]
    v_exp_f32 v92, v92
    v_exp_f32 v93, v93
    v_exp_f32 v94, v94
    v_exp_f32 v95, v95
    v_exp_f32 v100, v100
    v_mfma_f32_32x32x16_bf16 v[120:135], v[56:59], v[64:67], v[120:135]
    s_mov_b64 exec, s[44:45]
    ds_read_b128 v[56:59], v24 offset:10240
    s_mov_b64 exec, -1
    v_exp_f32 v101, v101
    v_exp_f32 v102, v102
    v_exp_f32 v103, v103
    v_cvt_pk_bf16_f32 v68, v92, v93
    v_cvt_pk_bf16_f32 v69, v94, v95
    v_cvt_pk_bf16_f32 v70, v100, v101
    v_cvt_pk_bf16_f32 v71, v102, v103
    s_waitcnt vmcnt(0)
    v_cmp_ne_u32 vcc, 1, v27
    s_nop 4
    s_cbranch_vccz L_f_wtok
    s_mov_b32 s38, 0
    s_branch L_f_q3
L_f_p3:
    s_sleep 4
L_f_q3:
    buffer_load_dword v27, v35, s[8:11], s60 offen sc1
    s_add_u32 s38, s38, 1
    s_cmp_gt_u32 s38, 100000
    s_waitcnt vmcnt(0)
    s_cbranch_scc1 L_f_x3
    v_cmp_ne_u32 vcc, 1, v27
    s_nop 4
    s_cbranch_vccnz L_f_p3
L_f_x3:
L_f_wtok:
    s_barrier
    s_setprio 0
    v_mfma_f32_32x32x8_bf16 v[88:103], v[52:53], v[46:47], 0
    s_mov_b32 exec_hi, 0
    ds_read_b64 v[52:53], v23 offset:15360
    s_mov_b32 exec_hi, -1
    v_exp_f32 v72, v72
    v_exp_f32 v73, v73
    v_exp_f32 v74, v74
    v_exp_f32 v75, v75
    v_exp_f32 v80, v80
    v_mfma_f32_32x32x16_bf16 v[120:135], v[60:63], v[68:71], v[120:135]
    s_mov_b64 exec, s[44:45]
    ds_read_b128 v[60:63], v24 offset:10880
    s_mov_b64 exec, -1
    v_exp_f32 v81, v81
    v_exp_f32 v82, v82
    v_exp_f32 v83, v83
    v_cvt_pk_bf16_f32 v64, v72, v73
    v_cvt_pk_bf16_f32 v65, v74, v75
    v_cvt_pk_bf16_f32 v66, v80, v81
    v_cvt_pk_bf16_f32 v67, v82, v83
    v_mfma_f32_32x32x16_bf16 v[88:103], v[48:51], v[40:43], v[88:103]
    ds_read2st64_b64 v[48:51], v22 offset0:30 offset1:31
    v_exp_f32 v76, v76
    v_exp_f32 v77, v77
    v_exp_f32 v78, v78
    v_exp_f32 v79, v79
    v_exp_f32 v84, v84
    s_waitcnt lgkmcnt(3)
    v_mfma_f32_32x32x16_bf16 v[104:119], v[56:59], v[64:67], v[104:119]
    v_exp_f32 v85, v85
    v_exp_f32 v86, v86
    v_exp_f32 v87, v87
    v_cvt_pk_bf16_f32 v68, v76, v77
    v_cvt_pk_bf16_f32 v69, v78, v79
    v_cvt_pk_bf16_f32 v70, v84, v85
    v_cvt_pk_bf16_f32 v71, v86, v87
    s_waitcnt lgkmcnt(2)
    v_mfma_f32_32x32x8_bf16 v[72:87], v[52:53], v[44:45], 0
    s_add_u32 m0, s53, 61440
    s_add_u32 s35, s53, s52
    buffer_load_dwordx4 v5, s[8:11], s35 offen sc1 lds
    buffer_load_dwordx4 v5, s[8:11], s35 offen offset:1024 sc1 lds
    s_add_u32 s53, s53, 16384
    v_exp_f32 v88, v88
    v_exp_f32 v89, v89
    v_exp_f32 v90, v90
    v_exp_f32 v91, v91
    v_exp_f32 v96, v96
    s_waitcnt lgkmcnt(1)
    v_mfma_f32_32x32x16_bf16 v[104:119], v[60:63], v[68:71], v[104:119]
    buffer_load_dwordx4 v[140:143], v5, s[8:11], s48 offen sc1
    s_add_u32 s48, s48, s89
    v_exp_f32 v97, v97
    v_exp_f32 v98, v98
    v_exp_f32 v99, v99
    v_cvt_pk_bf16_f32 v64, v88, v89
    v_cvt_pk_bf16_f32 v65, v90, v91
    v_cvt_pk_bf16_f32 v66, v96, v97
    v_cvt_pk_bf16_f32 v67, v98, v99
    s_waitcnt lgkmcnt(0)
    v_mfma_f32_32x32x16_bf16 v[72:87], v[48:51], v[36:39], v[72:87]
    buffer_load_dwordx4 v[144:147], v5, s[8:11], s48 offen sc1
    s_add_u32 s48, s48, s89
    v_exp_f32 v92, v92
    v_exp_f32 v93, v93
    v_exp_f32 v94, v94
    v_exp_f32 v95, v95
    v_exp_f32 v100, v100
    v_mfma_f32_32x32x16_bf16 v[120:135], v[56:59], v[64:67], v[120:135]
    s_mov_b64 exec, s[44:45]
    ds_read_b128 v[56:59], v24 offset:15360
    s_mov_b64 exec, -1
    v_exp_f32 v101, v101
    v_exp_f32 v102, v102
    v_exp_f32 v103, v103
    v_cvt_pk_bf16_f32 v68, v92, v93
    v_cvt_pk_bf16_f32 v69, v94, v95
    v_cvt_pk_bf16_f32 v70, v100, v101
    v_cvt_pk_bf16_f32 v71, v102, v103
    s_waitcnt vmcnt(5)
    s_barrier
    s_setprio 3
    v_mfma_f32_32x32x8_bf16 v[88:103], v[52:53], v[46:47], 0
    s_mov_b32 exec_hi, 0
    ds_read_b64 v[52:53], v23 offset:20480
    s_mov_b32 exec_hi, -1
    v_exp_f32 v72, v72
    v_exp_f32 v73, v73
    v_exp_f32 v74, v74
    v_exp_f32 v75, v75
    v_exp_f32 v80, v80
    v_mfma_f32_32x32x16_bf16 v[120:135], v[60:63], v[68:71], v[120:135]
    s_mov_b64 exec, s[44:45]
    ds_read_b128 v[60:63], v24 offset:16000
    s_mov_b64 exec, -1
    v_exp_f32 v81, v81
    v_exp_f32 v82, v82
    v_exp_f32 v83, v83
    v_cvt_pk_bf16_f32 v64, v72, v73
    v_cvt_pk_bf16_f32 v65, v74, v75
    v_cvt_pk_bf16_f32 v66, v80, v81
    v_cvt_pk_bf16_f32 v67, v82, v83
    v_mfma_f32_32x32x16_bf16 v[88:103], v[48:51], v[40:43], v[88:103]
    ds_read2st64_b64 v[48:51], v22 offset0:40 offset1:41
    v_exp_f32 v76, v76
    v_exp_f32 v77, v77
    v_exp_f32 v78, v78
    v_exp_f32 v79, v79
    v_exp_f32 v84, v84
    s_waitcnt lgkmcnt(3)
    v_mfma_f32_32x32x16_bf16 v[104:119], v[56:59], v[64:67], v[104:119]
    s_add_u32 m0, s37, 40960
    s_nop 0
    buffer_load_dwordx4 v32, s[8:11], s42 offen sc1 lds
    buffer_load_dwordx4 v33, s[8:11], s42 offen offset:1024 sc1 lds
    s_mov_b32 exec_hi, 0
    buffer_load_dwordx4 v34, s[8:11], s42 offen offset:2048 sc1 lds
    s_mov_b32 exec_hi, -1
    s_add_u32 s42, s42, 327680
    v_exp_f32 v85, v85
    v_exp_f32 v86, v86
    v_exp_f32 v87, v87
    v_cvt_pk_bf16_f32 v68, v76, v77
    v_cvt_pk_bf16_f32 v69, v78, v79
    v_cvt_pk_bf16_f32 v70, v84, v85
    v_cvt_pk_bf16_f32 v71, v86, v87
    s_waitcnt lgkmcnt(2)
    v_mfma_f32_32x32x8_bf16 v[72:87], v[52:53], v[44:45], 0
    buffer_load_dwordx4 v[148:151], v5, s[8:11], s48 offen sc1
    s_add_u32 s48, s48, s89
    v_exp_f32 v88, v88
    v_exp_f32 v89, v89
    v_exp_f32 v90, v90
    v_exp_f32 v91, v91
    v_exp_f32 v96, v96
    s_waitcnt lgkmcnt(1)
    v_mfma_f32_32x32x16_bf16 v[104:119], v[60:63], v[68:71], v[104:119]
    buffer_load_dwordx4 v[152:155], v5, s[8:11], s48 offen sc1
    s_add_u32 s48, s48, s89
    v_exp_f32 v97, v97
    v_exp_f32 v98, v98
    v_exp_f32 v99, v99
    v_cvt_pk_bf16_f32 v64, v88, v89
    v_cvt_pk_bf16_f32 v65, v90, v91
    v_cvt_pk_bf16_f32 v66, v96, v97
    v_cvt_pk_bf16_f32 v67, v98, v99
    s_waitcnt lgkmcnt(0)
    v_mfma_f32_32x32x16_bf16 v[72:87], v[48:51], v[36:39], v[72:87]
    s_add_u32 m0, s53, 61440
    s_add_u32 s35, s53, s52
    buffer_load_dwordx4 v5, s[8:11], s35 offen sc1 lds
    buffer_load_dwordx4 v5, s[8:11], s35 offen offset:1024 sc1 lds
    s_add_u32 s53, s53, 16384
    v_exp_f32 v92, v92
    v_exp_f32 v93, v93
    v_exp_f32 v94, v94
    v_exp_f32 v95, v95
    v_exp_f32 v100, v100
    v_mfma_f32_32x32x16_bf16 v[120:135], v[56:59], v[64:67], v[120:135]
    s_mov_b64 exec, s[44:45]
    ds_read_b128 v[56:59], v24 offset:20480
    s_mov_b64 exec, -1
    v_exp_f32 v101, v101
    v_exp_f32 v102, v102
    v_exp_f32 v103, v103
    v_cvt_pk_bf16_f32 v68, v92, v93
    v_cvt_pk_bf16_f32 v69, v94, v95
    v_cvt_pk_bf16_f32 v70, v100, v101
    v_cvt_pk_bf16_f32 v71, v102, v103
    s_setprio 2
    v_mfma_f32_32x32x8_bf16 v[88:103], v[52:53], v[46:47], 0
    s_mov_b32 exec_hi, 0
    ds_read_b64 v[52:53], v23 offset:25600
    s_mov_b32 exec_hi, -1
    v_exp_f32 v72, v72
    v_exp_f32 v73, v73
    v_exp_f32 v74, v74
    v_exp_f32 v75, v75
    v_exp_f32 v80, v80
    v_mfma_f32_32x32x16_bf16 v[120:135], v[60:63], v[68:71], v[120:135]
    s_mov_b64 exec, s[44:45]
    ds_read_b128 v[60:63], v24 offset:21120
    s_mov_b64 exec, -1
    v_exp_f32 v81, v81
    v_exp_f32 v82, v82
    v_exp_f32 v83, v83
    v_cvt_pk_bf16_f32 v64, v72, v73
    v_cvt_pk_bf16_f32 v65, v74, v75
    v_cvt_pk_bf16_f32 v66, v80, v81
    v_cvt_pk_bf16_f32 v67, v82, v83
    v_mfma_f32_32x32x16_bf16 v[88:103], v[48:51], v[40:43], v[88:103]
    ds_read2st64_b64 v[48:51], v22 offset0:50 offset1:51
    v_exp_f32 v76, v76
    v_exp_f32 v77, v77
    v_exp_f32 v78, v78
    v_exp_f32 v79, v79
    v_exp_f32 v84, v84
    s_waitcnt lgkmcnt(3)
    v_mfma_f32_32x32x16_bf16 v[104:119], v[56:59], v[64:67], v[104:119]
    v_exp_f32 v85, v85
    v_exp_f32 v86, v86
    v_exp_f32 v87, v87
    v_cvt_pk_bf16_f32 v68, v76, v77
    v_cvt_pk_bf16_f32 v69, v78, v79
    v_cvt_pk_bf16_f32 v70, v84, v85
    v_cvt_pk_bf16_f32 v71, v86, v87
    s_waitcnt lgkmcnt(2)
    v_mfma_f32_32x32x8_bf16 v[72:87], v[52:53], v[44:45], 0
    buffer_load_dwordx4 v[156:159], v5, s[8:11], s48 offen sc1
    s_add_u32 s48, s48, s89
    v_exp_f32 v88, v88
    v_exp_f32 v89, v89
    v_exp_f32 v90, v90
    v_exp_f32 v91, v91
    v_exp_f32 v96, v96
    s_waitcnt lgkmcnt(1)
    v_mfma_f32_32x32x16_bf16 v[104:119], v[60:63], v[68:71], v[104:119]
    buffer_load_dwordx4 v[160:163], v5, s[8:11], s48 offen sc1
    s_add_u32 s48, s48, s89
    v_exp_f32 v97, v97
    v_exp_f32 v98, v98
    v_exp_f32 v99, v99
    v_cvt_pk_bf16_f32 v64, v88, v89
    v_cvt_pk_bf16_f32 v65, v90, v91
    v_cvt_pk_bf16_f32 v66, v96, v97
    v_cvt_pk_bf16_f32 v67, v98, v99
    s_waitcnt lgkmcnt(0)
    v_mfma_f32_32x32x16_bf16 v[72:87], v[48:51], v[36:39], v[72:87]
    buffer_load_dwordx4 v[164:167], v5, s[8:11], s48 offen sc1
    s_add_u32 s48, s48, s89
    v_exp_f32 v92, v92
    v_exp_f32 v93, v93
    v_exp_f32 v94, v94
    v_exp_f32 v95, v95
    v_exp_f32 v100, v100
    v_mfma_f32_32x32x16_bf16 v[120:135], v[56:59], v[64:67], v[120:135]
    s_mov_b64 exec, s[44:45]
    ds_read_b128 v[56:59], v24 offset:25600
    s_mov_b64 exec, -1
    v_exp_f32 v101, v101
    v_exp_f32 v102, v102
    v_exp_f32 v103, v103
    v_cvt_pk_bf16_f32 v68, v92, v93
    v_cvt_pk_bf16_f32 v69, v94, v95
    v_cvt_pk_bf16_f32 v70, v100, v101
    v_cvt_pk_bf16_f32 v71, v102, v103
    s_setprio 1
    v_mfma_f32_32x32x8_bf16 v[88:103], v[52:53], v[46:47], 0
    s_mov_b32 exec_hi, 0
    ds_read_b64 v[52:53], v23 offset:30720
    s_mov_b32 exec_hi, -1
    v_exp_f32 v72, v72
    v_exp_f32 v73, v73
    v_exp_f32 v74, v74
    v_exp_f32 v75, v75
    v_exp_f32 v80, v80
    v_mfma_f32_32x32x16_bf16 v[120:135], v[60:63], v[68:71], v[120:135]
    s_mov_b64 exec, s[44:45]
    ds_read_b128 v[60:63], v24 offset:26240
    s_mov_b64 exec, -1
    v_exp_f32 v81, v81
    v_exp_f32 v82, v82
    v_exp_f32 v83, v83
    v_cvt_pk_bf16_f32 v64, v72, v73
    v_cvt_pk_bf16_f32 v65, v74, v75
    v_cvt_pk_bf16_f32 v66, v80, v81
    v_cvt_pk_bf16_f32 v67, v82, v83
    v_mfma_f32_32x32x16_bf16 v[88:103], v[48:51], v[40:43], v[88:103]
    ds_read2st64_b64 v[48:51], v22 offset0:60 offset1:61
    v_exp_f32 v76, v76
    v_exp_f32 v77, v77
    v_exp_f32 v78, v78
    v_exp_f32 v79, v79
    v_exp_f32 v84, v84
    s_waitcnt lgkmcnt(3)
    v_mfma_f32_32x32x16_bf16 v[104:119], v[56:59], v[64:67], v[104:119]
    v_exp_f32 v85, v85
    v_exp_f32 v86, v86
    v_exp_f32 v87, v87
    v_cvt_pk_bf16_f32 v68, v76, v77
    v_cvt_pk_bf16_f32 v69, v78, v79
    v_cvt_pk_bf16_f32 v70, v84, v85
    v_cvt_pk_bf16_f32 v71, v86, v87
    s_waitcnt lgkmcnt(2)
    v_mfma_f32_32x32x8_bf16 v[72:87], v[52:53], v[44:45], 0
    buffer_load_dwordx4 v[168:171], v5, s[8:11], s48 offen sc1
    s_add_u32 s48, s48, s89
    v_exp_f32 v88, v88
    v_exp_f32 v89, v89
    v_exp_f32 v90, v90
    v_exp_f32 v91, v91
    v_exp_f32 v96, v96
    s_waitcnt lgkmcnt(1)
    v_mfma_f32_32x32x16_bf16 v[104:119], v[60:63], v[68:71], v[104:119]
    s_add_u32 m0, s53, 61440
    s_add_u32 s35, s53, s52
    buffer_load_dwordx4 v5, s[8:11], s35 offen sc1 lds
    buffer_load_dwordx4 v5, s[8:11], s35 offen offset:1024 sc1 lds
    s_add_u32 s53, s53, 16384
    v_exp_f32 v97, v97
    v_exp_f32 v98, v98
    v_exp_f32 v99, v99
    v_cvt_pk_bf16_f32 v64, v88, v89
    v_cvt_pk_bf16_f32 v65, v90, v91
    v_cvt_pk_bf16_f32 v66, v96, v97
    v_cvt_pk_bf16_f32 v67, v98, v99
    s_waitcnt lgkmcnt(0)
    v_mfma_f32_32x32x16_bf16 v[72:87], v[48:51], v[36:39], v[72:87]
    buffer_load_dwordx4 v[172:175], v5, s[8:11], s48 offen sc1
    s_add_u32 s48, s48, s89
    v_exp_f32 v92, v92
    v_exp_f32 v93, v93
    v_exp_f32 v94, v94
    v_exp_f32 v95, v95
    v_exp_f32 v100, v100
    v_mfma_f32_32x32x16_bf16 v[120:135], v[56:59], v[64:67], v[120:135]
    s_mov_b64 exec, s[44:45]
    ds_read_b128 v[56:59], v24 offset:30720
    s_mov_b64 exec, -1
    v_exp_f32 v101, v101
    v_exp_f32 v102, v102
    v_exp_f32 v103, v103
    v_cvt_pk_bf16_f32 v68, v92, v93
    v_cvt_pk_bf16_f32 v69, v94, v95
    v_cvt_pk_bf16_f32 v70, v100, v101
    v_cvt_pk_bf16_f32 v71, v102, v103
    s_setprio 0
    v_mfma_f32_32x32x8_bf16 v[88:103], v[52:53], v[46:47], 0
    s_mov_b32 exec_hi, 0
    ds_read_b64 v[52:53], v23 offset:35840
    s_mov_b32 exec_hi, -1
    v_exp_f32 v72, v72
    v_exp_f32 v73, v73
    v_exp_f32 v74, v74
    v_exp_f32 v75, v75
    v_exp_f32 v80, v80
    v_mfma_f32_32x32x16_bf16 v[120:135], v[60:63], v[68:71], v[120:135]
    s_mov_b64 exec, s[44:45]
    ds_read_b128 v[60:63], v24 offset:31360
    s_mov_b64 exec, -1
    v_exp_f32 v81, v81
    v_exp_f32 v82, v82
    v_exp_f32 v83, v83
    v_cvt_pk_bf16_f32 v64, v72, v73
    v_cvt_pk_bf16_f32 v65, v74, v75
    v_cvt_pk_bf16_f32 v66, v80, v81
    v_cvt_pk_bf16_f32 v67, v82, v83
    v_mfma_f32_32x32x16_bf16 v[88:103], v[48:51], v[40:43], v[88:103]
    ds_read2st64_b64 v[48:51], v22 offset0:70 offset1:71
    v_exp_f32 v76, v76
    v_exp_f32 v77, v77
    v_exp_f32 v78, v78
    v_exp_f32 v79, v79
    v_exp_f32 v84, v84
    s_waitcnt lgkmcnt(3)
    v_mfma_f32_32x32x16_bf16 v[104:119], v[56:59], v[64:67], v[104:119]
    v_exp_f32 v85, v85
    v_exp_f32 v86, v86
    v_exp_f32 v87, v87
    v_cvt_pk_bf16_f32 v68, v76, v77
    v_cvt_pk_bf16_f32 v69, v78, v79
    v_cvt_pk_bf16_f32 v70, v84, v85
    v_cvt_pk_bf16_f32 v71, v86, v87
    s_waitcnt lgkmcnt(2)
    v_mfma_f32_32x32x8_bf16 v[72:87], v[52:53], v[44:45], 0
    buffer_load_dwordx4 v[176:179], v5, s[8:11], s48 offen sc1
    s_add_u32 s48, s48, s89
    v_exp_f32 v88, v88
    v_exp_f32 v89, v89
    v_exp_f32 v90, v90
    v_exp_f32 v91, v91
    v_exp_f32 v96, v96
    s_waitcnt lgkmcnt(1)
    v_mfma_f32_32x32x16_bf16 v[104:119], v[60:63], v[68:71], v[104:119]
    buffer_load_dwordx4 v[180:183], v5, s[8:11], s48 offen sc1
    s_add_u32 s48, s48, s89
    v_exp_f32 v97, v97
    v_exp_f32 v98, v98
    v_exp_f32 v99, v99
    v_cvt_pk_bf16_f32 v64, v88, v89
    v_cvt_pk_bf16_f32 v65, v90, v91
    v_cvt_pk_bf16_f32 v66, v96, v97
    v_cvt_pk_bf16_f32 v67, v98, v99
    s_waitcnt lgkmcnt(0)
    v_mfma_f32_32x32x16_bf16 v[72:87], v[48:51], v[36:39], v[72:87]
    buffer_load_dwordx4 v[184:187], v5, s[8:11], s48 offen sc1
    s_add_u32 s48, s48, s89
    v_exp_f32 v92, v92
    v_exp_f32 v93, v93
    v_exp_f32 v94, v94
    v_exp_f32 v95, v95
    v_exp_f32 v100, v100
    v_mfma_f32_32x32x16_bf16 v[120:135], v[56:59], v[64:67], v[120:135]
    s_mov_b64 exec, s[44:45]
    ds_read_b128 v[56:59], v24 offset:35840
    s_mov_b64 exec, -1
    v_exp_f32 v101, v101
    v_exp_f32 v102, v102
    v_exp_f32 v103, v103
    v_cvt_pk_bf16_f32 v68, v92, v93
    v_cvt_pk_bf16_f32 v69, v94, v95
    v_cvt_pk_bf16_f32 v70, v100, v101
    v_cvt_pk_bf16_f32 v71, v102, v103
    s_waitcnt vmcnt(14)
    s_barrier
    s_setprio 3
    v_mfma_f32_32x32x8_bf16 v[88:103], v[52:53], v[46:47], 0
    s_mov_b32 exec_hi, 0
    ds_read_b64 v[52:53], v23 offset:40960
    s_mov_b32 exec_hi, -1
    v_exp_f32 v72, v72
    v_exp_f32 v73, v73
    v_exp_f32 v74, v74
    v_exp_f32 v75, v75
    v_exp_f32 v80, v80
    v_mfma_f32_32x32x16_bf16 v[120:135], v[60:63], v[68:71], v[120:135]
    s_mov_b64 exec, s[44:45]
    ds_read_b128 v[60:63], v24 offset:36480
    s_mov_b64 exec, -1
    v_exp_f32 v81, v81
    v_exp_f32 v82, v82
    v_exp_f32 v83, v83
    v_cvt_pk_bf16_f32 v64, v72, v73
    v_cvt_pk_bf16_f32 v65, v74, v75
    v_cvt_pk_bf16_f32 v66, v80, v81
    v_cvt_pk_bf16_f32 v67, v82, v83
    v_mfma_f32_32x32x16_bf16 v[88:103], v[48:51], v[40:43], v[88:103]
    ds_read2st64_b64 v[48:51], v22 offset0:80 offset1:81
    v_exp_f32 v76, v76
    v_exp_f32 v77, v77
    v_exp_f32 v78, v78
    v_exp_f32 v79, v79
    v_exp_f32 v84, v84
    s_waitcnt lgkmcnt(3)
    v_mfma_f32_32x32x16_bf16 v[104:119], v[56:59], v[64:67], v[104:119]
    s_add_u32 m0, s37, 0
    s_nop 0
    buffer_load_dwordx4 v32, s[8:11], s42 offen sc1 lds
    buffer_load_dwordx4 v33, s[8:11], s42 offen offset:1024 sc1 lds
    s_mov_b32 exec_hi, 0
    buffer_load_dwordx4 v34, s[8:11], s42 offen offset:2048 sc1 lds
    s_mov_b32 exec_hi, -1
    s_add_u32 s42, s42, 327680
    v_exp_f32 v85, v85
    v_exp_f32 v86, v86
    v_exp_f32 v87, v87
    v_cvt_pk_bf16_f32 v68, v76, v77
    v_cvt_pk_bf16_f32 v69, v78, v79
    v_cvt_pk_bf16_f32 v70, v84, v85
    v_cvt_pk_bf16_f32 v71, v86, v87
    s_waitcnt lgkmcnt(2)
    v_mfma_f32_32x32x8_bf16 v[72:87], v[52:53], v[44:45], 0
    s_add_u32 m0, s53, 61440
    s_add_u32 s35, s53, s52
    buffer_load_dwordx4 v5, s[8:11], s35 offen sc1 lds
    buffer_load_dwordx4 v5, s[8:11], s35 offen offset:1024 sc1 lds
    s_add_u32 s53, s53, 16384
    v_exp_f32 v88, v88
    v_exp_f32 v89, v89
    v_exp_f32 v90, v90
    v_exp_f32 v91, v91
    v_exp_f32 v96, v96
    s_waitcnt lgkmcnt(1)
    v_mfma_f32_32x32x16_bf16 v[104:119], v[60:63], v[68:71], v[104:119]
    buffer_load_dwordx4 v[188:191], v5, s[8:11], s48 offen sc1
    s_add_u32 s48, s48, s89
    v_exp_f32 v97, v97
    v_exp_f32 v98, v98
    v_exp_f32 v99, v99
    v_cvt_pk_bf16_f32 v64, v88, v89
    v_cvt_pk_bf16_f32 v65, v90, v91
    v_cvt_pk_bf16_f32 v66, v96, v97
    v_cvt_pk_bf16_f32 v67, v98, v99
    s_waitcnt lgkmcnt(0)
    v_mfma_f32_32x32x16_bf16 v[72:87], v[48:51], v[36:39], v[72:87]
    buffer_load_dwordx4 v[192:195], v5, s[8:11], s48 offen sc1
    s_add_u32 s48, s48, s89
    v_exp_f32 v92, v92
    v_exp_f32 v93, v93
    v_exp_f32 v94, v94
    v_exp_f32 v95, v95
    v_exp_f32 v100, v100
    v_mfma_f32_32x32x16_bf16 v[120:135], v[56:59], v[64:67], v[120:135]
    s_mov_b64 exec, s[44:45]
    ds_read_b128 v[56:59], v24 offset:40960
    s_mov_b64 exec, -1
    v_exp_f32 v101, v101
    v_exp_f32 v102, v102
    v_exp_f32 v103, v103
    v_cvt_pk_bf16_f32 v68, v92, v93
    v_cvt_pk_bf16_f32 v69, v94, v95
    v_cvt_pk_bf16_f32 v70, v100, v101
    v_cvt_pk_bf16_f32 v71, v102, v103
    s_setprio 2
    v_mfma_f32_32x32x8_bf16 v[88:103], v[52:53], v[46:47], 0
    s_mov_b32 exec_hi, 0
    ds_read_b64 v[52:53], v23 offset:46080
    s_mov_b32 exec_hi, -1
    v_exp_f32 v72, v72
    v_exp_f32 v73, v73
    v_exp_f32 v74, v74
    v_exp_f32 v75, v75
    v_exp_f32 v80, v80
    v_mfma_f32_32x32x16_bf16 v[120:135], v[60:63], v[68:71], v[120:135]
    s_mov_b64 exec, s[44:45]
    ds_read_b128 v[60:63], v24 offset:41600
    s_mov_b64 exec, -1
    v_exp_f32 v81, v81
    v_exp_f32 v82, v82
    v_exp_f32 v83, v83
    v_cvt_pk_bf16_f32 v64, v72, v73
    v_cvt_pk_bf16_f32 v65, v74, v75
    v_cvt_pk_bf16_f32 v66, v80, v81
    v_cvt_pk_bf16_f32 v67, v82, v83
    v_mfma_f32_32x32x16_bf16 v[88:103], v[48:51], v[40:43], v[88:103]
    ds_read2st64_b64 v[48:51], v22 offset0:90 offset1:91
    v_exp_f32 v76, v76
    v_exp_f32 v77, v77
    v_exp_f32 v78, v78
    v_exp_f32 v79, v79
    v_exp_f32 v84, v84
    s_waitcnt lgkmcnt(3)
    v_mfma_f32_32x32x16_bf16 v[104:119], v[56:59], v[64:67], v[104:119]
    v_exp_f32 v85, v85
    v_exp_f32 v86, v86
    v_exp_f32 v87, v87
    v_cvt_pk_bf16_f32 v68, v76, v77
    v_cvt_pk_bf16_f32 v69, v78, v79
    v_cvt_pk_bf16_f32 v70, v84, v85
    v_cvt_pk_bf16_f32 v71, v86, v87
    s_waitcnt lgkmcnt(2)
    v_mfma_f32_32x32x8_bf16 v[72:87], v[52:53], v[44:45], 0
    s_cmp_eq_u32 s40, 0
    s_cselect_b32 s48, s90, s48
    buffer_load_dwordx4 v[196:199], v5, s[8:11], s48 offen sc1
    s_add_u32 s48, s48, s89
    v_exp_f32 v88, v88
    v_exp_f32 v89, v89
    v_exp_f32 v90, v90
    v_exp_f32 v91, v91
    v_exp_f32 v96, v96
    s_waitcnt lgkmcnt(1)
    v_mfma_f32_32x32x16_bf16 v[104:119], v[60:63], v[68:71], v[104:119]
    buffer_load_dwordx4 v[200:203], v5, s[8:11], s48 offen sc1
    s_add_u32 s48, s48, s89
    v_exp_f32 v97, v97
    v_exp_f32 v98, v98
    v_exp_f32 v99, v99
    v_cvt_pk_bf16_f32 v64, v88, v89
    v_cvt_pk_bf16_f32 v65, v90, v91
    v_cvt_pk_bf16_f32 v66, v96, v97
    v_cvt_pk_bf16_f32 v67, v98, v99
    s_waitcnt lgkmcnt(0)
    v_mfma_f32_32x32x16_bf16 v[72:87], v[48:51], v[36:39], v[72:87]
    s_add_u32 m0, s53, 61440
    s_add_u32 s35, s53, s52
    buffer_load_dwordx4 v5, s[8:11], s35 offen sc1 lds
    buffer_load_dwordx4 v5, s[8:11], s35 offen offset:1024 sc1 lds
    s_add_u32 s53, s53, 16384
    v_exp_f32 v92, v92
    v_exp_f32 v93, v93
    v_exp_f32 v94, v94
    v_exp_f32 v95, v95
    v_exp_f32 v100, v100
    v_mfma_f32_32x32x16_bf16 v[120:135], v[56:59], v[64:67], v[120:135]
    s_mov_b64 exec, s[44:45]
    ds_read_b128 v[56:59], v24 offset:46080
    s_mov_b64 exec, -1
    v_exp_f32 v101, v101
    v_exp_f32 v102, v102
    v_exp_f32 v103, v103
    v_cvt_pk_bf16_f32 v68, v92, v93
    v_cvt_pk_bf16_f32 v69, v94, v95
    v_cvt_pk_bf16_f32 v70, v100, v101
    v_cvt_pk_bf16_f32 v71, v102, v103
    s_setprio 1
    v_mfma_f32_32x32x8_bf16 v[88:103], v[52:53], v[46:47], 0
    s_mov_b32 exec_hi, 0
    ds_read_b64 v[52:53], v23 offset:51200
    s_mov_b32 exec_hi, -1
    v_exp_f32 v72, v72
    v_exp_f32 v73, v73
    v_exp_f32 v74, v74
    v_exp_f32 v75, v75
    v_exp_f32 v80, v80
    v_mfma_f32_32x32x16_bf16 v[120:135], v[60:63], v[68:71], v[120:135]
    s_mov_b64 exec, s[44:45]
    ds_read_b128 v[60:63], v24 offset:46720
    s_mov_b64 exec, -1
    v_exp_f32 v81, v81
    v_exp_f32 v82, v82
    v_exp_f32 v83, v83
    v_cvt_pk_bf16_f32 v64, v72, v73
    v_cvt_pk_bf16_f32 v65, v74, v75
    v_cvt_pk_bf16_f32 v66, v80, v81
    v_cvt_pk_bf16_f32 v67, v82, v83
    v_mfma_f32_32x32x16_bf16 v[88:103], v[48:51], v[40:43], v[88:103]
    ds_read2st64_b64 v[48:51], v22 offset0:100 offset1:101
    v_exp_f32 v76, v76
    v_exp_f32 v77, v77
    v_exp_f32 v78, v78
    v_exp_f32 v79, v79
    v_exp_f32 v84, v84
    s_waitcnt lgkmcnt(3)
    v_mfma_f32_32x32x16_bf16 v[104:119], v[56:59], v[64:67], v[104:119]
    v_exp_f32 v85, v85
    v_exp_f32 v86, v86
    v_exp_f32 v87, v87
    v_cvt_pk_bf16_f32 v68, v76, v77
    v_cvt_pk_bf16_f32 v69, v78, v79
    v_cvt_pk_bf16_f32 v70, v84, v85
    v_cvt_pk_bf16_f32 v71, v86, v87
    s_waitcnt lgkmcnt(2)
    v_mfma_f32_32x32x8_bf16 v[72:87], v[52:53], v[44:45], 0
    buffer_load_dwordx4 v[204:207], v5, s[8:11], s48 offen sc1
    s_add_u32 s48, s48, s89
    v_exp_f32 v88, v88
    v_exp_f32 v89, v89
    v_exp_f32 v90, v90
    v_exp_f32 v91, v91
    v_exp_f32 v96, v96
    s_waitcnt lgkmcnt(1)
    v_mfma_f32_32x32x16_bf16 v[104:119], v[60:63], v[68:71], v[104:119]
    s_cmp_ge_u32 s32, 6
    s_cselect_b32 s35, 2048, 0
    s_sub_u32 s48, s48, s35
    buffer_load_dwordx4 v[208:211], v5, s[8:11], s48 offen sc1
    s_add_u32 s48, s48, s89
    v_exp_f32 v97, v97
    v_exp_f32 v98, v98
    v_exp_f32 v99, v99
    v_cvt_pk_bf16_f32 v64, v88, v89
    v_cvt_pk_bf16_f32 v65, v90, v91
    v_cvt_pk_bf16_f32 v66, v96, v97
    v_cvt_pk_bf16_f32 v67, v98, v99
    s_waitcnt lgkmcnt(0)
    v_mfma_f32_32x32x16_bf16 v[72:87], v[48:51], v[36:39], v[72:87]
    s_cmp_eq_u32 s40, 1
    s_cselect_b32 s48, s90, s48
    s_movk_i32 s89, 1024
    buffer_load_dwordx4 v[212:215], v5, s[8:11], s48 offen sc1
    s_add_u32 s48, s48, s89
    v_exp_f32 v92, v92
    v_exp_f32 v93, v93
    v_exp_f32 v94, v94
    v_exp_f32 v95, v95
    v_exp_f32 v100, v100
    v_mfma_f32_32x32x16_bf16 v[120:135], v[56:59], v[64:67], v[120:135]
    s_mov_b64 exec, s[44:45]
    ds_read_b128 v[56:59], v24 offset:51200
    s_mov_b64 exec, -1
    v_exp_f32 v101, v101
    v_exp_f32 v102, v102
    v_exp_f32 v103, v103
    v_cvt_pk_bf16_f32 v68, v92, v93
    v_cvt_pk_bf16_f32 v69, v94, v95
    v_cvt_pk_bf16_f32 v70, v100, v101
    v_cvt_pk_bf16_f32 v71, v102, v103
    s_setprio 0
    v_mfma_f32_32x32x8_bf16 v[88:103], v[52:53], v[46:47], 0
    s_mov_b32 exec_hi, 0
    ds_read_b64 v[52:53], v23 offset:56320
    s_mov_b32 exec_hi, -1
    v_exp_f32 v72, v72
    v_exp_f32 v73, v73
    v_exp_f32 v74, v74
    v_exp_f32 v75, v75
    v_exp_f32 v80, v80
    v_mfma_f32_32x32x16_bf16 v[120:135], v[60:63], v[68:71], v[120:135]
    s_mov_b64 exec, s[44:45]
    ds_read_b128 v[60:63], v24 offset:51840
    s_mov_b64 exec, -1
    v_exp_f32 v81, v81
    v_exp_f32 v82, v82
    v_exp_f32 v83, v83
    v_cvt_pk_bf16_f32 v64, v72, v73
    v_cvt_pk_bf16_f32 v65, v74, v75
    v_cvt_pk_bf16_f32 v66, v80, v81
    v_cvt_pk_bf16_f32 v67, v82, v83
    v_mfma_f32_32x32x16_bf16 v[88:103], v[48:51], v[40:43], v[88:103]
    ds_read2st64_b64 v[48:51], v22 offset0:110 offset1:111
    v_exp_f32 v76, v76
    v_exp_f32 v77, v77
    v_exp_f32 v78, v78
    v_exp_f32 v79, v79
    v_exp_f32 v84, v84
    s_waitcnt lgkmcnt(3)
    v_mfma_f32_32x32x16_bf16 v[104:119], v[56:59], v[64:67], v[104:119]
    v_exp_f32 v85, v85
    v_exp_f32 v86, v86
    v_exp_f32 v87, v87
    v_cvt_pk_bf16_f32 v68, v76, v77
    v_cvt_pk_bf16_f32 v69, v78, v79
    v_cvt_pk_bf16_f32 v70, v84, v85
    v_cvt_pk_bf16_f32 v71, v86, v87
    s_waitcnt lgkmcnt(2)
    v_mfma_f32_32x32x8_bf16 v[72:87], v[52:53], v[44:45], 0
    buffer_load_dwordx4 v[216:219], v5, s[8:11], s48 offen sc1
    s_add_u32 s48, s48, s89
    v_exp_f32 v88, v88
    v_exp_f32 v89, v89
    v_exp_f32 v90, v90
    v_exp_f32 v91, v91
    v_exp_f32 v96, v96
    s_waitcnt lgkmcnt(1)
    v_mfma_f32_32x32x16_bf16 v[104:119], v[60:63], v[68:71], v[104:119]
    s_add_u32 m0, s53, 61440
    s_add_u32 s35, s53, s52
    buffer_load_dwordx4 v5, s[8:11], s35 offen sc1 lds
    buffer_load_dwordx4 v5, s[8:11], s35 offen offset:1024 sc1 lds
    s_add_u32 s53, s53, 16384
    v_exp_f32 v97, v97
    v_exp_f32 v98, v98
    v_exp_f32 v99, v99
    v_cvt_pk_bf16_f32 v64, v88, v89
    v_cvt_pk_bf16_f32 v65, v90, v91
    v_cvt_pk_bf16_f32 v66, v96, v97
    v_cvt_pk_bf16_f32 v67, v98, v99
    s_waitcnt lgkmcnt(0)
    v_mfma_f32_32x32x16_bf16 v[72:87], v[48:51], v[36:39], v[72:87]
    buffer_load_dwordx4 v[220:223], v5, s[8:11], s48 offen sc1
    s_add_u32 s48, s48, s89
    v_exp_f32 v92, v92
    v_exp_f32 v93, v93
    v_exp_f32 v94, v94
    v_exp_f32 v95, v95
    v_exp_f32 v100, v100
    v_mfma_f32_32x32x16_bf16 v[120:135], v[56:59], v[64:67], v[120:135]
    s_mov_b64 exec, s[44:45]
    ds_read_b128 v[56:59], v24 offset:56320
    s_mov_b64 exec, -1
    v_exp_f32 v101, v101
    v_exp_f32 v102, v102
    v_exp_f32 v103, v103
    v_cvt_pk_bf16_f32 v68, v92, v93
    v_cvt_pk_bf16_f32 v69, v94, v95
    v_cvt_pk_bf16_f32 v70, v100, v101
    v_cvt_pk_bf16_f32 v71, v102, v103
    s_waitcnt vmcnt(15)
    s_barrier
    s_setprio 3
    v_mfma_f32_32x32x8_bf16 v[88:103], v[52:53], v[46:47], 0
    s_mov_b32 exec_hi, 0
    ds_read_b64 v[52:53], v23 offset:0
    s_mov_b32 exec_hi, -1
    v_exp_f32 v72, v72
    v_exp_f32 v73, v73
    v_exp_f32 v74, v74
    v_exp_f32 v75, v75
    v_exp_f32 v80, v80
    v_mfma_f32_32x32x16_bf16 v[120:135], v[60:63], v[68:71], v[120:135]
    s_mov_b64 exec, s[44:45]
    ds_read_b128 v[60:63], v24 offset:56960
    s_mov_b64 exec, -1
    v_exp_f32 v81, v81
    v_exp_f32 v82, v82
    v_exp_f32 v83, v83
    v_cvt_pk_bf16_f32 v64, v72, v73
    v_cvt_pk_bf16_f32 v65, v74, v75
    v_cvt_pk_bf16_f32 v66, v80, v81
    v_cvt_pk_bf16_f32 v67, v82, v83
    v_mfma_f32_32x32x16_bf16 v[88:103], v[48:51], v[40:43], v[88:103]
    ds_read2st64_b64 v[48:51], v22 offset0:0 offset1:1
    v_exp_f32 v76, v76
    v_exp_f32 v77, v77
    v_exp_f32 v78, v78
    v_exp_f32 v79, v79
    v_exp_f32 v84, v84
    s_waitcnt lgkmcnt(3)
    v_mfma_f32_32x32x16_bf16 v[104:119], v[56:59], v[64:67], v[104:119]
    s_add_u32 m0, s37, 20480
    s_nop 0
    buffer_load_dwordx4 v32, s[8:11], s42 offen sc1 lds
    buffer_load_dwordx4 v33, s[8:11], s42 offen offset:1024 sc1 lds
    s_mov_b32 exec_hi, 0
    buffer_load_dwordx4 v34, s[8:11], s42 offen offset:2048 sc1 lds
    s_mov_b32 exec_hi, -1
    s_add_u32 s42, s42, 327680
    v_exp_f32 v85, v85
    v_exp_f32 v86, v86
    v_exp_f32 v87, v87
    v_cvt_pk_bf16_f32 v68, v76, v77
    v_cvt_pk_bf16_f32 v69, v78, v79
    v_cvt_pk_bf16_f32 v70, v84, v85
    v_cvt_pk_bf16_f32 v71, v86, v87
    s_waitcnt lgkmcnt(2)
    v_mfma_f32_32x32x8_bf16 v[72:87], v[52:53], v[44:45], 0
    buffer_load_dwordx4 v[224:227], v5, s[8:11], s48 offen sc1
    s_add_u32 s48, s48, s89
    v_exp_f32 v88, v88
    v_exp_f32 v89, v89
    v_exp_f32 v90, v90
    v_exp_f32 v91, v91
    v_exp_f32 v96, v96
    s_waitcnt lgkmcnt(1)
    v_mfma_f32_32x32x16_bf16 v[104:119], v[60:63], v[68:71], v[104:119]
    buffer_load_dwordx4 v[228:231], v5, s[8:11], s48 offen sc1
    s_add_u32 s48, s48, s89
    v_exp_f32 v97, v97
    v_exp_f32 v98, v98
    v_exp_f32 v99, v99
    v_cvt_pk_bf16_f32 v64, v88, v89
    v_cvt_pk_bf16_f32 v65, v90, v91
    v_cvt_pk_bf16_f32 v66, v96, v97
    v_cvt_pk_bf16_f32 v67, v98, v99
    s_waitcnt lgkmcnt(0)
    v_mfma_f32_32x32x16_bf16 v[72:87], v[48:51], v[36:39], v[72:87]
    buffer_load_dwordx4 v[232:235], v5, s[8:11], s48 offen sc1
    s_add_u32 s48, s48, s89
    v_exp_f32 v92, v92
    v_exp_f32 v93, v93
    v_exp_f32 v94, v94
    v_exp_f32 v95, v95
    v_exp_f32 v100, v100
    v_mfma_f32_32x32x16_bf16 v[120:135], v[56:59], v[64:67], v[120:135]
    s_mov_b64 exec, s[44:45]
    ds_read_b128 v[56:59], v24 offset:0
    s_mov_b64 exec, -1
    v_exp_f32 v101, v101
    v_exp_f32 v102, v102
    v_exp_f32 v103, v103
    v_cvt_pk_bf16_f32 v68, v92, v93
    v_cvt_pk_bf16_f32 v69, v94, v95
    v_cvt_pk_bf16_f32 v70, v100, v101
    v_cvt_pk_bf16_f32 v71, v102, v103
    s_setprio 2
    v_mfma_f32_32x32x8_bf16 v[88:103], v[52:53], v[46:47], 0
    s_mov_b32 exec_hi, 0
    ds_read_b64 v[52:53], v23 offset:5120
    s_mov_b32 exec_hi, -1
    v_exp_f32 v72, v72
    v_exp_f32 v73, v73
    v_exp_f32 v74, v74
    v_exp_f32 v75, v75
    v_exp_f32 v80, v80
    v_mfma_f32_32x32x16_bf16 v[120:135], v[60:63], v[68:71], v[120:135]
    s_mov_b64 exec, s[44:45]
    ds_read_b128 v[60:63], v24 offset:640
    s_mov_b64 exec, -1
    v_exp_f32 v81, v81
    v_exp_f32 v82, v82
    v_exp_f32 v83, v83
    v_cvt_pk_bf16_f32 v64, v72, v73
    v_cvt_pk_bf16_f32 v65, v74, v75
    v_cvt_pk_bf16_f32 v66, v80, v81
    v_cvt_pk_bf16_f32 v67, v82, v83
    v_mfma_f32_32x32x16_bf16 v[88:103], v[48:51], v[40:43], v[88:103]
    ds_read2st64_b64 v[48:51], v22 offset0:10 offset1:11
    v_exp_f32 v76, v76
    v_exp_f32 v77, v77
    v_exp_f32 v78, v78
    v_exp_f32 v79, v79
    v_exp_f32 v84, v84
    s_waitcnt lgkmcnt(3)
    v_mfma_f32_32x32x16_bf16 v[104:119], v[56:59], v[64:67], v[104:119]
    v_exp_f32 v85, v85
    v_exp_f32 v86, v86
    v_exp_f32 v87, v87
    v_cvt_pk_bf16_f32 v68, v76, v77
    v_cvt_pk_bf16_f32 v69, v78, v79
    v_cvt_pk_bf16_f32 v70, v84, v85
    v_cvt_pk_bf16_f32 v71, v86, v87
    s_waitcnt lgkmcnt(2)
    v_mfma_f32_32x32x8_bf16 v[72:87], v[52:53], v[44:45], 0
    s_min_u32 s53, s53, 100352
    s_add_u32 m0, s53, 61440
    s_add_u32 s35, s53, s52
    buffer_load_dwordx4 v5, s[8:11], s35 offen sc1 lds
    buffer_load_dwordx4 v5, s[8:11], s35 offen offset:1024 sc1 lds
    s_add_u32 s53, s53, 16384
    v_exp_f32 v88, v88
    v_exp_f32 v89, v89
    v_exp_f32 v90, v90
    v_exp_f32 v91, v91
    v_exp_f32 v96, v96
    s_waitcnt lgkmcnt(1)
    v_mfma_f32_32x32x16_bf16 v[104:119], v[60:63], v[68:71], v[104:119]
    s_cmp_eq_u32 s40, 0
    s_cbranch_scc1 L_f_sx24
    buffer_load_dwordx4 v[236:239], v5, s[8:11], s48 offen sc1
    s_branch L_f_sy24
L_f_sx24:
    buffer_load_dwordx2 v[236:237], v30, s[12:15], s66 offen offset:0
    buffer_load_dwordx2 v[246:247], v31, s[16:19], s101 offen offset:0
L_f_sy24:
    s_add_u32 s48, s48, s89
    v_exp_f32 v97, v97
    v_exp_f32 v98, v98
    v_exp_f32 v99, v99
    v_cvt_pk_bf16_f32 v64, v88, v89
    v_cvt_pk_bf16_f32 v65, v90, v91
    v_cvt_pk_bf16_f32 v66, v96, v97
    v_cvt_pk_bf16_f32 v67, v98, v99
    s_waitcnt lgkmcnt(0)
    v_mfma_f32_32x32x16_bf16 v[72:87], v[48:51], v[36:39], v[72:87]
    s_cmp_eq_u32 s40, 0
    s_cbranch_scc1 L_f_sx25
    buffer_load_dwordx4 v[240:243], v5, s[8:11], s48 offen sc1
    s_branch L_f_sy25
L_f_sx25:
    buffer_load_dwordx2 v[238:239], v30, s[12:15], s66 offen offset:32
    buffer_load_dwordx2 v[248:249], v31, s[16:19], s101 offen offset:32
L_f_sy25:
    s_add_u32 s48, s48, s89
    v_exp_f32 v92, v92
    v_exp_f32 v93, v93
    v_exp_f32 v94, v94
    v_exp_f32 v95, v95
    v_exp_f32 v100, v100
    v_mfma_f32_32x32x16_bf16 v[120:135], v[56:59], v[64:67], v[120:135]
    s_mov_b64 exec, s[44:45]
    ds_read_b128 v[56:59], v24 offset:5120
    s_mov_b64 exec, -1
    v_exp_f32 v101, v101
    v_exp_f32 v102, v102
    v_exp_f32 v103, v103
    v_cvt_pk_bf16_f32 v68, v92, v93
    v_cvt_pk_bf16_f32 v69, v94, v95
    v_cvt_pk_bf16_f32 v70, v100, v101
    v_cvt_pk_bf16_f32 v71, v102, v103
    s_setprio 1
    v_mfma_f32_32x32x8_bf16 v[88:103], v[52:53], v[46:47], 0
    s_mov_b32 exec_hi, 0
    ds_read_b64 v[52:53], v23 offset:10240
    s_mov_b32 exec_hi, -1
    v_exp_f32 v72, v72
    v_exp_f32 v73, v73
    v_exp_f32 v74, v74
    v_exp_f32 v75, v75
    v_exp_f32 v80, v80
    v_mfma_f32_32x32x16_bf16 v[120:135], v[60:63], v[68:71], v[120:135]
    s_mov_b64 exec, s[44:45]
    ds_read_b128 v[60:63], v24 offset:5760
    s_mov_b64 exec, -1
    v_exp_f32 v81, v81
    v_exp_f32 v82, v82
    v_exp_f32 v83, v83
    v_cvt_pk_bf16_f32 v64, v72, v73
    v_cvt_pk_bf16_f32 v65, v74, v75
    v_cvt_pk_bf16_f32 v66, v80, v81
    v_cvt_pk_bf16_f32 v67, v82, v83
    v_mfma_f32_32x32x16_bf16 v[88:103], v[48:51], v[40:43], v[88:103]
    ds_read2st64_b64 v[48:51], v22 offset0:20 offset1:21
    v_exp_f32 v76, v76
    v_exp_f32 v77, v77
    v_exp_f32 v78, v78
    v_exp_f32 v79, v79
    v_exp_f32 v84, v84
    s_waitcnt lgkmcnt(3)
    v_mfma_f32_32x32x16_bf16 v[104:119], v[56:59], v[64:67], v[104:119]
    v_exp_f32 v85, v85
    v_exp_f32 v86, v86
    v_exp_f32 v87, v87
    v_cvt_pk_bf16_f32 v68, v76, v77
    v_cvt_pk_bf16_f32 v69, v78, v79
    v_cvt_pk_bf16_f32 v70, v84, v85
    v_cvt_pk_bf16_f32 v71, v86, v87
    s_waitcnt lgkmcnt(2)
    v_mfma_f32_32x32x8_bf16 v[72:87], v[52:53], v[44:45], 0
    s_cmp_eq_u32 s40, 0
    s_cbranch_scc1 L_f_sx26
    buffer_load_dwordx4 v[244:247], v5, s[8:11], s48 offen sc1
    s_branch L_f_sy26
L_f_sx26:
    buffer_load_dwordx2 v[240:241], v30, s[12:15], s66 offen offset:64
    buffer_load_dwordx2 v[250:251], v31, s[16:19], s101 offen offset:64
L_f_sy26:
    s_add_u32 s48, s48, s89
    v_exp_f32 v88, v88
    v_exp_f32 v89, v89
    v_exp_f32 v90, v90
    v_exp_f32 v91, v91
    v_exp_f32 v96, v96
    s_waitcnt lgkmcnt(1)
    v_mfma_f32_32x32x16_bf16 v[104:119], v[60:63], v[68:71], v[104:119]
    s_cmp_eq_u32 s40, 0
    s_cbranch_scc1 L_f_sx27
    buffer_load_dwordx4 v[248:251], v5, s[8:11], s48 offen sc1
    s_branch L_f_sy27
L_f_sx27:
    buffer_load_dwordx2 v[242:243], v30, s[12:15], s66 offen offset:96
    buffer_load_dwordx2 v[252:253], v31, s[16:19], s101 offen offset:96
L_f_sy27:
    s_add_u32 s48, s48, s89
    v_exp_f32 v97, v97
    v_exp_f32 v98, v98
    v_exp_f32 v99, v99
    v_cvt_pk_bf16_f32 v64, v88, v89
    v_cvt_pk_bf16_f32 v65, v90, v91
    v_cvt_pk_bf16_f32 v66, v96, v97
    v_cvt_pk_bf16_f32 v67, v98, v99
    s_waitcnt lgkmcnt(0)
    v_mfma_f32_32x32x16_bf16 v[72:87], v[48:51], v[36:39], v[72:87]
    s_cmp_eq_u32 s40, 0
    s_cbranch_scc1 L_f_sx28
    buffer_load_dwordx4 v[252:255], v5, s[8:11], s48 offen sc1
    s_branch L_f_sy28
L_f_sx28:
    buffer_load_dwordx2 v[244:245], v30, s[12:15], s67 offen
    buffer_load_dwordx2 v[254:255], v31, s[16:19], s88 offen
L_f_sy28:
    s_add_u32 s48, s48, s89
    v_exp_f32 v92, v92
    v_exp_f32 v93, v93
    v_exp_f32 v94, v94
    v_exp_f32 v95, v95
    v_exp_f32 v100, v100
    v_mfma_f32_32x32x16_bf16 v[120:135], v[56:59], v[64:67], v[120:135]
    s_mov_b64 exec, s[44:45]
    ds_read_b128 v[56:59], v24 offset:10240
    s_mov_b64 exec, -1
    v_exp_f32 v101, v101
    v_exp_f32 v102, v102
    v_exp_f32 v103, v103
    v_cvt_pk_bf16_f32 v68, v92, v93
    v_cvt_pk_bf16_f32 v69, v94, v95
    v_cvt_pk_bf16_f32 v70, v100, v101
    v_cvt_pk_bf16_f32 v71, v102, v103
    s_setprio 0
    v_mfma_f32_32x32x8_bf16 v[88:103], v[52:53], v[46:47], 0
    s_mov_b32 exec_hi, 0
    ds_read_b64 v[52:53], v23 offset:15360
    s_mov_b32 exec_hi, -1
    v_exp_f32 v72, v72
    v_exp_f32 v73, v73
    v_exp_f32 v74, v74
    v_exp_f32 v75, v75
    v_exp_f32 v80, v80
    v_mfma_f32_32x32x16_bf16 v[120:135], v[60:63], v[68:71], v[120:135]
    s_mov_b64 exec, s[44:45]
    ds_read_b128 v[60:63], v24 offset:10880
    s_mov_b64 exec, -1
    v_exp_f32 v81, v81
    v_exp_f32 v82, v82
    v_exp_f32 v83, v83
    v_cvt_pk_bf16_f32 v64, v72, v73
    v_cvt_pk_bf16_f32 v65, v74, v75
    v_cvt_pk_bf16_f32 v66, v80, v81
    v_cvt_pk_bf16_f32 v67, v82, v83
    v_mfma_f32_32x32x16_bf16 v[88:103], v[48:51], v[40:43], v[88:103]
    ds_read2st64_b64 v[48:51], v22 offset0:30 offset1:31
    v_exp_f32 v76, v76
    v_exp_f32 v77, v77
    v_exp_f32 v78, v78
    v_exp_f32 v79, v79
    v_exp_f32 v84, v84
    s_waitcnt lgkmcnt(3)
    v_mfma_f32_32x32x16_bf16 v[104:119], v[56:59], v[64:67], v[104:119]
    v_exp_f32 v85, v85
    v_exp_f32 v86, v86
    v_exp_f32 v87, v87
    v_cvt_pk_bf16_f32 v68, v76, v77
    v_cvt_pk_bf16_f32 v69, v78, v79
    v_cvt_pk_bf16_f32 v70, v84, v85
    v_cvt_pk_bf16_f32 v71, v86, v87
    s_waitcnt lgkmcnt(2)
    v_mfma_f32_32x32x8_bf16 v[72:87], v[52:53], v[44:45], 0
    v_exp_f32 v88, v88
    v_exp_f32 v89, v89
    v_exp_f32 v90, v90
    v_exp_f32 v91, v91
    v_exp_f32 v96, v96
    s_waitcnt lgkmcnt(1)
    v_mfma_f32_32x32x16_bf16 v[104:119], v[60:63], v[68:71], v[104:119]
    v_exp_f32 v97, v97
    v_exp_f32 v98, v98
    v_exp_f32 v99, v99
    v_cvt_pk_bf16_f32 v64, v88, v89
    v_cvt_pk_bf16_f32 v65, v90, v91
    v_cvt_pk_bf16_f32 v66, v96, v97
    v_cvt_pk_bf16_f32 v67, v98, v99
    s_waitcnt lgkmcnt(0)
    v_mfma_f32_32x32x16_bf16 v[72:87], v[48:51], v[36:39], v[72:87]
    v_exp_f32 v92, v92
    v_exp_f32 v93, v93
    v_exp_f32 v94, v94
    v_exp_f32 v95, v95
    v_exp_f32 v100, v100
    v_mfma_f32_32x32x16_bf16 v[120:135], v[56:59], v[64:67], v[120:135]
    s_mov_b64 exec, s[44:45]
    ds_read_b128 v[56:59], v24 offset:15360
    s_mov_b64 exec, -1
    v_exp_f32 v101, v101
    v_exp_f32 v102, v102
    v_exp_f32 v103, v103
    v_cvt_pk_bf16_f32 v68, v92, v93
    v_cvt_pk_bf16_f32 v69, v94, v95
    v_cvt_pk_bf16_f32 v70, v100, v101
    v_cvt_pk_bf16_f32 v71, v102, v103
    s_waitcnt vmcnt(10)
    s_barrier
    s_setprio 3
    v_mfma_f32_32x32x8_bf16 v[88:103], v[52:53], v[46:47], 0
    s_mov_b32 exec_hi, 0
    ds_read_b64 v[52:53], v23 offset:20480
    s_mov_b32 exec_hi, -1
    v_exp_f32 v72, v72
    v_exp_f32 v73, v73
    v_exp_f32 v74, v74
    v_exp_f32 v75, v75
    v_exp_f32 v80, v80
    v_mfma_f32_32x32x16_bf16 v[120:135], v[60:63], v[68:71], v[120:135]
    s_mov_b64 exec, s[44:45]
    ds_read_b128 v[60:63], v24 offset:16000
    s_mov_b64 exec, -1
    v_exp_f32 v81, v81
    v_exp_f32 v82, v82
    v_exp_f32 v83, v83
    v_cvt_pk_bf16_f32 v64, v72, v73
    v_cvt_pk_bf16_f32 v65, v74, v75
    v_cvt_pk_bf16_f32 v66, v80, v81
    v_cvt_pk_bf16_f32 v67, v82, v83
    v_mfma_f32_32x32x16_bf16 v[88:103], v[48:51], v[40:43], v[88:103]
    ds_read2st64_b64 v[48:51], v22 offset0:40 offset1:41
    v_exp_f32 v76, v76
    v_exp_f32 v77, v77
    v_exp_f32 v78, v78
    v_exp_f32 v79, v79
    v_exp_f32 v84, v84
    s_waitcnt lgkmcnt(3)
    v_mfma_f32_32x32x16_bf16 v[104:119], v[56:59], v[64:67], v[104:119]
    v_exp_f32 v85, v85
    v_exp_f32 v86, v86
    v_exp_f32 v87, v87
    v_cvt_pk_bf16_f32 v68, v76, v77
    v_cvt_pk_bf16_f32 v69, v78, v79
    v_cvt_pk_bf16_f32 v70, v84, v85
    v_cvt_pk_bf16_f32 v71, v86, v87
    s_waitcnt lgkmcnt(2)
    v_mfma_f32_32x32x8_bf16 v[72:87], v[52:53], v[44:45], 0
    v_exp_f32 v88, v88
    v_exp_f32 v89, v89
    v_exp_f32 v90, v90
    v_exp_f32 v91, v91
    v_exp_f32 v96, v96
    s_waitcnt lgkmcnt(1)
    v_mfma_f32_32x32x16_bf16 v[104:119], v[60:63], v[68:71], v[104:119]
    v_exp_f32 v97, v97
    v_exp_f32 v98, v98
    v_exp_f32 v99, v99
    v_cvt_pk_bf16_f32 v64, v88, v89
    v_cvt_pk_bf16_f32 v65, v90, v91
    v_cvt_pk_bf16_f32 v66, v96, v97
    v_cvt_pk_bf16_f32 v67, v98, v99
    s_waitcnt lgkmcnt(0)
    v_mfma_f32_32x32x16_bf16 v[72:87], v[48:51], v[36:39], v[72:87]
    v_exp_f32 v92, v92
    v_exp_f32 v93, v93
    v_exp_f32 v94, v94
    v_exp_f32 v95, v95
    v_exp_f32 v100, v100
    v_mfma_f32_32x32x16_bf16 v[120:135], v[56:59], v[64:67], v[120:135]
    s_mov_b64 exec, s[44:45]
    ds_read_b128 v[56:59], v24 offset:20480
    s_mov_b64 exec, -1
    v_exp_f32 v101, v101
    v_exp_f32 v102, v102
    v_exp_f32 v103, v103
    v_cvt_pk_bf16_f32 v68, v92, v93
    v_cvt_pk_bf16_f32 v69, v94, v95
    v_cvt_pk_bf16_f32 v70, v100, v101
    v_cvt_pk_bf16_f32 v71, v102, v103
    s_setprio 2
    v_mfma_f32_32x32x8_bf16 v[88:103], v[52:53], v[46:47], 0
    s_mov_b32 exec_hi, 0
    ds_read_b64 v[52:53], v23 offset:25600
    s_mov_b32 exec_hi, -1
    v_exp_f32 v72, v72
    v_exp_f32 v73, v73
    v_exp_f32 v74, v74
    v_exp_f32 v75, v75
    v_exp_f32 v80, v80
    v_mfma_f32_32x32x16_bf16 v[120:135], v[60:63], v[68:71], v[120:135]
    s_mov_b64 exec, s[44:45]
    ds_read_b128 v[60:63], v24 offset:21120
    s_mov_b64 exec, -1
    v_exp_f32 v81, v81
    v_exp_f32 v82, v82
    v_exp_f32 v83, v83
    v_cvt_pk_bf16_f32 v64, v72, v73
    v_cvt_pk_bf16_f32 v65, v74, v75
    v_cvt_pk_bf16_f32 v66, v80, v81
    v_cvt_pk_bf16_f32 v67, v82, v83
    v_mfma_f32_32x32x16_bf16 v[88:103], v[48:51], v[40:43], v[88:103]
    ds_read2st64_b64 v[48:51], v22 offset0:50 offset1:51
    v_exp_f32 v76, v76
    v_exp_f32 v77, v77
    v_exp_f32 v78, v78
    v_exp_f32 v79, v79
    v_exp_f32 v84, v84
    s_waitcnt lgkmcnt(3)
    v_mfma_f32_32x32x16_bf16 v[104:119], v[56:59], v[64:67], v[104:119]
    v_exp_f32 v85, v85
    v_exp_f32 v86, v86
    v_exp_f32 v87, v87
    v_cvt_pk_bf16_f32 v68, v76, v77
    v_cvt_pk_bf16_f32 v69, v78, v79
    v_cvt_pk_bf16_f32 v70, v84, v85
    v_cvt_pk_bf16_f32 v71, v86, v87
    s_waitcnt lgkmcnt(2)
    v_mfma_f32_32x32x8_bf16 v[72:87], v[52:53], v[44:45], 0
    v_exp_f32 v88, v88
    v_exp_f32 v89, v89
    v_exp_f32 v90, v90
    v_exp_f32 v91, v91
    v_exp_f32 v96, v96
    s_waitcnt lgkmcnt(1)
    v_mfma_f32_32x32x16_bf16 v[104:119], v[60:63], v[68:71], v[104:119]
    v_exp_f32 v97, v97
    v_exp_f32 v98, v98
    v_exp_f32 v99, v99
    v_cvt_pk_bf16_f32 v64, v88, v89
    v_cvt_pk_bf16_f32 v65, v90, v91
    v_cvt_pk_bf16_f32 v66, v96, v97
    v_cvt_pk_bf16_f32 v67, v98, v99
    s_waitcnt lgkmcnt(0)
    v_mfma_f32_32x32x16_bf16 v[72:87], v[48:51], v[36:39], v[72:87]
    v_exp_f32 v92, v92
    v_exp_f32 v93, v93
    v_exp_f32 v94, v94
    v_exp_f32 v95, v95
    v_exp_f32 v100, v100
    v_mfma_f32_32x32x16_bf16 v[120:135], v[56:59], v[64:67], v[120:135]
    s_mov_b64 exec, s[44:45]
    ds_read_b128 v[56:59], v24 offset:25600
    s_mov_b64 exec, -1
    v_exp_f32 v101, v101
    v_exp_f32 v102, v102
    v_exp_f32 v103, v103
    v_cvt_pk_bf16_f32 v68, v92, v93
    v_cvt_pk_bf16_f32 v69, v94, v95
    v_cvt_pk_bf16_f32 v70, v100, v101
    v_cvt_pk_bf16_f32 v71, v102, v103
    s_setprio 1
    v_mfma_f32_32x32x8_bf16 v[88:103], v[52:53], v[46:47], 0
    s_mov_b32 exec_hi, 0
    ds_read_b64 v[52:53], v23 offset:30720
    s_mov_b32 exec_hi, -1
    v_exp_f32 v72, v72
    v_exp_f32 v73, v73
    v_exp_f32 v74, v74
    v_exp_f32 v75, v75
    v_exp_f32 v80, v80
    v_mfma_f32_32x32x16_bf16 v[120:135], v[60:63], v[68:71], v[120:135]
    s_mov_b64 exec, s[44:45]
    ds_read_b128 v[60:63], v24 offset:26240
    s_mov_b64 exec, -1
    v_exp_f32 v81, v81
    v_exp_f32 v82, v82
    v_exp_f32 v83, v83
    v_cvt_pk_bf16_f32 v64, v72, v73
    v_cvt_pk_bf16_f32 v65, v74, v75
    v_cvt_pk_bf16_f32 v66, v80, v81
    v_cvt_pk_bf16_f32 v67, v82, v83
    v_mfma_f32_32x32x16_bf16 v[88:103], v[48:51], v[40:43], v[88:103]
    ds_read2st64_b64 v[48:51], v22 offset0:60 offset1:61
    v_exp_f32 v76, v76
    v_exp_f32 v77, v77
    v_exp_f32 v78, v78
    v_exp_f32 v79, v79
    v_exp_f32 v84, v84
    s_waitcnt lgkmcnt(3)
    v_mfma_f32_32x32x16_bf16 v[104:119], v[56:59], v[64:67], v[104:119]
    v_exp_f32 v85, v85
    v_exp_f32 v86, v86
    v_exp_f32 v87, v87
    v_cvt_pk_bf16_f32 v68, v76, v77
    v_cvt_pk_bf16_f32 v69, v78, v79
    v_cvt_pk_bf16_f32 v70, v84, v85
    v_cvt_pk_bf16_f32 v71, v86, v87
    s_waitcnt lgkmcnt(2)
    v_mfma_f32_32x32x8_bf16 v[72:87], v[52:53], v[44:45], 0
    buffer_load_dword v27, v26, s[8:11], s54 offen sc1
    s_add_u32 s54, s54, 10240
    v_exp_f32 v88, v88
    v_exp_f32 v89, v89
    v_exp_f32 v90, v90
    v_exp_f32 v91, v91
    v_exp_f32 v96, v96
    s_waitcnt lgkmcnt(1)
    v_mfma_f32_32x32x16_bf16 v[104:119], v[60:63], v[68:71], v[104:119]
    buffer_load_dword v27, v26, s[8:11], s54 offen sc1
    s_add_u32 s54, s54, 10240
    v_exp_f32 v97, v97
    v_exp_f32 v98, v98
    v_exp_f32 v99, v99
    v_cvt_pk_bf16_f32 v64, v88, v89
    v_cvt_pk_bf16_f32 v65, v90, v91
    v_cvt_pk_bf16_f32 v66, v96, v97
    v_cvt_pk_bf16_f32 v67, v98, v99
    s_waitcnt lgkmcnt(0)
    v_mfma_f32_32x32x16_bf16 v[72:87], v[48:51], v[36:39], v[72:87]
    v_exp_f32 v92, v92
    v_exp_f32 v93, v93
    v_exp_f32 v94, v94
    v_exp_f32 v95, v95
    v_exp_f32 v100, v100
    v_mfma_f32_32x32x16_bf16 v[120:135], v[56:59], v[64:67], v[120:135]
    s_mov_b64 exec, s[44:45]
    ds_read_b128 v[56:59], v24 offset:30720
    s_mov_b64 exec, -1
    v_exp_f32 v101, v101
    v_exp_f32 v102, v102
    v_exp_f32 v103, v103
    v_cvt_pk_bf16_f32 v68, v92, v93
    v_cvt_pk_bf16_f32 v69, v94, v95
    v_cvt_pk_bf16_f32 v70, v100, v101
    v_cvt_pk_bf16_f32 v71, v102, v103
    s_setprio 0
    v_mfma_f32_32x32x8_bf16 v[88:103], v[52:53], v[46:47], 0
    s_mov_b32 exec_hi, 0
    ds_read_b64 v[52:53], v23 offset:35840
    s_mov_b32 exec_hi, -1
    v_exp_f32 v72, v72
    v_exp_f32 v73, v73
    v_exp_f32 v74, v74
    v_exp_f32 v75, v75
    v_exp_f32 v80, v80
    v_mfma_f32_32x32x16_bf16 v[120:135], v[60:63], v[68:71], v[120:135]
    s_mov_b64 exec, s[44:45]
    ds_read_b128 v[60:63], v24 offset:31360
    s_mov_b64 exec, -1
    v_exp_f32 v81, v81
    v_exp_f32 v82, v82
    v_exp_f32 v83, v83
    v_cvt_pk_bf16_f32 v64, v72, v73
    v_cvt_pk_bf16_f32 v65, v74, v75
    v_cvt_pk_bf16_f32 v66, v80, v81
    v_cvt_pk_bf16_f32 v67, v82, v83
    v_mfma_f32_32x32x16_bf16 v[88:103], v[48:51], v[40:43], v[88:103]
    ds_read2st64_b64 v[48:51], v22 offset0:70 offset1:71
    v_exp_f32 v76, v76
    v_exp_f32 v77, v77
    v_exp_f32 v78, v78
    v_exp_f32 v79, v79
    v_exp_f32 v84, v84
    s_waitcnt lgkmcnt(3)
    v_mfma_f32_32x32x16_bf16 v[104:119], v[56:59], v[64:67], v[104:119]
    v_exp_f32 v85, v85
    v_exp_f32 v86, v86
    v_exp_f32 v87, v87
    v_cvt_pk_bf16_f32 v68, v76, v77
    v_cvt_pk_bf16_f32 v69, v78, v79
    v_cvt_pk_bf16_f32 v70, v84, v85
    v_cvt_pk_bf16_f32 v71, v86, v87
    s_waitcnt lgkmcnt(2)
    v_mfma_f32_32x32x8_bf16 v[72:87], v[52:53], v[44:45], 0
    s_getpc_b64 s[46:47]
    v_min_u32 v35, 5, v1
    v_lshlrev_b32 v35, 12, v35
    s_lshl_b32 s35, s51, 7
    v_add_u32 v35, s35, v35
    v_min_u32 v35, 21692, v35
    global_load_dword v27, v35, s[46:47]
L_f_cpf:
    v_exp_f32 v88, v88
    v_exp_f32 v89, v89
    v_exp_f32 v90, v90
    v_exp_f32 v91, v91
    v_exp_f32 v96, v96
    s_waitcnt lgkmcnt(1)
    v_mfma_f32_32x32x16_bf16 v[104:119], v[60:63], v[68:71], v[104:119]
    v_exp_f32 v97, v97
    v_exp_f32 v98, v98
    v_exp_f32 v99, v99
    v_cvt_pk_bf16_f32 v64, v88, v89
    v_cvt_pk_bf16_f32 v65, v90, v91
    v_cvt_pk_bf16_f32 v66, v96, v97
    v_cvt_pk_bf16_f32 v67, v98, v99
    s_waitcnt lgkmcnt(0)
    v_mfma_f32_32x32x16_bf16 v[72:87], v[48:51], v[36:39], v[72:87]
    v_exp_f32 v92, v92
    v_exp_f32 v93, v93
    v_exp_f32 v94, v94
    v_exp_f32 v95, v95
    v_exp_f32 v100, v100
    v_mfma_f32_32x32x16_bf16 v[120:135], v[56:59], v[64:67], v[120:135]
    s_mov_b64 exec, s[44:45]
    ds_read_b128 v[56:59], v24 offset:35840
    s_mov_b64 exec, -1
    v_exp_f32 v101, v101
    v_exp_f32 v102, v102
    v_exp_f32 v103, v103
    v_cvt_pk_bf16_f32 v68, v92, v93
    v_cvt_pk_bf16_f32 v69, v94, v95
    v_cvt_pk_bf16_f32 v70, v100, v101
    v_cvt_pk_bf16_f32 v71, v102, v103
    s_barrier
    s_setprio 3
    v_mfma_f32_32x32x8_bf16 v[88:103], v[52:53], v[46:47], 0
    v_exp_f32 v72, v72
    v_exp_f32 v73, v73
    v_exp_f32 v74, v74
    v_exp_f32 v75, v75
    v_exp_f32 v80, v80
    v_mfma_f32_32x32x16_bf16 v[120:135], v[60:63], v[68:71], v[120:135]
    s_mov_b64 exec, s[44:45]
    ds_read_b128 v[60:63], v24 offset:36480
    s_mov_b64 exec, -1
    v_exp_f32 v81, v81
    v_exp_f32 v82, v82
    v_exp_f32 v83, v83
    v_cvt_pk_bf16_f32 v64, v72, v73
    v_cvt_pk_bf16_f32 v65, v74, v75
    v_cvt_pk_bf16_f32 v66, v80, v81
    v_cvt_pk_bf16_f32 v67, v82, v83
    v_mfma_f32_32x32x16_bf16 v[88:103], v[48:51], v[40:43], v[88:103]
    v_exp_f32 v76, v76
    v_exp_f32 v77, v77
    v_exp_f32 v78, v78
    v_exp_f32 v79, v79
    v_exp_f32 v84, v84
    s_waitcnt lgkmcnt(1)
    v_mfma_f32_32x32x16_bf16 v[104:119], v[56:59], v[64:67], v[104:119]
    v_exp_f32 v85, v85
    v_exp_f32 v86, v86
    v_exp_f32 v87, v87
    v_cvt_pk_bf16_f32 v68, v76, v77
    v_cvt_pk_bf16_f32 v69, v78, v79
    v_cvt_pk_bf16_f32 v70, v84, v85
    v_cvt_pk_bf16_f32 v71, v86, v87
    v_exp_f32 v88, v88
    v_exp_f32 v89, v89
    v_exp_f32 v90, v90
    v_exp_f32 v91, v91
    v_exp_f32 v96, v96
    s_waitcnt lgkmcnt(0)
    v_mfma_f32_32x32x16_bf16 v[104:119], v[60:63], v[68:71], v[104:119]
    v_add_u32 v2, s64, v5
    v_add_u32 v3, s65, v5
    v_lshl_add_u32 v4, v1, 2, s64
    v_lshl_add_u32 v22, v1, 2, s65
    v_exp_f32 v97, v97
    v_exp_f32 v98, v98
    v_exp_f32 v99, v99
    v_cvt_pk_bf16_f32 v64, v88, v89
    v_cvt_pk_bf16_f32 v65, v90, v91
    v_cvt_pk_bf16_f32 v66, v96, v97
    v_cvt_pk_bf16_f32 v67, v98, v99
    v_exp_f32 v92, v92
    v_exp_f32 v93, v93
    v_exp_f32 v94, v94
    v_exp_f32 v95, v95
    v_exp_f32 v100, v100
    v_mfma_f32_32x32x16_bf16 v[120:135], v[56:59], v[64:67], v[120:135]
    ds_write_b128 v2, v[104:107] offset:0
    ds_write_b128 v2, v[108:111] offset:1024
    ds_write_b128 v2, v[112:115] offset:2048
    ds_write_b32 v4, v116 offset:3072
    v_exp_f32 v101, v101
    v_exp_f32 v102, v102
    v_exp_f32 v103, v103
    v_cvt_pk_bf16_f32 v68, v92, v93
    v_cvt_pk_bf16_f32 v69, v94, v95
    v_cvt_pk_bf16_f32 v70, v100, v101
    v_cvt_pk_bf16_f32 v71, v102, v103
    s_mov_b64 s[96:97], 0
    s_setprio 0
    v_mfma_f32_32x32x16_bf16 v[120:135], v[60:63], v[68:71], v[120:135]
    s_waitcnt lgkmcnt(0)
    s_barrier
    ds_read_b128 v[72:75], v3 offset:0
    ds_read_b128 v[76:79], v3 offset:1024
    ds_read_b128 v[80:83], v3 offset:2048
    ds_read_b32 v84, v22 offset:3072
    v_mov_b32 v4, 0x2b800000
    s_waitcnt lgkmcnt(0)
    s_nop 3
    v_add_f32 v132, v132, v84
    v_pk_add_f32 v[120:121], v[120:121], v[72:73]
    v_pk_add_f32 v[122:123], v[122:123], v[74:75]
    v_pk_add_f32 v[124:125], v[124:125], v[76:77]
    v_pk_add_f32 v[126:127], v[126:127], v[78:79]
    v_pk_add_f32 v[128:129], v[128:129], v[80:81]
    v_pk_add_f32 v[130:131], v[130:131], v[82:83]
L_f_store:
    s_nop 7
    v_rcp_f32 v86, v132
    v_pk_add_f32 v[72:73], v[120:121], v[122:123]
    v_pk_add_f32 v[74:75], v[124:125], v[126:127]
    v_pk_add_f32 v[76:77], v[128:129], v[130:131]
    v_cmp_ngt_f32 s[46:47], v132, v4
    v_pk_add_f32 v[72:73], v[72:73], v[74:75]
    v_pk_mul_f32 v[120:121], v[120:121], v[86:87] op_sel_hi:[1,0]
    v_pk_mul_f32 v[122:123], v[122:123], v[86:87] op_sel_hi:[1,0]
    v_pk_mul_f32 v[124:125], v[124:125], v[86:87] op_sel_hi:[1,0]
    v_pk_mul_f32 v[126:127], v[126:127], v[86:87] op_sel_hi:[1,0]
    v_pk_mul_f32 v[128:129], v[128:129], v[86:87] op_sel_hi:[1,0]
    v_pk_mul_f32 v[130:131], v[130:131], v[86:87] op_sel_hi:[1,0]
    v_pk_add_f32 v[72:73], v[72:73], v[76:77]
    v_mov_b32 v3, 0x7f800000
    v_add_f32 v72, v72, v73
    v_add_f32 v72, v72, v132
    v_cvt_pk_bf16_f32 v64, v120, v121
    v_cvt_pk_bf16_f32 v65, v122, v123
    v_cvt_pk_bf16_f32 v66, v124, v125
    v_cvt_pk_bf16_f32 v67, v126, v127
    v_cvt_pk_bf16_f32 v68, v128, v129
    v_cvt_pk_bf16_f32 v69, v130, v131
    v_cmp_nlt_f32 vcc, abs(v72), v3
    s_nop 0
    s_or_b64 vcc, vcc, s[46:47]
    s_andn2_b64 vcc, vcc, s[96:97]
    s_nop 1
    s_cbranch_vccnz L_f_slow
    buffer_store_dwordx4 v[64:67], v28, s[8:11], s62 offen sc1
    s_mov_b32 exec_hi, 0
    buffer_store_dwordx2 v[68:69], v29, s[8:11], s63 offen sc1
    s_mov_b32 exec_hi, -1
    s_and_b32 s35, s43, 7
    s_lshl_b32 s35, s35, 2
    s_add_u32 s37, s100, s35
    s_add_u32 s37, s37, 128
    s_lshl_b32 s42, s50, 15
    s_and_b32 s35, s56, 3
    s_lshl_b32 s35, s35, 3
    s_add_u32 s42, s42, s35
    s_add_u32 s42, s42, 32505984
    s_waitcnt vmcnt(0)
    s_mov_b64 exec, 1
    buffer_store_dword v7, v6, s[8:11], s37 offen sc1
    s_mov_b64 exec, -1
    s_barrier
    v_add_u32 v22, s49, v5
    s_lshr_b32 s36, s56, 1
    v_and_b32 v3, 3, v1
    v_lshlrev_b32 v3, 2, v3
    v_lshrrev_b32 v23, 2, v1
    v_lshl_add_u32 v23, v23, 14, v3
    s_and_b32 s64, s36, 1
    s_lshl_b32 s64, s64, 3
    s_add_u32 s64, s64, s50
    s_lshl_b32 s64, s64, 10
    s_add_u32 s65, s64, 32506368
    s_add_u32 s64, s64, 32506240
    s_cmp_ge_u32 s32, 4
    s_cbranch_scc1 L_f_help
    v_lshrrev_b32 v0, 3, v1
    v_lshl_add_u32 v0, v0, 15, v3
    v_bfe_u32 v3, v1, 2, 1
    v_lshl_add_u32 v0, v3, 13, v0
    v_mov_b32 v24, v5
    v_add_u32 v25, 0x10000, v5
    v_add_u32 v26, 0x20000, v5
    ds_write_b128 v22, v[140:143] offset:0
    ds_write_b128 v22, v[144:147] offset:1024
    ds_write_b128 v22, v[148:151] offset:2048
    ds_write_b128 v22, v[152:155] offset:3072
    ds_write_b128 v22, v[156:159] offset:4096
    ds_write_b128 v22, v[160:163] offset:5120
    ds_write_b128 v22, v[164:167] offset:6144
    ds_write_b128 v22, v[168:171] offset:7168
    ds_write_b128 v22, v[172:175] offset:8192
    ds_write_b128 v22, v[176:179] offset:9216
    ds_write_b128 v22, v[180:183] offset:10240
    ds_write_b128 v22, v[184:187] offset:11264
    ds_write_b128 v22, v[188:191] offset:12288
    ds_write_b128 v22, v[192:195] offset:13312
    ds_read_b128 v[52:55], v24 offset:61440
    ds_read_b128 v[56:59], v24 offset:62464
    ds_read_b128 v[60:63], v24 offset:63488
    ds_read_b128 v[64:67], v24 offset:64512
    ds_read_b128 v[68:71], v25 offset:0
    s_mul_i32 s88, s61, 20480
    s_add_u32 s26, s88, 9437184
    v_mov_b32 v28, 0
    v_mov_b32 v29, 0
    v_mov_b32 v27, 0x3f803f80
    v_lshlrev_b32 v32, 16, v236
    v_and_b32 v33, 0xffff0000, v236
    v_lshlrev_b32 v34, 16, v237
    v_and_b32 v35, 0xffff0000, v237
    v_lshlrev_b32 v36, 16, v238
    v_and_b32 v37, 0xffff0000, v238
    v_lshlrev_b32 v38, 16, v239
    v_and_b32 v39, 0xffff0000, v239
    v_lshlrev_b32 v40, 16, v240
    v_and_b32 v41, 0xffff0000, v240
    v_lshlrev_b32 v42, 16, v241
    v_and_b32 v43, 0xffff0000, v241
    v_lshlrev_b32 v44, 16, v242
    v_and_b32 v45, 0xffff0000, v242
    v_lshlrev_b32 v46, 16, v243
    v_and_b32 v47, 0xffff0000, v243
    v_lshlrev_b32 v48, 16, v244
    v_and_b32 v49, 0xffff0000, v244
    v_lshlrev_b32 v50, 16, v245
    v_and_b32 v51, 0xffff0000, v245
    v_lshrrev_b32 v2, 1, v1
    v_lshlrev_b32 v2, 10, v2
    v_and_b32 v3, 1, v1
    v_lshl_add_u32 v2, v3, 2, v2
    s_cmp_lg_u32 s32, 0
    s_cbranch_scc1 L_f_o4
    s_mov_b32 s38, 0
    s_branch L_f_q5
L_f_p5:
    s_sleep 4
L_f_q5:
    buffer_load_dword v3, v2, s[8:11], s42 offen sc1
    s_add_u32 s38, s38, 1
    s_cmp_gt_u32 s38, 100000
    s_waitcnt vmcnt(0)
    s_cbranch_scc1 L_f_x5
    v_cmp_ne_u32 vcc, 1, v3
    s_nop 4
    s_cbranch_vccnz L_f_p5
L_f_x5:
L_f_o4:
    s_barrier
    buffer_load_dwordx4 v[92:95], v5, s[8:11], s26 offen offset:0 sc1
    buffer_load_dwordx4 v[96:99], v5, s[8:11], s26 offen offset:1024 sc1
    buffer_load_dwordx4 v[100:103], v5, s[8:11], s26 offen offset:2048 sc1
    buffer_load_dwordx4 v[104:107], v5, s[8:11], s26 offen offset:3072 sc1
    s_add_u32 s26, s26, 4096
    buffer_load_dwordx4 v[108:111], v5, s[8:11], s26 offen offset:0 sc1
    buffer_load_dwordx4 v[112:115], v5, s[8:11], s26 offen offset:1024 sc1
    buffer_load_dwordx4 v[116:119], v5, s[8:11], s26 offen offset:2048 sc1
    buffer_load_dwordx4 v[120:123], v5, s[8:11], s26 offen offset:3072 sc1
    s_add_u32 s26, s26, 4096
    buffer_load_dwordx4 v[124:127], v5, s[8:11], s26 offen offset:0 sc1
    buffer_load_dwordx4 v[128:131], v5, s[8:11], s26 offen offset:1024 sc1
    s_lshr_b32 s35, s57, 1
    s_mul_i32 s35, s35, 5120
    s_add_u32 s35, s35, s88
    s_add_u32 s35, s35, 12582912
    s_mul_i32 s53, s68, 3072
    s_add_u32 s53, s53, s35
    s_lshl_b32 s54, s68, 9
    s_add_u32 s54, s54, s35
    s_lshl_b32 s62, s61, 10
    s_lshl_b32 s39, s57, 7
    s_add_u32 s62, s62, s39
    s_add_u32 s62, s62, 15728640
    s_waitcnt vmcnt(9)
    s_waitcnt lgkmcnt(4)
    v_mfma_f32_16x16x32_bf16 v[32:35], v[52:55], v[92:95], v[32:35]
    ds_read_b128 v[72:75], v25 offset:1024
    s_waitcnt lgkmcnt(4)
    v_mfma_f32_16x16x32_bf16 v[36:39], v[56:59], v[92:95], v[36:39]
    buffer_load_dwordx4 v[132:135], v5, s[8:11], s26 offen offset:2048 sc1
    ds_read_b128 v[76:79], v25 offset:2048
    s_waitcnt lgkmcnt(4)
    v_mfma_f32_16x16x32_bf16 v[40:43], v[60:63], v[92:95], v[40:43]
    ds_read_b128 v[80:83], v25 offset:3072
    s_waitcnt lgkmcnt(4)
    v_mfma_f32_16x16x32_bf16 v[44:47], v[64:67], v[92:95], v[44:47]
    ds_read_b128 v[84:87], v25 offset:4096
    s_waitcnt lgkmcnt(4)
    v_mfma_f32_16x16x32_bf16 v[48:51], v[68:71], v[92:95], v[48:51]
    ds_read_b128 v[88:91], v25 offset:5120
    s_waitcnt vmcnt(9)
    s_waitcnt lgkmcnt(4)
    v_mfma_f32_16x16x32_bf16 v[32:35], v[72:75], v[96:99], v[32:35]
    ds_read_b128 v[52:55], v25 offset:6144
    s_waitcnt lgkmcnt(4)
    v_mfma_f32_16x16x32_bf16 v[36:39], v[76:79], v[96:99], v[36:39]
    buffer_load_dwordx4 v[136:139], v5, s[8:11], s26 offen offset:3072 sc1
    ds_read_b128 v[56:59], v25 offset:7168
    s_waitcnt lgkmcnt(4)
    v_mfma_f32_16x16x32_bf16 v[40:43], v[80:83], v[96:99], v[40:43]
    ds_read_b128 v[60:63], v25 offset:8192
    s_waitcnt lgkmcnt(4)
    v_mfma_f32_16x16x32_bf16 v[44:47], v[84:87], v[96:99], v[44:47]
    ds_read_b128 v[64:67], v25 offset:9216
    s_waitcnt lgkmcnt(4)
    v_mfma_f32_16x16x32_bf16 v[48:51], v[88:91], v[96:99], v[48:51]
    ds_read_b128 v[68:71], v25 offset:10240
    s_waitcnt vmcnt(9)
    s_waitcnt lgkmcnt(4)
    v_mfma_f32_16x16x32_bf16 v[32:35], v[52:55], v[100:103], v[32:35]
    ds_read_b128 v[72:75], v25 offset:11264
    s_waitcnt lgkmcnt(4)
    v_mfma_f32_16x16x32_bf16 v[36:39], v[56:59], v[100:103], v[36:39]
    s_add_u32 s26, s26, 4096
    buffer_load_dwordx4 v[140:143], v5, s[8:11], s26 offen offset:0 sc1
    ds_read_b128 v[76:79], v25 offset:12288
    s_waitcnt lgkmcnt(4)
    v_mfma_f32_16x16x32_bf16 v[40:43], v[60:63], v[100:103], v[40:43]
    ds_read_b128 v[80:83], v25 offset:13312
    s_waitcnt lgkmcnt(4)
    v_mfma_f32_16x16x32_bf16 v[44:47], v[64:67], v[100:103], v[44:47]
    ds_read_b128 v[84:87], v25 offset:14336
    s_waitcnt lgkmcnt(4)
    v_mfma_f32_16x16x32_bf16 v[48:51], v[68:71], v[100:103], v[48:51]
    ds_read_b128 v[88:91], v25 offset:15360
    s_waitcnt vmcnt(9)
    s_waitcnt lgkmcnt(4)
    v_mfma_f32_16x16x32_bf16 v[32:35], v[72:75], v[104:107], v[32:35]
    ds_read_b128 v[52:55], v25 offset:16384
    s_waitcnt lgkmcnt(4)
    v_mfma_f32_16x16x32_bf16 v[36:39], v[76:79], v[104:107], v[36:39]
    buffer_load_dwordx4 v[144:147], v5, s[8:11], s26 offen offset:1024 sc1
    ds_read_b128 v[56:59], v25 offset:17408
    s_waitcnt lgkmcnt(4)
    v_mfma_f32_16x16x32_bf16 v[40:43], v[80:83], v[104:107], v[40:43]
    ds_read_b128 v[60:63], v25 offset:18432
    s_waitcnt lgkmcnt(4)
    v_mfma_f32_16x16x32_bf16 v[44:47], v[84:87], v[104:107], v[44:47]
    ds_read_b128 v[64:67], v25 offset:19456
    s_waitcnt lgkmcnt(4)
    v_mfma_f32_16x16x32_bf16 v[48:51], v[88:91], v[104:107], v[48:51]
    ds_read_b128 v[68:71], v25 offset:20480
    s_waitcnt vmcnt(9)
    s_waitcnt lgkmcnt(4)
    v_mfma_f32_16x16x32_bf16 v[32:35], v[52:55], v[108:111], v[32:35]
    ds_read_b128 v[72:75], v25 offset:21504
    s_waitcnt lgkmcnt(4)
    v_mfma_f32_16x16x32_bf16 v[36:39], v[56:59], v[108:111], v[36:39]
    buffer_load_dwordx4 v[148:151], v5, s[8:11], s26 offen offset:2048 sc1
    ds_read_b128 v[76:79], v25 offset:22528
    s_waitcnt lgkmcnt(4)
    v_mfma_f32_16x16x32_bf16 v[40:43], v[60:63], v[108:111], v[40:43]
    ds_read_b128 v[80:83], v25 offset:23552
    s_waitcnt lgkmcnt(4)
    v_mfma_f32_16x16x32_bf16 v[44:47], v[64:67], v[108:111], v[44:47]
    ds_read_b128 v[84:87], v25 offset:24576
    s_waitcnt lgkmcnt(4)
    v_mfma_f32_16x16x32_bf16 v[48:51], v[68:71], v[108:111], v[48:51]
    ds_read_b128 v[88:91], v25 offset:25600
    s_waitcnt vmcnt(9)
    s_waitcnt lgkmcnt(4)
    v_mfma_f32_16x16x32_bf16 v[32:35], v[72:75], v[112:115], v[32:35]
    ds_read_b128 v[52:55], v25 offset:26624
    s_waitcnt lgkmcnt(4)
    v_mfma_f32_16x16x32_bf16 v[36:39], v[76:79], v[112:115], v[36:39]
    buffer_load_dwordx4 v[152:155], v5, s[8:11], s26 offen offset:3072 sc1
    ds_read_b128 v[56:59], v25 offset:27648
    s_waitcnt lgkmcnt(4)
    v_mfma_f32_16x16x32_bf16 v[40:43], v[80:83], v[112:115], v[40:43]
    ds_read_b128 v[60:63], v25 offset:28672
    s_waitcnt lgkmcnt(4)
    v_mfma_f32_16x16x32_bf16 v[44:47], v[84:87], v[112:115], v[44:47]
    ds_read_b128 v[64:67], v25 offset:29696
    s_waitcnt lgkmcnt(4)
    v_mfma_f32_16x16x32_bf16 v[48:51], v[88:91], v[112:115], v[48:51]
    ds_read_b128 v[68:71], v25 offset:30720
    s_waitcnt vmcnt(9)
    s_waitcnt lgkmcnt(4)
    v_mfma_f32_16x16x32_bf16 v[32:35], v[52:55], v[116:119], v[32:35]
    ds_read_b128 v[72:75], v25 offset:31744
    s_waitcnt lgkmcnt(4)
    v_mfma_f32_16x16x32_bf16 v[36:39], v[56:59], v[116:119], v[36:39]
    s_add_u32 s26, s26, 4096
    buffer_load_dwordx2 v[156:157], v10, s[8:11], s26 offen offset:0 sc1
    buffer_load_dwordx2 v[158:159], v10, s[8:11], s26 offen offset:512 sc1
    ds_read_b128 v[76:79], v25 offset:32768
    s_waitcnt lgkmcnt(4)
    v_mfma_f32_16x16x32_bf16 v[40:43], v[60:63], v[116:119], v[40:43]
    ds_read_b128 v[80:83], v25 offset:33792
    s_waitcnt lgkmcnt(4)
    v_mfma_f32_16x16x32_bf16 v[44:47], v[64:67], v[116:119], v[44:47]
    ds_read_b128 v[84:87], v25 offset:34816
    s_waitcnt lgkmcnt(4)
    v_mfma_f32_16x16x32_bf16 v[48:51], v[68:71], v[116:119], v[48:51]
    ds_read_b128 v[88:91], v25 offset:35840
    s_waitcnt vmcnt(10)
    s_waitcnt lgkmcnt(4)
    v_mfma_f32_16x16x32_bf16 v[32:35], v[72:75], v[120:123], v[32:35]
    ds_read_b128 v[52:55], v25 offset:36864
    s_waitcnt lgkmcnt(4)
    v_mfma_f32_16x16x32_bf16 v[36:39], v[76:79], v[120:123], v[36:39]
    buffer_load_dwordx2 v[160:161], v10, s[8:11], s26 offen offset:1024 sc1
    buffer_load_dwordx2 v[162:163], v10, s[8:11], s26 offen offset:1536 sc1
    ds_read_b128 v[56:59], v25 offset:37888
    s_waitcnt lgkmcnt(4)
    v_mfma_f32_16x16x32_bf16 v[40:43], v[80:83], v[120:123], v[40:43]
    ds_read_b128 v[60:63], v25 offset:38912
    s_waitcnt lgkmcnt(4)
    v_mfma_f32_16x16x32_bf16 v[44:47], v[84:87], v[120:123], v[44:47]
    ds_read_b128 v[64:67], v25 offset:39936
    s_waitcnt lgkmcnt(4)
    v_mfma_f32_16x16x32_bf16 v[48:51], v[88:91], v[120:123], v[48:51]
    ds_read_b128 v[68:71], v25 offset:40960
    s_waitcnt vmcnt(11)
    s_waitcnt lgkmcnt(4)
    v_mfma_f32_16x16x32_bf16 v[32:35], v[52:55], v[124:127], v[32:35]
    ds_read_b128 v[72:75], v25 offset:41984
    s_waitcnt lgkmcnt(4)
    v_mfma_f32_16x16x32_bf16 v[36:39], v[56:59], v[124:127], v[36:39]
    buffer_load_dwordx2 v[164:165], v10, s[8:11], s26 offen offset:2048 sc1
    buffer_load_dwordx2 v[166:167], v10, s[8:11], s26 offen offset:2560 sc1
    ds_read_b128 v[76:79], v25 offset:43008
    s_waitcnt lgkmcnt(4)
    v_mfma_f32_16x16x32_bf16 v[40:43], v[60:63], v[124:127], v[40:43]
    ds_read_b128 v[80:83], v25 offset:44032
    s_waitcnt lgkmcnt(4)
    v_mfma_f32_16x16x32_bf16 v[44:47], v[64:67], v[124:127], v[44:47]
    ds_read_b128 v[84:87], v25 offset:45056
    s_waitcnt lgkmcnt(4)
    v_mfma_f32_16x16x32_bf16 v[48:51], v[68:71], v[124:127], v[48:51]
    ds_read_b128 v[88:91], v25 offset:46080
    s_waitcnt vmcnt(12)
    s_waitcnt lgkmcnt(4)
    v_mfma_f32_16x16x32_bf16 v[32:35], v[72:75], v[128:131], v[32:35]
    ds_read_b128 v[52:55], v25 offset:47104
    s_waitcnt lgkmcnt(4)
    v_mfma_f32_16x16x32_bf16 v[36:39], v[76:79], v[128:131], v[36:39]
    buffer_load_dwordx2 v[168:169], v10, s[8:11], s26 offen offset:3072 sc1
    buffer_load_dwordx2 v[170:171], v10, s[8:11], s26 offen offset:3584 sc1
    ds_read_b128 v[56:59], v25 offset:48128
    s_waitcnt lgkmcnt(4)
    v_mfma_f32_16x16x32_bf16 v[40:43], v[80:83], v[128:131], v[40:43]
    ds_read_b128 v[60:63], v25 offset:49152
    s_waitcnt lgkmcnt(4)
    v_mfma_f32_16x16x32_bf16 v[44:47], v[84:87], v[128:131], v[44:47]
    ds_read_b128 v[64:67], v25 offset:50176
    s_waitcnt lgkmcnt(4)
    v_mfma_f32_16x16x32_bf16 v[48:51], v[88:91], v[128:131], v[48:51]
    ds_read_b128 v[68:71], v25 offset:51200
    s_waitcnt vmcnt(13)
    s_waitcnt lgkmcnt(4)
    v_mfma_f32_16x16x32_bf16 v[32:35], v[52:55], v[132:135], v[32:35]
    ds_read_b128 v[72:75], v25 offset:52224
    s_waitcnt lgkmcnt(4)
    v_mfma_f32_16x16x32_bf16 v[36:39], v[56:59], v[132:135], v[36:39]
    ds_read_b128 v[76:79], v25 offset:53248
    s_waitcnt lgkmcnt(4)
    v_mfma_f32_16x16x32_bf16 v[40:43], v[60:63], v[132:135], v[40:43]
    ds_read_b128 v[80:83], v25 offset:54272
    s_waitcnt lgkmcnt(4)
    v_mfma_f32_16x16x32_bf16 v[44:47], v[64:67], v[132:135], v[44:47]
    ds_read_b128 v[84:87], v25 offset:55296
    s_waitcnt lgkmcnt(4)
    v_mfma_f32_16x16x32_bf16 v[48:51], v[68:71], v[132:135], v[48:51]
    ds_read_b128 v[88:91], v25 offset:56320
    s_waitcnt vmcnt(12)
    s_waitcnt lgkmcnt(4)
    v_mfma_f32_16x16x32_bf16 v[32:35], v[72:75], v[136:139], v[32:35]
    ds_read_b128 v[52:55], v25 offset:57344
    s_waitcnt lgkmcnt(4)
    v_mfma_f32_16x16x32_bf16 v[36:39], v[76:79], v[136:139], v[36:39]
    ds_read_b128 v[56:59], v25 offset:58368
    s_waitcnt lgkmcnt(4)
    v_mfma_f32_16x16x32_bf16 v[40:43], v[80:83], v[136:139], v[40:43]
    ds_read_b128 v[60:63], v25 offset:59392
    s_waitcnt lgkmcnt(4)
    v_mfma_f32_16x16x32_bf16 v[44:47], v[84:87], v[136:139], v[44:47]
    ds_read_b128 v[64:67], v25 offset:60416
    s_waitcnt lgkmcnt(4)
    v_mfma_f32_16x16x32_bf16 v[48:51], v[88:91], v[136:139], v[48:51]
    ds_read_b128 v[68:71], v25 offset:61440
    s_waitcnt vmcnt(11)
    s_waitcnt lgkmcnt(4)
    v_mfma_f32_16x16x32_bf16 v[32:35], v[52:55], v[140:143], v[32:35]
    ds_read_b128 v[72:75], v25 offset:62464
    s_waitcnt lgkmcnt(4)
    v_mfma_f32_16x16x32_bf16 v[36:39], v[56:59], v[140:143], v[36:39]
    ds_read_b128 v[76:79], v25 offset:63488
    s_waitcnt lgkmcnt(4)
    v_mfma_f32_16x16x32_bf16 v[40:43], v[60:63], v[140:143], v[40:43]
    ds_read_b128 v[80:83], v25 offset:64512
    s_waitcnt lgkmcnt(4)
    v_mfma_f32_16x16x32_bf16 v[44:47], v[64:67], v[140:143], v[44:47]
    ds_read_b128 v[84:87], v26 offset:0
    s_waitcnt lgkmcnt(4)
    v_mfma_f32_16x16x32_bf16 v[48:51], v[68:71], v[140:143], v[48:51]
    ds_read_b128 v[88:91], v26 offset:1024
    s_waitcnt vmcnt(10)
    s_waitcnt lgkmcnt(4)
    v_mfma_f32_16x16x32_bf16 v[32:35], v[72:75], v[144:147], v[32:35]
    ds_read_b128 v[52:55], v26 offset:2048
    s_waitcnt lgkmcnt(4)
    v_mfma_f32_16x16x32_bf16 v[36:39], v[76:79], v[144:147], v[36:39]
    ds_read_b128 v[56:59], v26 offset:3072
    s_waitcnt lgkmcnt(4)
    v_mfma_f32_16x16x32_bf16 v[40:43], v[80:83], v[144:147], v[40:43]
    ds_read_b128 v[60:63], v26 offset:4096
    s_waitcnt lgkmcnt(4)
    v_mfma_f32_16x16x32_bf16 v[44:47], v[84:87], v[144:147], v[44:47]
    ds_read_b128 v[64:67], v26 offset:5120
    s_waitcnt lgkmcnt(4)
    v_mfma_f32_16x16x32_bf16 v[48:51], v[88:91], v[144:147], v[48:51]
    ds_read_b128 v[68:71], v26 offset:6144
    s_waitcnt vmcnt(9)
    s_waitcnt lgkmcnt(4)
    v_mfma_f32_16x16x32_bf16 v[32:35], v[52:55], v[148:151], v[32:35]
    ds_read_b128 v[72:75], v26 offset:7168
    s_waitcnt lgkmcnt(4)
    v_mfma_f32_16x16x32_bf16 v[36:39], v[56:59], v[148:151], v[36:39]
    ds_read_b128 v[76:79], v26 offset:8192
    s_waitcnt lgkmcnt(4)
    v_mfma_f32_16x16x32_bf16 v[40:43], v[60:63], v[148:151], v[40:43]
    ds_read_b128 v[80:83], v26 offset:9216
    s_waitcnt lgkmcnt(4)
    v_mfma_f32_16x16x32_bf16 v[44:47], v[64:67], v[148:151], v[44:47]
    ds_read_b128 v[84:87], v26 offset:10240
    s_waitcnt lgkmcnt(4)
    v_mfma_f32_16x16x32_bf16 v[48:51], v[68:71], v[148:151], v[48:51]
    ds_read_b128 v[88:91], v26 offset:11264
    s_waitcnt vmcnt(8)
    s_waitcnt lgkmcnt(4)
    v_mfma_f32_16x16x32_bf16 v[32:35], v[72:75], v[152:155], v[32:35]
    ds_read_b128 v[52:55], v26 offset:12288
    s_waitcnt lgkmcnt(4)
    v_mfma_f32_16x16x32_bf16 v[36:39], v[76:79], v[152:155], v[36:39]
    ds_read_b128 v[56:59], v26 offset:13312
    s_waitcnt lgkmcnt(4)
    v_mfma_f32_16x16x32_bf16 v[40:43], v[80:83], v[152:155], v[40:43]
    ds_read_b128 v[60:63], v26 offset:14336
    s_waitcnt lgkmcnt(4)
    v_mfma_f32_16x16x32_bf16 v[44:47], v[84:87], v[152:155], v[44:47]
    ds_read_b128 v[64:67], v26 offset:15360
    s_waitcnt lgkmcnt(4)
    v_mfma_f32_16x16x32_bf16 v[48:51], v[88:91], v[152:155], v[48:51]
    ds_read_b128 v[68:71], v26 offset:16384
    s_waitcnt vmcnt(6)
    s_waitcnt lgkmcnt(4)
    v_mfma_f32_16x16x32_bf16 v[32:35], v[52:55], v[156:159], v[32:35]
    ds_read_b128 v[72:75], v26 offset:17408
    s_waitcnt lgkmcnt(4)
    v_mfma_f32_16x16x32_bf16 v[36:39], v[56:59], v[156:159], v[36:39]
    ds_read_b128 v[76:79], v26 offset:18432
    s_waitcnt lgkmcnt(4)
    v_mfma_f32_16x16x32_bf16 v[40:43], v[60:63], v[156:159], v[40:43]
    ds_read_b128 v[80:83], v26 offset:19456
    s_waitcnt lgkmcnt(4)
    v_mfma_f32_16x16x32_bf16 v[44:47], v[64:67], v[156:159], v[44:47]
    ds_read_b128 v[84:87], v26 offset:20480
    s_waitcnt lgkmcnt(4)
    v_mfma_f32_16x16x32_bf16 v[48:51], v[68:71], v[156:159], v[48:51]
    ds_read_b128 v[88:91], v26 offset:21504
    s_waitcnt vmcnt(4)
    s_waitcnt lgkmcnt(4)
    v_mfma_f32_16x16x32_bf16 v[32:35], v[72:75], v[160:163], v[32:35]
    ds_read_b128 v[52:55], v26 offset:22528
    s_waitcnt lgkmcnt(4)
    v_mfma_f32_16x16x32_bf16 v[36:39], v[76:79], v[160:163], v[36:39]
    ds_read_b128 v[56:59], v26 offset:23552
    s_waitcnt lgkmcnt(4)
    v_mfma_f32_16x16x32_bf16 v[40:43], v[80:83], v[160:163], v[40:43]
    ds_read_b128 v[60:63], v26 offset:24576
    s_waitcnt lgkmcnt(4)
    v_mfma_f32_16x16x32_bf16 v[44:47], v[84:87], v[160:163], v[44:47]
    ds_read_b128 v[64:67], v26 offset:25600
    s_waitcnt lgkmcnt(4)
    v_mfma_f32_16x16x32_bf16 v[48:51], v[88:91], v[160:163], v[48:51]
    ds_read_b128 v[68:71], v26 offset:26624
    s_waitcnt vmcnt(2)
    s_waitcnt lgkmcnt(4)
    v_mfma_f32_16x16x32_bf16 v[32:35], v[52:55], v[164:167], v[32:35]
    ds_read_b128 v[72:75], v26 offset:27648
    s_waitcnt lgkmcnt(4)
    v_mfma_f32_16x16x32_bf16 v[36:39], v[56:59], v[164:167], v[36:39]
    ds_read_b128 v[76:79], v26 offset:28672
    s_waitcnt lgkmcnt(4)
    v_mfma_f32_16x16x32_bf16 v[40:43], v[60:63], v[164:167], v[40:43]
    ds_read_b128 v[80:83], v26 offset:29696
    s_waitcnt lgkmcnt(4)
    v_mfma_f32_16x16x32_bf16 v[44:47], v[64:67], v[164:167], v[44:47]
    ds_read_b128 v[84:87], v26 offset:30720
    s_waitcnt lgkmcnt(4)
    v_mfma_f32_16x16x32_bf16 v[48:51], v[68:71], v[164:167], v[48:51]
    ds_read_b128 v[88:91], v26 offset:31744
    s_waitcnt vmcnt(0)
    s_waitcnt lgkmcnt(4)
    v_mfma_f32_16x16x32_bf16 v[32:35], v[72:75], v[168:171], v[32:35]
    s_waitcnt lgkmcnt(3)
    v_mfma_f32_16x16x32_bf16 v[36:39], v[76:79], v[168:171], v[36:39]
    s_waitcnt lgkmcnt(2)
    v_mfma_f32_16x16x32_bf16 v[40:43], v[80:83], v[168:171], v[40:43]
    s_waitcnt lgkmcnt(1)
    v_mfma_f32_16x16x32_bf16 v[44:47], v[84:87], v[168:171], v[44:47]
    s_waitcnt lgkmcnt(0)
    v_mfma_f32_16x16x32_bf16 v[48:51], v[88:91], v[168:171], v[48:51]
    s_barrier
    v_cvt_pk_bf16_f32 v12, v32, v33
    v_cvt_pk_bf16_f32 v13, v34, v35
    v_cvt_pk_bf16_f32 v14, v36, v37
    v_cvt_pk_bf16_f32 v15, v38, v39
    buffer_store_dwordx4 v[12:15], v5, s[8:11], s53 offen offset:0 sc1
    v_cvt_pk_bf16_f32 v16, v40, v41
    v_cvt_pk_bf16_f32 v17, v42, v43
    v_cvt_pk_bf16_f32 v18, v44, v45
    v_cvt_pk_bf16_f32 v19, v46, v47
    buffer_store_dwordx4 v[16:19], v5, s[8:11], s53 offen offset:1024 sc1
    v_cvt_pk_bf16_f32 v20, v48, v49
    v_cvt_pk_bf16_f32 v21, v50, v51
    buffer_store_dwordx2 v[20:21], v10, s[8:11], s54 offen offset:2048 sc1
    v_dot2c_f32_bf16 v28, v12, v27
    v_dot2c_f32_bf16 v29, v12, v12
    v_dot2c_f32_bf16 v28, v13, v27
    v_dot2c_f32_bf16 v29, v13, v13
    v_dot2c_f32_bf16 v28, v14, v27
    v_dot2c_f32_bf16 v29, v14, v14
    v_dot2c_f32_bf16 v28, v15, v27
    v_dot2c_f32_bf16 v29, v15, v15
    v_dot2c_f32_bf16 v28, v16, v27
    v_dot2c_f32_bf16 v29, v16, v16
    v_dot2c_f32_bf16 v28, v17, v27
    v_dot2c_f32_bf16 v29, v17, v17
    v_dot2c_f32_bf16 v28, v18, v27
    v_dot2c_f32_bf16 v29, v18, v18
    v_dot2c_f32_bf16 v28, v19, v27
    v_dot2c_f32_bf16 v29, v19, v19
    v_dot2c_f32_bf16 v28, v20, v27
    v_dot2c_f32_bf16 v29, v20, v20
    v_dot2c_f32_bf16 v28, v21, v27
    v_dot2c_f32_bf16 v29, v21, v21
    s_nop 1
    v_mov_b32 v2, v28
    v_mov_b32 v3, v29
    s_nop 0
    v_permlane32_swap_b32 v28, v2
    v_permlane32_swap_b32 v29, v3
    v_add_f32 v28, v28, v2
    v_add_f32 v29, v29, v3
    v_mov_b32 v2, v28
    v_mov_b32 v3, v29
    s_nop 0
    v_permlane16_swap_b32 v28, v2
    v_permlane16_swap_b32 v29, v3
    v_add_f32 v28, v28, v2
    v_add_f32 v29, v29, v3
    s_mov_b64 exec, 0xffff
    buffer_store_dwordx2 v[28:29], v10, s[8:11], s62 offen sc1
    s_mov_b64 exec, -1
    s_and_b32 s42, s58, 1
    s_lshl_b32 s42, s42, 4
    s_add_u32 s42, s42, s50
    s_lshl_b32 s42, s42, 10
    s_add_u32 s42, s42, 32506112
    s_lshl_b32 s35, s32, 2
    s_add_u32 s37, s100, s35
    s_add_u32 s37, s37, 256
    s_lshl_b32 s60, s58, 3
    s_lshl_b32 s35, s32, 1
    s_add_u32 s60, s60, s35
    s_mul_i32 s26, s60, 20480
    s_add_u32 s26, s26, 12582912
    s_lshl_b32 s27, s60, 10
    s_add_u32 s27, s27, 15728640
    v_add_u32 v30, 20480, v5
    v_add_u32 v31, 20480, v10
    v_lshlrev_b32 v4, 3, v9
    v_lshl_add_u32 v4, v8, 8, v4
    v_add_u32 v22, s91, v5
    ds_write_b128 v22, v[196:199] offset:0
    ds_write_b128 v22, v[200:203] offset:1024
    ds_write_b128 v22, v[204:207] offset:2048
    ds_write_b128 v22, v[208:211] offset:3072
    ds_write_b128 v22, v[212:215] offset:4096
    ds_write_b128 v22, v[216:219] offset:5120
    ds_write_b128 v22, v[220:223] offset:6144
    ds_write_b128 v22, v[224:227] offset:7168
    ds_write_b128 v22, v[228:231] offset:8192
    ds_write_b128 v22, v[232:235] offset:9216
    s_waitcnt vmcnt(0)
    s_mov_b64 exec, 1
    buffer_store_dword v7, v6, s[8:11], s37 offen offset:384
    buffer_store_dword v7, v6, s[8:11], s37 offen sc1
    s_mov_b64 exec, -1
    s_waitcnt lgkmcnt(0)
    ds_read_b128 v[88:91], v24 offset:0
    ds_read_b128 v[92:95], v24 offset:1024
    ds_read_b128 v[96:99], v24 offset:2048
    ds_read_b128 v[100:103], v24 offset:3072
    ds_read_b128 v[104:107], v24 offset:4096
    ds_read_b128 v[108:111], v24 offset:5120
    ds_read_b128 v[112:115], v24 offset:6144
    s_cmp_lg_u32 s32, 0
    s_cbranch_scc1 L_f_o6
    s_mov_b32 s38, 0
    s_branch L_f_q7
L_f_p7:
    s_sleep 1
L_f_q7:
    buffer_load_dword v2, v0, s[8:11], s42 offen offset:384 sc1
    s_add_u32 s38, s38, 1
    s_waitcnt vmcnt(0)
    v_cmp_ne_u32 vcc, 1, v2
    s_nop 4
    s_cbranch_vccz L_f_x7
    s_cmp_lt_u32 s38, 12
    s_cbranch_scc1 L_f_p7
    s_mov_b32 s38, 0
    s_branch L_f_q8
L_f_p8:
    s_sleep 4
L_f_q8:
    buffer_load_dword v2, v0, s[8:11], s42 offen sc1
    s_add_u32 s38, s38, 1
    s_cmp_gt_u32 s38, 100000
    s_waitcnt vmcnt(0)
    s_cbranch_scc1 L_f_x8
    v_cmp_ne_u32 vcc, 1, v2
    s_nop 4
    s_cbranch_vccnz L_f_p8
L_f_x8:
L_f_x7:
L_f_o6:
    s_barrier
    buffer_load_dwordx4 v[144:147], v5, s[8:11], s26 offen offset:0 sc1
    buffer_load_dwordx4 v[148:151], v30, s[8:11], s26 offen offset:0 sc1
    buffer_load_dwordx4 v[152:155], v5, s[8:11], s26 offen offset:1024 sc1
    buffer_load_dwordx4 v[156:159], v30, s[8:11], s26 offen offset:1024 sc1
    buffer_load_dwordx2 v[160:161], v10, s[8:11], s26 offen offset:2048 sc1
    buffer_load_dwordx2 v[162:163], v10, s[8:11], s26 offen offset:2560 sc1
    buffer_load_dwordx2 v[164:165], v31, s[8:11], s26 offen offset:2048 sc1
    buffer_load_dwordx2 v[166:167], v31, s[8:11], s26 offen offset:2560 sc1
    buffer_load_dwordx4 v[168:171], v5, s[8:11], s26 offen offset:3072 sc1
    buffer_load_dwordx4 v[172:175], v30, s[8:11], s26 offen offset:3072 sc1
    s_add_u32 s26, s26, 4096
    buffer_load_dwordx4 v[176:179], v5, s[8:11], s26 offen offset:0 sc1
    buffer_load_dwordx4 v[180:183], v30, s[8:11], s26 offen offset:0 sc1
    v_lshlrev_b32 v22, 5, v8
    v_add_u32 v22, 162816, v22
    s_mul_i32 s35, s60, 55296
    s_add_u32 s35, s35, 16777216
    s_lshl_b32 s53, s59, 11
    s_add_u32 s53, s53, s35
    s_add_u32 s54, s53, 1024
    s_lshl_b32 s62, s59, 10
    s_add_u32 s62, s62, s35
    s_add_u32 s62, s62, 30720
    s_lshl_b32 s63, s59, 9
    s_add_u32 s63, s63, s35
    s_add_u32 s63, s63, 47104
    s_cmp_eq_u32 s59, 15
    s_cselect_b32 s53, s62, s53
    s_cselect_b32 s54, 2130706432, s54
    s_cselect_b32 s62, 2130706432, s62
    s_add_u32 s37, s37, 128
    s_add_u32 s42, s37, 128
    v_mov_b32 v224, 0xc09d30fc
    v_mov_b32 v225, 0x3eeff558
    s_waitcnt vmcnt(10)
    s_waitcnt lgkmcnt(6)
    v_mfma_f32_16x16x32_bf16 v[32:35], v[88:91], v[144:147], 0
    ds_read_b128 v[116:119], v24 offset:7168
    v_mfma_f32_16x16x32_bf16 v[60:63], v[88:91], v[148:151], 0
    buffer_load_dwordx2 v[200:201], v4, s[8:11], s27 offen offset:0 sc1
    buffer_load_dwordx2 v[202:203], v4, s[8:11], s27 offen offset:128 sc1
    buffer_load_dwordx2 v[204:205], v4, s[8:11], s27 offen offset:1024 sc1
    buffer_load_dwordx2 v[206:207], v4, s[8:11], s27 offen offset:1152 sc1
    s_waitcnt lgkmcnt(6)
    v_mfma_f32_16x16x32_bf16 v[36:39], v[92:95], v[144:147], 0
    ds_read_b128 v[120:123], v24 offset:8192
    v_mfma_f32_16x16x32_bf16 v[64:67], v[92:95], v[148:151], 0
    s_waitcnt lgkmcnt(6)
    v_mfma_f32_16x16x32_bf16 v[40:43], v[96:99], v[144:147], 0
    ds_read_b128 v[124:127], v24 offset:9216
    v_mfma_f32_16x16x32_bf16 v[68:71], v[96:99], v[148:151], 0
    buffer_load_dwordx4 v[184:187], v5, s[8:11], s26 offen offset:1024 sc1
    s_waitcnt lgkmcnt(6)
    v_mfma_f32_16x16x32_bf16 v[44:47], v[100:103], v[144:147], 0
    ds_read_b128 v[128:131], v24 offset:10240
    v_mfma_f32_16x16x32_bf16 v[72:75], v[100:103], v[148:151], 0
    s_waitcnt lgkmcnt(6)
    v_mfma_f32_16x16x32_bf16 v[48:51], v[104:107], v[144:147], 0
    ds_read_b128 v[132:135], v24 offset:11264
    v_mfma_f32_16x16x32_bf16 v[76:79], v[104:107], v[148:151], 0
    buffer_load_dwordx4 v[188:191], v30, s[8:11], s26 offen offset:1024 sc1
    s_waitcnt lgkmcnt(6)
    v_mfma_f32_16x16x32_bf16 v[52:55], v[108:111], v[144:147], 0
    ds_read_b128 v[136:139], v24 offset:12288
    v_mfma_f32_16x16x32_bf16 v[80:83], v[108:111], v[148:151], 0
    buffer_load_dwordx4 v[192:195], v5, s[8:11], s26 offen offset:2048 sc1
    s_waitcnt lgkmcnt(6)
    v_mfma_f32_16x16x32_bf16 v[56:59], v[112:115], v[144:147], 0
    ds_read_b128 v[140:143], v24 offset:13312
    v_mfma_f32_16x16x32_bf16 v[84:87], v[112:115], v[148:151], 0
    s_waitcnt vmcnt(15)
    s_waitcnt lgkmcnt(6)
    v_mfma_f32_16x16x32_bf16 v[32:35], v[116:119], v[152:155], v[32:35]
    ds_read_b128 v[88:91], v24 offset:14336
    v_mfma_f32_16x16x32_bf16 v[60:63], v[116:119], v[156:159], v[60:63]
    buffer_load_dwordx4 v[196:199], v30, s[8:11], s26 offen offset:2048 sc1
    s_waitcnt lgkmcnt(6)
    v_mfma_f32_16x16x32_bf16 v[36:39], v[120:123], v[152:155], v[36:39]
    ds_read_b128 v[92:95], v24 offset:15360
    v_mfma_f32_16x16x32_bf16 v[64:67], v[120:123], v[156:159], v[64:67]
    s_waitcnt lgkmcnt(6)
    v_mfma_f32_16x16x32_bf16 v[40:43], v[124:127], v[152:155], v[40:43]
    ds_read_b128 v[96:99], v24 offset:16384
    v_mfma_f32_16x16x32_bf16 v[68:71], v[124:127], v[156:159], v[68:71]
    buffer_load_dwordx2 v[144:145], v10, s[8:11], s26 offen offset:3072 sc1
    buffer_load_dwordx2 v[146:147], v10, s[8:11], s26 offen offset:3584 sc1
    s_waitcnt lgkmcnt(6)
    v_mfma_f32_16x16x32_bf16 v[44:47], v[128:131], v[152:155], v[44:47]
    ds_read_b128 v[100:103], v24 offset:17408
    v_mfma_f32_16x16x32_bf16 v[72:75], v[128:131], v[156:159], v[72:75]
    s_waitcnt lgkmcnt(6)
    v_mfma_f32_16x16x32_bf16 v[48:51], v[132:135], v[152:155], v[48:51]
    ds_read_b128 v[104:107], v24 offset:18432
    v_mfma_f32_16x16x32_bf16 v[76:79], v[132:135], v[156:159], v[76:79]
    buffer_load_dwordx2 v[148:149], v31, s[8:11], s26 offen offset:3072 sc1
    buffer_load_dwordx2 v[150:151], v31, s[8:11], s26 offen offset:3584 sc1
    s_waitcnt lgkmcnt(6)
    v_mfma_f32_16x16x32_bf16 v[52:55], v[136:139], v[152:155], v[52:55]
    ds_read_b128 v[108:111], v24 offset:19456
    v_mfma_f32_16x16x32_bf16 v[80:83], v[136:139], v[156:159], v[80:83]
    s_waitcnt lgkmcnt(6)
    v_mfma_f32_16x16x32_bf16 v[56:59], v[140:143], v[152:155], v[56:59]
    ds_read_b128 v[112:115], v24 offset:20480
    v_mfma_f32_16x16x32_bf16 v[84:87], v[140:143], v[156:159], v[84:87]
    s_waitcnt vmcnt(16)
    s_waitcnt lgkmcnt(6)
    v_mfma_f32_16x16x32_bf16 v[32:35], v[88:91], v[160:163], v[32:35]
    ds_read_b128 v[116:119], v24 offset:21504
    v_mfma_f32_16x16x32_bf16 v[60:63], v[88:91], v[164:167], v[60:63]
    s_add_u32 s26, s26, 4096
    buffer_load_dwordx4 v[152:155], v5, s[8:11], s26 offen offset:0 sc1
    s_waitcnt lgkmcnt(6)
    v_mfma_f32_16x16x32_bf16 v[36:39], v[92:95], v[160:163], v[36:39]
    ds_read_b128 v[120:123], v24 offset:22528
    v_mfma_f32_16x16x32_bf16 v[64:67], v[92:95], v[164:167], v[64:67]
    s_waitcnt lgkmcnt(6)
    v_mfma_f32_16x16x32_bf16 v[40:43], v[96:99], v[160:163], v[40:43]
    ds_read_b128 v[124:127], v24 offset:23552
    v_mfma_f32_16x16x32_bf16 v[68:71], v[96:99], v[164:167], v[68:71]
    buffer_load_dwordx4 v[156:159], v30, s[8:11], s26 offen offset:0 sc1
    s_waitcnt lgkmcnt(6)
    v_mfma_f32_16x16x32_bf16 v[44:47], v[100:103], v[160:163], v[44:47]
    ds_read_b128 v[128:131], v24 offset:24576
    v_mfma_f32_16x16x32_bf16 v[72:75], v[100:103], v[164:167], v[72:75]
    s_waitcnt lgkmcnt(6)
    v_mfma_f32_16x16x32_bf16 v[48:51], v[104:107], v[160:163], v[48:51]
    ds_read_b128 v[132:135], v24 offset:25600
    v_mfma_f32_16x16x32_bf16 v[76:79], v[104:107], v[164:167], v[76:79]
    s_waitcnt lgkmcnt(6)
    v_mfma_f32_16x16x32_bf16 v[52:55], v[108:111], v[160:163], v[52:55]
    ds_read_b128 v[136:139], v24 offset:26624
    v_mfma_f32_16x16x32_bf16 v[80:83], v[108:111], v[164:167], v[80:83]
    s_waitcnt lgkmcnt(6)
    v_mfma_f32_16x16x32_bf16 v[56:59], v[112:115], v[160:163], v[56:59]
    ds_read_b128 v[140:143], v24 offset:27648
    v_mfma_f32_16x16x32_bf16 v[84:87], v[112:115], v[164:167], v[84:87]
    s_waitcnt vmcnt(16)
    s_waitcnt lgkmcnt(6)
    v_mfma_f32_16x16x32_bf16 v[32:35], v[116:119], v[168:171], v[32:35]
    ds_read_b128 v[88:91], v24 offset:28672
    v_mfma_f32_16x16x32_bf16 v[60:63], v[116:119], v[172:175], v[60:63]
    buffer_load_dwordx4 v[160:163], v5, s[8:11], s26 offen offset:1024 sc1
    s_waitcnt lgkmcnt(6)
    v_mfma_f32_16x16x32_bf16 v[36:39], v[120:123], v[168:171], v[36:39]
    ds_read_b128 v[92:95], v24 offset:29696
    v_mfma_f32_16x16x32_bf16 v[64:67], v[120:123], v[172:175], v[64:67]
    s_waitcnt lgkmcnt(6)
    v_mfma_f32_16x16x32_bf16 v[40:43], v[124:127], v[168:171], v[40:43]
    ds_read_b128 v[96:99], v24 offset:30720
    v_mfma_f32_16x16x32_bf16 v[68:71], v[124:127], v[172:175], v[68:71]
    buffer_load_dwordx4 v[164:167], v30, s[8:11], s26 offen offset:1024 sc1
    s_waitcnt lgkmcnt(6)
    v_mfma_f32_16x16x32_bf16 v[44:47], v[128:131], v[168:171], v[44:47]
    ds_read_b128 v[100:103], v24 offset:31744
    v_mfma_f32_16x16x32_bf16 v[72:75], v[128:131], v[172:175], v[72:75]
    s_waitcnt lgkmcnt(6)
    v_mfma_f32_16x16x32_bf16 v[48:51], v[132:135], v[168:171], v[48:51]
    ds_read_b128 v[104:107], v24 offset:32768
    v_mfma_f32_16x16x32_bf16 v[76:79], v[132:135], v[172:175], v[76:79]
    s_waitcnt lgkmcnt(6)
    v_mfma_f32_16x16x32_bf16 v[52:55], v[136:139], v[168:171], v[52:55]
    ds_read_b128 v[108:111], v24 offset:33792
    v_mfma_f32_16x16x32_bf16 v[80:83], v[136:139], v[172:175], v[80:83]
    s_waitcnt lgkmcnt(6)
    v_mfma_f32_16x16x32_bf16 v[56:59], v[140:143], v[168:171], v[56:59]
    ds_read_b128 v[112:115], v24 offset:34816
    v_mfma_f32_16x16x32_bf16 v[84:87], v[140:143], v[172:175], v[84:87]
    s_waitcnt vmcnt(16)
    s_waitcnt lgkmcnt(6)
    v_mfma_f32_16x16x32_bf16 v[32:35], v[88:91], v[176:179], v[32:35]
    ds_read_b128 v[116:119], v24 offset:35840
    v_mfma_f32_16x16x32_bf16 v[60:63], v[88:91], v[180:183], v[60:63]
    buffer_load_dwordx4 v[168:171], v5, s[8:11], s26 offen offset:2048 sc1
    s_waitcnt lgkmcnt(6)
    v_mfma_f32_16x16x32_bf16 v[36:39], v[92:95], v[176:179], v[36:39]
    ds_read_b128 v[120:123], v24 offset:36864
    v_mfma_f32_16x16x32_bf16 v[64:67], v[92:95], v[180:183], v[64:67]
    s_waitcnt lgkmcnt(6)
    v_mfma_f32_16x16x32_bf16 v[40:43], v[96:99], v[176:179], v[40:43]
    ds_read_b128 v[124:127], v24 offset:37888
    v_mfma_f32_16x16x32_bf16 v[68:71], v[96:99], v[180:183], v[68:71]
    buffer_load_dwordx4 v[172:175], v30, s[8:11], s26 offen offset:2048 sc1
    s_waitcnt lgkmcnt(6)
    v_mfma_f32_16x16x32_bf16 v[44:47], v[100:103], v[176:179], v[44:47]
    ds_read_b128 v[128:131], v24 offset:38912
    v_mfma_f32_16x16x32_bf16 v[72:75], v[100:103], v[180:183], v[72:75]
    s_waitcnt lgkmcnt(6)
    v_mfma_f32_16x16x32_bf16 v[48:51], v[104:107], v[176:179], v[48:51]
    ds_read_b128 v[132:135], v24 offset:39936
    v_mfma_f32_16x16x32_bf16 v[76:79], v[104:107], v[180:183], v[76:79]
    s_waitcnt lgkmcnt(6)
    v_mfma_f32_16x16x32_bf16 v[52:55], v[108:111], v[176:179], v[52:55]
    ds_read_b128 v[136:139], v24 offset:40960
    v_mfma_f32_16x16x32_bf16 v[80:83], v[108:111], v[180:183], v[80:83]
    s_waitcnt lgkmcnt(6)
    v_mfma_f32_16x16x32_bf16 v[56:59], v[112:115], v[176:179], v[56:59]
    ds_read_b128 v[140:143], v24 offset:41984
    v_mfma_f32_16x16x32_bf16 v[84:87], v[112:115], v[180:183], v[84:87]
    s_waitcnt vmcnt(12)
    s_waitcnt lgkmcnt(6)
    v_mfma_f32_16x16x32_bf16 v[32:35], v[116:119], v[184:187], v[32:35]
    ds_read_b128 v[88:91], v24 offset:43008
    v_mfma_f32_16x16x32_bf16 v[60:63], v[116:119], v[188:191], v[60:63]
    buffer_load_dwordx4 v[176:179], v5, s[8:11], s26 offen offset:3072 sc1
    s_waitcnt lgkmcnt(6)
    v_mfma_f32_16x16x32_bf16 v[36:39], v[120:123], v[184:187], v[36:39]
    ds_read_b128 v[92:95], v24 offset:44032
    v_mfma_f32_16x16x32_bf16 v[64:67], v[120:123], v[188:191], v[64:67]
    s_waitcnt lgkmcnt(6)
    v_mfma_f32_16x16x32_bf16 v[40:43], v[124:127], v[184:187], v[40:43]
    ds_read_b128 v[96:99], v24 offset:45056
    v_mfma_f32_16x16x32_bf16 v[68:71], v[124:127], v[188:191], v[68:71]
    buffer_load_dwordx4 v[180:183], v30, s[8:11], s26 offen offset:3072 sc1
    s_waitcnt lgkmcnt(6)
    v_mfma_f32_16x16x32_bf16 v[44:47], v[128:131], v[184:187], v[44:47]
    ds_read_b128 v[100:103], v24 offset:46080
    v_mfma_f32_16x16x32_bf16 v[72:75], v[128:131], v[188:191], v[72:75]
    s_waitcnt lgkmcnt(6)
    v_mfma_f32_16x16x32_bf16 v[48:51], v[132:135], v[184:187], v[48:51]
    ds_read_b128 v[104:107], v24 offset:47104
    v_mfma_f32_16x16x32_bf16 v[76:79], v[132:135], v[188:191], v[76:79]
    s_waitcnt lgkmcnt(6)
    v_mfma_f32_16x16x32_bf16 v[52:55], v[136:139], v[184:187], v[52:55]
    ds_read_b128 v[108:111], v24 offset:48128
    v_mfma_f32_16x16x32_bf16 v[80:83], v[136:139], v[188:191], v[80:83]
    s_waitcnt lgkmcnt(6)
    v_mfma_f32_16x16x32_bf16 v[56:59], v[140:143], v[184:187], v[56:59]
    ds_read_b128 v[112:115], v24 offset:49152
    v_mfma_f32_16x16x32_bf16 v[84:87], v[140:143], v[188:191], v[84:87]
    s_waitcnt vmcnt(12)
    s_waitcnt vmcnt(16)
    s_waitcnt lgkmcnt(6)
    v_mfma_f32_16x16x32_bf16 v[32:35], v[88:91], v[192:195], v[32:35]
    ds_read_b128 v[116:119], v24 offset:50176
    v_mfma_f32_16x16x32_bf16 v[60:63], v[88:91], v[196:199], v[60:63]
    v_add_f32 v200, v200, v202
    v_add_f32 v204, v204, v206
    s_add_u32 s26, s26, 4096
    buffer_load_dwordx2 v[184:185], v10, s[8:11], s26 offen offset:0 sc1
    buffer_load_dwordx2 v[186:187], v10, s[8:11], s26 offen offset:512 sc1
    s_waitcnt lgkmcnt(6)
    v_mfma_f32_16x16x32_bf16 v[36:39], v[92:95], v[192:195], v[36:39]
    ds_read_b128 v[120:123], v24 offset:51200
    v_mfma_f32_16x16x32_bf16 v[64:67], v[92:95], v[196:199], v[64:67]
    v_add_f32 v201, v201, v203
    v_add_f32 v205, v205, v207
    s_waitcnt lgkmcnt(6)
    v_mfma_f32_16x16x32_bf16 v[40:43], v[96:99], v[192:195], v[40:43]
    ds_read_b128 v[124:127], v24 offset:52224
    v_mfma_f32_16x16x32_bf16 v[68:71], v[96:99], v[196:199], v[68:71]
    v_mov_b32 v202, v200
    v_mov_b32 v206, v204
    buffer_load_dwordx2 v[188:189], v31, s[8:11], s26 offen offset:0 sc1
    buffer_load_dwordx2 v[190:191], v31, s[8:11], s26 offen offset:512 sc1
    s_waitcnt lgkmcnt(6)
    v_mfma_f32_16x16x32_bf16 v[44:47], v[100:103], v[192:195], v[44:47]
    ds_read_b128 v[128:131], v24 offset:53248
    v_mfma_f32_16x16x32_bf16 v[72:75], v[100:103], v[196:199], v[72:75]
    v_mov_b32 v203, v201
    v_mov_b32 v207, v205
    s_waitcnt lgkmcnt(6)
    v_mfma_f32_16x16x32_bf16 v[48:51], v[104:107], v[192:195], v[48:51]
    ds_read_b128 v[132:135], v24 offset:54272
    v_mfma_f32_16x16x32_bf16 v[76:79], v[104:107], v[196:199], v[76:79]
    v_permlane32_swap_b32 v200, v202
    v_permlane32_swap_b32 v204, v206
    s_waitcnt lgkmcnt(6)
    v_mfma_f32_16x16x32_bf16 v[52:55], v[108:111], v[192:195], v[52:55]
    ds_read_b128 v[136:139], v24 offset:55296
    v_mfma_f32_16x16x32_bf16 v[80:83], v[108:111], v[196:199], v[80:83]
    v_permlane32_swap_b32 v201, v203
    v_permlane32_swap_b32 v205, v207
    s_waitcnt lgkmcnt(6)
    v_mfma_f32_16x16x32_bf16 v[56:59], v[112:115], v[192:195], v[56:59]
    ds_read_b128 v[140:143], v24 offset:56320
    v_mfma_f32_16x16x32_bf16 v[84:87], v[112:115], v[196:199], v[84:87]
    v_add_f32 v200, v200, v202
    v_add_f32 v204, v204, v206
    s_barrier
    s_waitcnt vmcnt(12)
    s_waitcnt lgkmcnt(6)
    v_mfma_f32_16x16x32_bf16 v[32:35], v[116:119], v[144:147], v[32:35]
    ds_read_b128 v[88:91], v24 offset:61440
    v_mfma_f32_16x16x32_bf16 v[60:63], v[116:119], v[148:151], v[60:63]
    v_add_f32 v201, v201, v203
    v_add_f32 v205, v205, v207
    buffer_load_dwordx4 v[192:195], v5, s[8:11], s26 offen offset:1024 sc1
    s_waitcnt lgkmcnt(6)
    v_mfma_f32_16x16x32_bf16 v[36:39], v[120:123], v[144:147], v[36:39]
    ds_read_b128 v[92:95], v24 offset:62464
    v_mfma_f32_16x16x32_bf16 v[64:67], v[120:123], v[148:151], v[64:67]
    v_mov_b32 v202, v200
    v_mov_b32 v206, v204
    s_waitcnt lgkmcnt(6)
    v_mfma_f32_16x16x32_bf16 v[40:43], v[124:127], v[144:147], v[40:43]
    ds_read_b128 v[96:99], v24 offset:63488
    v_mfma_f32_16x16x32_bf16 v[68:71], v[124:127], v[148:151], v[68:71]
    v_mov_b32 v203, v201
    v_mov_b32 v207, v205
    buffer_load_dwordx4 v[196:199], v30, s[8:11], s26 offen offset:1024 sc1
    s_waitcnt lgkmcnt(6)
    v_mfma_f32_16x16x32_bf16 v[44:47], v[128:131], v[144:147], v[44:47]
    ds_read_b128 v[100:103], v24 offset:64512
    v_mfma_f32_16x16x32_bf16 v[72:75], v[128:131], v[148:151], v[72:75]
    v_permlane16_swap_b32 v200, v202
    v_permlane16_swap_b32 v204, v206
    s_waitcnt lgkmcnt(6)
    v_mfma_f32_16x16x32_bf16 v[48:51], v[132:135], v[144:147], v[48:51]
    ds_read_b128 v[104:107], v25 offset:0
    v_mfma_f32_16x16x32_bf16 v[76:79], v[132:135], v[148:151], v[76:79]
    v_permlane16_swap_b32 v201, v203
    v_permlane16_swap_b32 v205, v207
    s_waitcnt lgkmcnt(6)
    v_mfma_f32_16x16x32_bf16 v[52:55], v[136:139], v[144:147], v[52:55]
    ds_read_b128 v[108:111], v25 offset:1024
    v_mfma_f32_16x16x32_bf16 v[80:83], v[136:139], v[148:151], v[80:83]
    v_add_f32 v200, v200, v202
    v_add_f32 v204, v204, v206
    s_waitcnt lgkmcnt(6)
    v_mfma_f32_16x16x32_bf16 v[56:59], v[140:143], v[144:147], v[56:59]
    ds_read_b128 v[112:115], v25 offset:2048
    v_mfma_f32_16x16x32_bf16 v[84:87], v[140:143], v[148:151], v[84:87]
    v_add_f32 v201, v201, v203
    v_add_f32 v205, v205, v207
    s_waitcnt vmcnt(12)
    s_waitcnt lgkmcnt(6)
    v_mfma_f32_16x16x32_bf16 v[32:35], v[88:91], v[152:155], v[32:35]
    ds_read_b128 v[116:119], v25 offset:3072
    v_mfma_f32_16x16x32_bf16 v[60:63], v[88:91], v[156:159], v[60:63]
    v_mul_f32 v200, 0xbacccccd, v200
    v_mul_f32 v204, 0xbacccccd, v204
    buffer_load_dwordx4 v[144:147], v5, s[8:11], s26 offen offset:2048 sc1
    s_waitcnt lgkmcnt(6)
    v_mfma_f32_16x16x32_bf16 v[36:39], v[92:95], v[152:155], v[36:39]
    ds_read_b128 v[120:123], v25 offset:4096
    v_mfma_f32_16x16x32_bf16 v[64:67], v[92:95], v[156:159], v[64:67]
    v_mul_f32 v201, 0x3acccccd, v201
    v_mul_f32 v205, 0x3acccccd, v205
    s_waitcnt lgkmcnt(6)
    v_mfma_f32_16x16x32_bf16 v[40:43], v[96:99], v[152:155], v[40:43]
    ds_read_b128 v[124:127], v25 offset:5120
    v_mfma_f32_16x16x32_bf16 v[68:71], v[96:99], v[156:159], v[68:71]
    v_fma_f32 v201, -v200, v200, v201
    v_fma_f32 v205, -v204, v204, v205
    buffer_load_dwordx4 v[148:151], v30, s[8:11], s26 offen offset:2048 sc1
    s_waitcnt lgkmcnt(6)
    v_mfma_f32_16x16x32_bf16 v[44:47], v[100:103], v[152:155], v[44:47]
    ds_read_b128 v[128:131], v25 offset:6144
    v_mfma_f32_16x16x32_bf16 v[72:75], v[100:103], v[156:159], v[72:75]
    v_max_f32 v201, 0, v201
    v_max_f32 v205, 0, v205
    s_waitcnt lgkmcnt(6)
    v_mfma_f32_16x16x32_bf16 v[48:51], v[104:107], v[152:155], v[48:51]
    ds_read_b128 v[132:135], v25 offset:7168
    v_mfma_f32_16x16x32_bf16 v[76:79], v[104:107], v[156:159], v[76:79]
    v_add_f32 v202, 0x3727c5ac, v201
    v_add_f32 v206, 0x3727c5ac, v205
    s_waitcnt lgkmcnt(6)
    v_mfma_f32_16x16x32_bf16 v[52:55], v[108:111], v[152:155], v[52:55]
    ds_read_b128 v[136:139], v25 offset:8192
    v_mfma_f32_16x16x32_bf16 v[80:83], v[108:111], v[156:159], v[80:83]
    v_rsq_f32 v202, v202
    v_rsq_f32 v206, v206
    s_waitcnt lgkmcnt(6)
    v_mfma_f32_16x16x32_bf16 v[56:59], v[112:115], v[152:155], v[56:59]
    ds_read_b128 v[140:143], v25 offset:9216
    v_mfma_f32_16x16x32_bf16 v[84:87], v[112:115], v[156:159], v[84:87]
    v_mul_f32 v203, v202, v202
    v_mul_f32 v207, v206, v206
    s_waitcnt vmcnt(12)
    s_waitcnt lgkmcnt(6)
    v_mfma_f32_16x16x32_bf16 v[32:35], v[116:119], v[160:163], v[32:35]
    ds_read_b128 v[88:91], v25 offset:10240
    v_mfma_f32_16x16x32_bf16 v[60:63], v[116:119], v[164:167], v[60:63]
    v_mul_f32 v203, v203, v201
    v_mul_f32 v207, v207, v205
    buffer_load_dwordx4 v[152:155], v5, s[8:11], s26 offen offset:3072 sc1
    s_waitcnt lgkmcnt(6)
    v_mfma_f32_16x16x32_bf16 v[36:39], v[120:123], v[160:163], v[36:39]
    ds_read_b128 v[92:95], v25 offset:11264
    v_mfma_f32_16x16x32_bf16 v[64:67], v[120:123], v[164:167], v[64:67]
    v_add_f32 v203, 0x3727c5ac, v203
    v_add_f32 v207, 0x3727c5ac, v207
    s_waitcnt lgkmcnt(6)
    v_mfma_f32_16x16x32_bf16 v[40:43], v[124:127], v[160:163], v[40:43]
    ds_read_b128 v[96:99], v25 offset:12288
    v_mfma_f32_16x16x32_bf16 v[68:71], v[124:127], v[164:167], v[68:71]
    v_rsq_f32 v203, v203
    v_rsq_f32 v207, v207
    buffer_load_dwordx4 v[156:159], v30, s[8:11], s26 offen offset:3072 sc1
    s_waitcnt lgkmcnt(6)
    v_mfma_f32_16x16x32_bf16 v[44:47], v[128:131], v[160:163], v[44:47]
    ds_read_b128 v[100:103], v25 offset:13312
    v_mfma_f32_16x16x32_bf16 v[72:75], v[128:131], v[164:167], v[72:75]
    v_mul_f32 v202, v202, v203
    v_mul_f32 v206, v206, v207
    s_waitcnt lgkmcnt(6)
    v_mfma_f32_16x16x32_bf16 v[48:51], v[132:135], v[160:163], v[48:51]
    ds_read_b128 v[104:107], v25 offset:14336
    v_mfma_f32_16x16x32_bf16 v[76:79], v[132:135], v[164:167], v[76:79]
    v_rcp_f32 v201, v202
    v_rcp_f32 v205, v206
    ds_read_b128 v[208:211], v22 offset:0
    ds_read_b128 v[212:215], v22 offset:16
    s_waitcnt lgkmcnt(8)
    v_mfma_f32_16x16x32_bf16 v[52:55], v[136:139], v[160:163], v[52:55]
    ds_read_b128 v[108:111], v25 offset:15360
    v_mfma_f32_16x16x32_bf16 v[80:83], v[136:139], v[164:167], v[80:83]
    v_mul_f32 v202, 0x3eeff558, v202
    v_mul_f32 v206, 0x3eeff558, v206
    s_waitcnt lgkmcnt(8)
    v_mfma_f32_16x16x32_bf16 v[56:59], v[140:143], v[160:163], v[56:59]
    ds_read_b128 v[112:115], v25 offset:16384
    v_mfma_f32_16x16x32_bf16 v[84:87], v[140:143], v[164:167], v[84:87]
    s_waitcnt vmcnt(12)
    s_waitcnt lgkmcnt(8)
    v_mfma_f32_16x16x32_bf16 v[32:35], v[88:91], v[168:171], v[32:35]
    ds_read_b128 v[116:119], v25 offset:17408
    v_mfma_f32_16x16x32_bf16 v[60:63], v[88:91], v[172:175], v[60:63]
    s_add_u32 s26, s26, 4096
    buffer_load_dwordx4 v[160:163], v5, s[8:11], s26 offen offset:0 sc1
    s_waitcnt lgkmcnt(8)
    v_mfma_f32_16x16x32_bf16 v[36:39], v[92:95], v[168:171], v[36:39]
    ds_read_b128 v[120:123], v25 offset:18432
    v_mfma_f32_16x16x32_bf16 v[64:67], v[92:95], v[172:175], v[64:67]
    s_waitcnt lgkmcnt(8)
    v_mfma_f32_16x16x32_bf16 v[40:43], v[96:99], v[168:171], v[40:43]
    ds_read_b128 v[124:127], v25 offset:19456
    v_mfma_f32_16x16x32_bf16 v[68:71], v[96:99], v[172:175], v[68:71]
    buffer_load_dwordx4 v[164:167], v30, s[8:11], s26 offen offset:0 sc1
    s_waitcnt lgkmcnt(8)
    v_mfma_f32_16x16x32_bf16 v[44:47], v[100:103], v[168:171], v[44:47]
    ds_read_b128 v[128:131], v25 offset:20480
    s_waitcnt lgkmcnt(6)
    v_fmac_f32 v32, v200, v208
    v_fmac_f32 v33, v200, v209
    v_mfma_f32_16x16x32_bf16 v[72:75], v[100:103], v[172:175], v[72:75]
    v_fmac_f32 v34, v200, v210
    v_fmac_f32 v35, v200, v211
    v_mfma_f32_16x16x32_bf16 v[48:51], v[104:107], v[168:171], v[48:51]
    ds_read_b128 v[132:135], v25 offset:21504
    v_fmac_f32 v32, v201, v212
    v_fmac_f32 v33, v201, v213
    v_mfma_f32_16x16x32_bf16 v[76:79], v[104:107], v[172:175], v[76:79]
    v_fmac_f32 v34, v201, v214
    v_fmac_f32 v35, v201, v215
    v_fmac_f32 v60, v204, v208
    s_waitcnt lgkmcnt(6)
    v_mfma_f32_16x16x32_bf16 v[52:55], v[108:111], v[168:171], v[52:55]
    ds_read_b128 v[136:139], v25 offset:22528
    v_fmac_f32 v61, v204, v209
    v_fmac_f32 v62, v204, v210
    v_mfma_f32_16x16x32_bf16 v[80:83], v[108:111], v[172:175], v[80:83]
    v_fmac_f32 v63, v204, v211
    v_fmac_f32 v60, v205, v212
    ds_read_b128 v[216:219], v22 offset:128
    ds_read_b128 v[220:223], v22 offset:144
    s_waitcnt lgkmcnt(8)
    v_mfma_f32_16x16x32_bf16 v[56:59], v[112:115], v[168:171], v[56:59]
    ds_read_b128 v[140:143], v25 offset:23552
    v_fmac_f32 v61, v205, v213
    v_fmac_f32 v62, v205, v214
    v_fmac_f32 v63, v205, v215
    v_mfma_f32_16x16x32_bf16 v[84:87], v[112:115], v[172:175], v[84:87]
    s_waitcnt vmcnt(12)
    s_waitcnt lgkmcnt(8)
    v_mfma_f32_16x16x32_bf16 v[32:35], v[116:119], v[176:179], v[32:35]
    ds_read_b128 v[88:91], v25 offset:24576
    v_mfma_f32_16x16x32_bf16 v[60:63], v[116:119], v[180:183], v[60:63]
    buffer_load_dwordx2 v[168:169], v10, s[8:11], s26 offen offset:1024 sc1
    buffer_load_dwordx2 v[170:171], v10, s[8:11], s26 offen offset:1536 sc1
    s_waitcnt lgkmcnt(8)
    v_mfma_f32_16x16x32_bf16 v[36:39], v[120:123], v[176:179], v[36:39]
    ds_read_b128 v[92:95], v25 offset:25600
    v_mfma_f32_16x16x32_bf16 v[64:67], v[120:123], v[180:183], v[64:67]
    s_waitcnt lgkmcnt(8)
    v_mfma_f32_16x16x32_bf16 v[40:43], v[124:127], v[176:179], v[40:43]
    ds_read_b128 v[96:99], v25 offset:26624
    v_mfma_f32_16x16x32_bf16 v[68:71], v[124:127], v[180:183], v[68:71]
    buffer_load_dwordx2 v[172:173], v31, s[8:11], s26 offen offset:1024 sc1
    buffer_load_dwordx2 v[174:175], v31, s[8:11], s26 offen offset:1536 sc1
    s_waitcnt lgkmcnt(8)
    v_mfma_f32_16x16x32_bf16 v[44:47], v[128:131], v[176:179], v[44:47]
    ds_read_b128 v[100:103], v25 offset:27648
    v_mfma_f32_16x16x32_bf16 v[72:75], v[128:131], v[180:183], v[72:75]
    s_waitcnt lgkmcnt(8)
    v_mfma_f32_16x16x32_bf16 v[48:51], v[132:135], v[176:179], v[48:51]
    ds_read_b128 v[104:107], v25 offset:28672
    s_waitcnt lgkmcnt(6)
    v_fmac_f32 v36, v200, v216
    v_fmac_f32 v37, v200, v217
    v_mfma_f32_16x16x32_bf16 v[76:79], v[132:135], v[180:183], v[76:79]
    v_fmac_f32 v38, v200, v218
    v_fmac_f32 v39, v200, v219
    v_mfma_f32_16x16x32_bf16 v[52:55], v[136:139], v[176:179], v[52:55]
    ds_read_b128 v[108:111], v25 offset:29696
    v_fmac_f32 v36, v201, v220
    v_fmac_f32 v37, v201, v221
    v_mfma_f32_16x16x32_bf16 v[80:83], v[136:139], v[180:183], v[80:83]
    v_fmac_f32 v38, v201, v222
    v_fmac_f32 v39, v201, v223
    v_fmac_f32 v64, v204, v216
    s_waitcnt lgkmcnt(6)
    v_mfma_f32_16x16x32_bf16 v[56:59], v[140:143], v[176:179], v[56:59]
    ds_read_b128 v[112:115], v25 offset:30720
    v_fmac_f32 v65, v204, v217
    v_fmac_f32 v66, v204, v218
    v_mfma_f32_16x16x32_bf16 v[84:87], v[140:143], v[180:183], v[84:87]
    v_fmac_f32 v67, v204, v219
    v_fmac_f32 v64, v205, v220
    ds_read_b128 v[208:211], v22 offset:256
    ds_read_b128 v[212:215], v22 offset:272
    s_waitcnt vmcnt(12)
    s_waitcnt lgkmcnt(8)
    v_mfma_f32_16x16x32_bf16 v[32:35], v[88:91], v[184:187], v[32:35]
    ds_read_b128 v[116:119], v25 offset:31744
    v_fmac_f32 v65, v205, v221
    v_fmac_f32 v66, v205, v222
    v_fmac_f32 v67, v205, v223
    v_mfma_f32_16x16x32_bf16 v[60:63], v[88:91], v[188:191], v[60:63]
    buffer_load_dwordx4 v[176:179], v5, s[8:11], s26 offen offset:2048 sc1
    s_waitcnt lgkmcnt(8)
    v_mfma_f32_16x16x32_bf16 v[36:39], v[92:95], v[184:187], v[36:39]
    ds_read_b128 v[120:123], v25 offset:32768
    v_mfma_f32_16x16x32_bf16 v[64:67], v[92:95], v[188:191], v[64:67]
    s_waitcnt lgkmcnt(8)
    v_mfma_f32_16x16x32_bf16 v[40:43], v[96:99], v[184:187], v[40:43]
    ds_read_b128 v[124:127], v25 offset:33792
    v_mfma_f32_16x16x32_bf16 v[68:71], v[96:99], v[188:191], v[68:71]
    buffer_load_dwordx4 v[180:183], v30, s[8:11], s26 offen offset:2048 sc1
    s_waitcnt lgkmcnt(8)
    v_mfma_f32_16x16x32_bf16 v[44:47], v[100:103], v[184:187], v[44:47]
    ds_read_b128 v[128:131], v25 offset:34816
    v_mfma_f32_16x16x32_bf16 v[72:75], v[100:103], v[188:191], v[72:75]
    s_waitcnt lgkmcnt(8)
    v_mfma_f32_16x16x32_bf16 v[48:51], v[104:107], v[184:187], v[48:51]
    ds_read_b128 v[132:135], v25 offset:35840
    v_mfma_f32_16x16x32_bf16 v[76:79], v[104:107], v[188:191], v[76:79]
    s_waitcnt lgkmcnt(8)
    v_mfma_f32_16x16x32_bf16 v[52:55], v[108:111], v[184:187], v[52:55]
    ds_read_b128 v[136:139], v25 offset:36864
    s_waitcnt lgkmcnt(6)
    v_fmac_f32 v40, v200, v208
    v_fmac_f32 v41, v200, v209
    v_mfma_f32_16x16x32_bf16 v[80:83], v[108:111], v[188:191], v[80:83]
    v_fmac_f32 v42, v200, v210
    v_fmac_f32 v43, v200, v211
    v_mfma_f32_16x16x32_bf16 v[56:59], v[112:115], v[184:187], v[56:59]
    ds_read_b128 v[140:143], v25 offset:37888
    v_fmac_f32 v40, v201, v212
    v_fmac_f32 v41, v201, v213
    v_mfma_f32_16x16x32_bf16 v[84:87], v[112:115], v[188:191], v[84:87]
    v_fmac_f32 v42, v201, v214
    v_fmac_f32 v43, v201, v215
    v_fmac_f32 v68, v204, v208
    s_waitcnt vmcnt(12)
    s_waitcnt lgkmcnt(6)
    v_mfma_f32_16x16x32_bf16 v[32:35], v[116:119], v[192:195], v[32:35]
    ds_read_b128 v[88:91], v25 offset:38912
    v_fmac_f32 v69, v204, v209
    v_fmac_f32 v70, v204, v210
    v_mfma_f32_16x16x32_bf16 v[60:63], v[116:119], v[196:199], v[60:63]
    v_fmac_f32 v71, v204, v211
    v_fmac_f32 v68, v205, v212
    ds_read_b128 v[216:219], v22 offset:384
    ds_read_b128 v[220:223], v22 offset:400
    buffer_load_dwordx4 v[184:187], v5, s[8:11], s26 offen offset:3072 sc1
    s_waitcnt lgkmcnt(8)
    v_mfma_f32_16x16x32_bf16 v[36:39], v[120:123], v[192:195], v[36:39]
    ds_read_b128 v[92:95], v25 offset:39936
    v_fmac_f32 v69, v205, v213
    v_fmac_f32 v70, v205, v214
    v_fmac_f32 v71, v205, v215
    v_mfma_f32_16x16x32_bf16 v[64:67], v[120:123], v[196:199], v[64:67]
    s_waitcnt lgkmcnt(8)
    v_mfma_f32_16x16x32_bf16 v[40:43], v[124:127], v[192:195], v[40:43]
    ds_read_b128 v[96:99], v25 offset:40960
    v_mfma_f32_16x16x32_bf16 v[68:71], v[124:127], v[196:199], v[68:71]
    buffer_load_dwordx4 v[188:191], v30, s[8:11], s26 offen offset:3072 sc1
    s_waitcnt lgkmcnt(8)
    v_mfma_f32_16x16x32_bf16 v[44:47], v[128:131], v[192:195], v[44:47]
    ds_read_b128 v[100:103], v25 offset:41984
    v_mfma_f32_16x16x32_bf16 v[72:75], v[128:131], v[196:199], v[72:75]
    s_waitcnt lgkmcnt(8)
    v_mfma_f32_16x16x32_bf16 v[48:51], v[132:135], v[192:195], v[48:51]
    ds_read_b128 v[104:107], v25 offset:43008
    v_mfma_f32_16x16x32_bf16 v[76:79], v[132:135], v[196:199], v[76:79]
    s_waitcnt lgkmcnt(8)
    v_mfma_f32_16x16x32_bf16 v[52:55], v[136:139], v[192:195], v[52:55]
    ds_read_b128 v[108:111], v25 offset:44032
    v_mfma_f32_16x16x32_bf16 v[80:83], v[136:139], v[196:199], v[80:83]
    s_waitcnt lgkmcnt(8)
    v_mfma_f32_16x16x32_bf16 v[56:59], v[140:143], v[192:195], v[56:59]
    ds_read_b128 v[112:115], v25 offset:45056
    s_waitcnt lgkmcnt(6)
    v_fmac_f32 v44, v200, v216
    v_fmac_f32 v45, v200, v217
    v_mfma_f32_16x16x32_bf16 v[84:87], v[140:143], v[196:199], v[84:87]
    v_fmac_f32 v46, v200, v218
    v_fmac_f32 v47, v200, v219
    s_barrier
    s_waitcnt vmcnt(12)
    v_mfma_f32_16x16x32_bf16 v[32:35], v[88:91], v[144:147], v[32:35]
    ds_read_b128 v[116:119], v25 offset:46080
    v_fmac_f32 v44, v201, v220
    v_fmac_f32 v45, v201, v221
    v_mfma_f32_16x16x32_bf16 v[60:63], v[88:91], v[148:151], v[60:63]
    v_fmac_f32 v46, v201, v222
    v_fmac_f32 v47, v201, v223
    v_fmac_f32 v72, v204, v216
    s_waitcnt lgkmcnt(6)
    v_mfma_f32_16x16x32_bf16 v[36:39], v[92:95], v[144:147], v[36:39]
    ds_read_b128 v[120:123], v25 offset:47104
    v_fmac_f32 v73, v204, v217
    v_fmac_f32 v74, v204, v218
    v_mfma_f32_16x16x32_bf16 v[64:67], v[92:95], v[148:151], v[64:67]
    v_fmac_f32 v75, v204, v219
    v_fmac_f32 v72, v205, v220
    ds_read_b128 v[208:211], v22 offset:512
    ds_read_b128 v[212:215], v22 offset:528
    s_waitcnt lgkmcnt(8)
    v_mfma_f32_16x16x32_bf16 v[40:43], v[96:99], v[144:147], v[40:43]
    ds_read_b128 v[124:127], v25 offset:48128
    v_fmac_f32 v73, v205, v221
    v_fmac_f32 v74, v205, v222
    v_fmac_f32 v75, v205, v223
    v_mfma_f32_16x16x32_bf16 v[68:71], v[96:99], v[148:151], v[68:71]
    s_waitcnt lgkmcnt(8)
    v_mfma_f32_16x16x32_bf16 v[44:47], v[100:103], v[144:147], v[44:47]
    ds_read_b128 v[128:131], v25 offset:49152
    v_mfma_f32_16x16x32_bf16 v[72:75], v[100:103], v[148:151], v[72:75]
    s_waitcnt lgkmcnt(8)
    v_mfma_f32_16x16x32_bf16 v[48:51], v[104:107], v[144:147], v[48:51]
    ds_read_b128 v[132:135], v25 offset:50176
    v_mfma_f32_16x16x32_bf16 v[76:79], v[104:107], v[148:151], v[76:79]
    s_waitcnt lgkmcnt(8)
    v_mfma_f32_16x16x32_bf16 v[52:55], v[108:111], v[144:147], v[52:55]
    ds_read_b128 v[136:139], v25 offset:51200
    v_mfma_f32_16x16x32_bf16 v[80:83], v[108:111], v[148:151], v[80:83]
    s_waitcnt lgkmcnt(8)
    v_mfma_f32_16x16x32_bf16 v[56:59], v[112:115], v[144:147], v[56:59]
    ds_read_b128 v[140:143], v25 offset:52224
    v_mfma_f32_16x16x32_bf16 v[84:87], v[112:115], v[148:151], v[84:87]
    s_waitcnt vmcnt(10)
    s_waitcnt lgkmcnt(8)
    v_mfma_f32_16x16x32_bf16 v[32:35], v[116:119], v[152:155], v[32:35]
    ds_read_b128 v[88:91], v25 offset:53248
    s_waitcnt lgkmcnt(6)
    v_fmac_f32 v48, v200, v208
    v_fmac_f32 v49, v200, v209
    v_mfma_f32_16x16x32_bf16 v[60:63], v[116:119], v[156:159], v[60:63]
    v_fmac_f32 v50, v200, v210
    v_fmac_f32 v51, v200, v211
    v_mfma_f32_16x16x32_bf16 v[36:39], v[120:123], v[152:155], v[36:39]
    ds_read_b128 v[92:95], v25 offset:54272
    v_fmac_f32 v48, v201, v212
    v_fmac_f32 v49, v201, v213
    v_mfma_f32_16x16x32_bf16 v[64:67], v[120:123], v[156:159], v[64:67]
    v_fmac_f32 v50, v201, v214
    v_fmac_f32 v51, v201, v215
    v_fmac_f32 v76, v204, v208
    s_waitcnt lgkmcnt(6)
    v_mfma_f32_16x16x32_bf16 v[40:43], v[124:127], v[152:155], v[40:43]
    ds_read_b128 v[96:99], v25 offset:55296
    v_fmac_f32 v77, v204, v209
    v_fmac_f32 v78, v204, v210
    v_mfma_f32_16x16x32_bf16 v[68:71], v[124:127], v[156:159], v[68:71]
    v_fmac_f32 v79, v204, v211
    v_fmac_f32 v76, v205, v212
    ds_read_b128 v[216:219], v22 offset:640
    ds_read_b128 v[220:223], v22 offset:656
    s_waitcnt lgkmcnt(8)
    v_mfma_f32_16x16x32_bf16 v[44:47], v[128:131], v[152:155], v[44:47]
    ds_read_b128 v[100:103], v25 offset:56320
    v_fmac_f32 v77, v205, v213
    v_fmac_f32 v78, v205, v214
    v_fmac_f32 v79, v205, v215
    v_mfma_f32_16x16x32_bf16 v[72:75], v[128:131], v[156:159], v[72:75]
    s_waitcnt lgkmcnt(8)
    v_mfma_f32_16x16x32_bf16 v[48:51], v[132:135], v[152:155], v[48:51]
    ds_read_b128 v[104:107], v25 offset:57344
    v_mfma_f32_16x16x32_bf16 v[76:79], v[132:135], v[156:159], v[76:79]
    s_waitcnt lgkmcnt(8)
    v_mfma_f32_16x16x32_bf16 v[52:55], v[136:139], v[152:155], v[52:55]
    ds_read_b128 v[108:111], v25 offset:58368
    v_mfma_f32_16x16x32_bf16 v[80:83], v[136:139], v[156:159], v[80:83]
    s_waitcnt lgkmcnt(8)
    v_mfma_f32_16x16x32_bf16 v[56:59], v[140:143], v[152:155], v[56:59]
    ds_read_b128 v[112:115], v25 offset:59392
    v_mfma_f32_16x16x32_bf16 v[84:87], v[140:143], v[156:159], v[84:87]
    s_waitcnt vmcnt(8)
    s_waitcnt lgkmcnt(8)
    v_mfma_f32_16x16x32_bf16 v[32:35], v[88:91], v[160:163], v[32:35]
    ds_read_b128 v[116:119], v25 offset:60416
    v_mfma_f32_16x16x32_bf16 v[60:63], v[88:91], v[164:167], v[60:63]
    s_waitcnt lgkmcnt(8)
    v_mfma_f32_16x16x32_bf16 v[36:39], v[92:95], v[160:163], v[36:39]
    ds_read_b128 v[120:123], v25 offset:61440
    s_waitcnt lgkmcnt(6)
    v_fmac_f32 v52, v200, v216
    v_fmac_f32 v53, v200, v217
    v_mfma_f32_16x16x32_bf16 v[64:67], v[92:95], v[164:167], v[64:67]
    v_fmac_f32 v54, v200, v218
    v_fmac_f32 v55, v200, v219
    v_mfma_f32_16x16x32_bf16 v[40:43], v[96:99], v[160:163], v[40:43]
    ds_read_b128 v[124:127], v25 offset:62464
    v_fmac_f32 v52, v201, v220
    v_fmac_f32 v53, v201, v221
    v_mfma_f32_16x16x32_bf16 v[68:71], v[96:99], v[164:167], v[68:71]
    v_fmac_f32 v54, v201, v222
    v_fmac_f32 v55, v201, v223
    v_fmac_f32 v80, v204, v216
    s_waitcnt lgkmcnt(6)
    v_mfma_f32_16x16x32_bf16 v[44:47], v[100:103], v[160:163], v[44:47]
    ds_read_b128 v[128:131], v25 offset:63488
    v_fmac_f32 v81, v204, v217
    v_fmac_f32 v82, v204, v218
    v_mfma_f32_16x16x32_bf16 v[72:75], v[100:103], v[164:167], v[72:75]
    v_fmac_f32 v83, v204, v219
    v_fmac_f32 v80, v205, v220
    ds_read_b128 v[208:211], v22 offset:768
    ds_read_b128 v[212:215], v22 offset:784
    s_waitcnt lgkmcnt(8)
    v_mfma_f32_16x16x32_bf16 v[48:51], v[104:107], v[160:163], v[48:51]
    ds_read_b128 v[132:135], v25 offset:64512
    v_fmac_f32 v81, v205, v221
    v_fmac_f32 v82, v205, v222
    v_fmac_f32 v83, v205, v223
    v_mfma_f32_16x16x32_bf16 v[76:79], v[104:107], v[164:167], v[76:79]
    s_waitcnt lgkmcnt(8)
    v_mfma_f32_16x16x32_bf16 v[52:55], v[108:111], v[160:163], v[52:55]
    ds_read_b128 v[136:139], v26 offset:0
    v_mfma_f32_16x16x32_bf16 v[80:83], v[108:111], v[164:167], v[80:83]
    s_waitcnt lgkmcnt(8)
    v_mfma_f32_16x16x32_bf16 v[56:59], v[112:115], v[160:163], v[56:59]
    ds_read_b128 v[140:143], v26 offset:1024
    v_mfma_f32_16x16x32_bf16 v[84:87], v[112:115], v[164:167], v[84:87]
    s_waitcnt vmcnt(4)
    s_waitcnt lgkmcnt(8)
    v_mfma_f32_16x16x32_bf16 v[32:35], v[116:119], v[168:171], v[32:35]
    ds_read_b128 v[88:91], v26 offset:2048
    v_mfma_f32_16x16x32_bf16 v[60:63], v[116:119], v[172:175], v[60:63]
    s_waitcnt lgkmcnt(8)
    v_mfma_f32_16x16x32_bf16 v[36:39], v[120:123], v[168:171], v[36:39]
    ds_read_b128 v[92:95], v26 offset:3072
    v_mfma_f32_16x16x32_bf16 v[64:67], v[120:123], v[172:175], v[64:67]
    s_waitcnt lgkmcnt(8)
    v_mfma_f32_16x16x32_bf16 v[40:43], v[124:127], v[168:171], v[40:43]
    ds_read_b128 v[96:99], v26 offset:4096
    s_waitcnt lgkmcnt(6)
    v_fmac_f32 v56, v200, v208
    v_fmac_f32 v57, v200, v209
    v_mfma_f32_16x16x32_bf16 v[68:71], v[124:127], v[172:175], v[68:71]
    v_fmac_f32 v58, v200, v210
    v_fmac_f32 v59, v200, v211
    v_mfma_f32_16x16x32_bf16 v[44:47], v[128:131], v[168:171], v[44:47]
    ds_read_b128 v[100:103], v26 offset:5120
    v_fmac_f32 v56, v201, v212
    v_fmac_f32 v57, v201, v213
    v_mfma_f32_16x16x32_bf16 v[72:75], v[128:131], v[172:175], v[72:75]
    v_fmac_f32 v58, v201, v214
    v_fmac_f32 v59, v201, v215
    v_fmac_f32 v84, v204, v208
    s_waitcnt lgkmcnt(6)
    v_mfma_f32_16x16x32_bf16 v[48:51], v[132:135], v[168:171], v[48:51]
    ds_read_b128 v[104:107], v26 offset:6144
    v_fmac_f32 v85, v204, v209
    v_fmac_f32 v86, v204, v210
    v_mfma_f32_16x16x32_bf16 v[76:79], v[132:135], v[172:175], v[76:79]
    v_fmac_f32 v87, v204, v211
    v_fmac_f32 v84, v205, v212
    s_waitcnt lgkmcnt(6)
    v_mfma_f32_16x16x32_bf16 v[52:55], v[136:139], v[168:171], v[52:55]
    ds_read_b128 v[108:111], v26 offset:7168
    v_fmac_f32 v85, v205, v213
    v_fmac_f32 v86, v205, v214
    v_fmac_f32 v87, v205, v215
    v_mfma_f32_16x16x32_bf16 v[80:83], v[136:139], v[172:175], v[80:83]
    s_waitcnt lgkmcnt(6)
    v_mfma_f32_16x16x32_bf16 v[56:59], v[140:143], v[168:171], v[56:59]
    ds_read_b128 v[112:115], v26 offset:8192
    v_mfma_f32_16x16x32_bf16 v[84:87], v[140:143], v[172:175], v[84:87]
    s_waitcnt vmcnt(2)
    s_waitcnt lgkmcnt(6)
    v_mfma_f32_16x16x32_bf16 v[32:35], v[88:91], v[176:179], v[32:35]
    ds_read_b128 v[116:119], v26 offset:9216
    v_mfma_f32_16x16x32_bf16 v[60:63], v[88:91], v[180:183], v[60:63]
    s_waitcnt lgkmcnt(6)
    v_mfma_f32_16x16x32_bf16 v[36:39], v[92:95], v[176:179], v[36:39]
    ds_read_b128 v[120:123], v26 offset:10240
    v_mfma_f32_16x16x32_bf16 v[64:67], v[92:95], v[180:183], v[64:67]
    s_waitcnt lgkmcnt(6)
    v_mfma_f32_16x16x32_bf16 v[40:43], v[96:99], v[176:179], v[40:43]
    ds_read_b128 v[124:127], v26 offset:11264
    v_mfma_f32_16x16x32_bf16 v[68:71], v[96:99], v[180:183], v[68:71]
    s_waitcnt lgkmcnt(6)
    v_mfma_f32_16x16x32_bf16 v[44:47], v[100:103], v[176:179], v[44:47]
    ds_read_b128 v[128:131], v26 offset:12288
    v_mfma_f32_16x16x32_bf16 v[72:75], v[100:103], v[180:183], v[72:75]
    s_waitcnt lgkmcnt(6)
    v_mfma_f32_16x16x32_bf16 v[48:51], v[104:107], v[176:179], v[48:51]
    ds_read_b128 v[132:135], v26 offset:13312
    v_mfma_f32_16x16x32_bf16 v[76:79], v[104:107], v[180:183], v[76:79]
    s_waitcnt lgkmcnt(6)
    v_mfma_f32_16x16x32_bf16 v[52:55], v[108:111], v[176:179], v[52:55]
    ds_read_b128 v[136:139], v26 offset:14336
    v_mfma_f32_16x16x32_bf16 v[80:83], v[108:111], v[180:183], v[80:83]
    s_waitcnt lgkmcnt(6)
    v_mfma_f32_16x16x32_bf16 v[56:59], v[112:115], v[176:179], v[56:59]
    ds_read_b128 v[140:143], v26 offset:15360
    v_mfma_f32_16x16x32_bf16 v[84:87], v[112:115], v[180:183], v[84:87]
    s_waitcnt vmcnt(0)
    s_waitcnt lgkmcnt(6)
    v_mfma_f32_16x16x32_bf16 v[32:35], v[116:119], v[184:187], v[32:35]
    v_mfma_f32_16x16x32_bf16 v[60:63], v[116:119], v[188:191], v[60:63]
    s_waitcnt lgkmcnt(5)
    v_mfma_f32_16x16x32_bf16 v[36:39], v[120:123], v[184:187], v[36:39]
    v_mfma_f32_16x16x32_bf16 v[64:67], v[120:123], v[188:191], v[64:67]
    s_waitcnt lgkmcnt(4)
    v_mfma_f32_16x16x32_bf16 v[40:43], v[124:127], v[184:187], v[40:43]
    v_mfma_f32_16x16x32_bf16 v[68:71], v[124:127], v[188:191], v[68:71]
    s_waitcnt lgkmcnt(3)
    v_mfma_f32_16x16x32_bf16 v[44:47], v[128:131], v[184:187], v[44:47]
    v_mfma_f32_16x16x32_bf16 v[72:75], v[128:131], v[188:191], v[72:75]
    s_waitcnt lgkmcnt(2)
    v_mfma_f32_16x16x32_bf16 v[48:51], v[132:135], v[184:187], v[48:51]
    v_mfma_f32_16x16x32_bf16 v[76:79], v[132:135], v[188:191], v[76:79]
    s_waitcnt lgkmcnt(1)
    v_mfma_f32_16x16x32_bf16 v[52:55], v[136:139], v[184:187], v[52:55]
    v_mfma_f32_16x16x32_bf16 v[80:83], v[136:139], v[188:191], v[80:83]
    s_waitcnt lgkmcnt(0)
    v_mfma_f32_16x16x32_bf16 v[56:59], v[140:143], v[184:187], v[56:59]
    v_mfma_f32_16x16x32_bf16 v[84:87], v[140:143], v[188:191], v[84:87]
    s_barrier
    v_add_u32 v30, 55296, v5
    v_add_u32 v31, 55296, v10
    v_pk_mul_f32 v[32:33], v[32:33], v[202:203] op_sel_hi:[1,0]
    v_pk_mul_f32 v[34:35], v[34:35], v[202:203] op_sel_hi:[1,0]
    v_pk_mul_f32 v[36:37], v[36:37], v[202:203] op_sel_hi:[1,0]
    v_pk_mul_f32 v[38:39], v[38:39], v[202:203] op_sel_hi:[1,0]
    v_pk_fma_f32 v[88:89], v[32:33], v[32:33], v[224:225] op_sel_hi:[1,1,0] neg_lo:[1,0,0] neg_hi:[1,0,0]
    v_pk_fma_f32 v[90:91], v[34:35], v[34:35], v[224:225] op_sel_hi:[1,1,0] neg_lo:[1,0,0] neg_hi:[1,0,0]
    v_pk_fma_f32 v[92:93], v[36:37], v[36:37], v[224:225] op_sel_hi:[1,1,0] neg_lo:[1,0,0] neg_hi:[1,0,0]
    v_pk_fma_f32 v[94:95], v[38:39], v[38:39], v[224:225] op_sel_hi:[1,1,0] neg_lo:[1,0,0] neg_hi:[1,0,0]
    v_pk_mul_f32 v[88:89], v[88:89], v[32:33]
    v_pk_mul_f32 v[90:91], v[90:91], v[34:35]
    v_pk_mul_f32 v[92:93], v[92:93], v[36:37]
    v_pk_mul_f32 v[94:95], v[94:95], v[38:39]
    v_exp_f32 v88, v88
    v_exp_f32 v89, v89
    v_exp_f32 v90, v90
    v_exp_f32 v91, v91
    v_exp_f32 v92, v92
    v_exp_f32 v93, v93
    v_exp_f32 v94, v94
    v_exp_f32 v95, v95
    v_pk_fma_f32 v[88:89], v[88:89], v[224:225], v[224:225] op_sel:[0,1,1] op_sel_hi:[1,1,1]
    v_pk_fma_f32 v[90:91], v[90:91], v[224:225], v[224:225] op_sel:[0,1,1] op_sel_hi:[1,1,1]
    v_pk_fma_f32 v[92:93], v[92:93], v[224:225], v[224:225] op_sel:[0,1,1] op_sel_hi:[1,1,1]
    v_pk_fma_f32 v[94:95], v[94:95], v[224:225], v[224:225] op_sel:[0,1,1] op_sel_hi:[1,1,1]
    v_rcp_f32 v88, v88
    v_rcp_f32 v89, v89
    v_rcp_f32 v90, v90
    v_rcp_f32 v91, v91
    v_rcp_f32 v92, v92
    v_rcp_f32 v93, v93
    v_rcp_f32 v94, v94
    v_rcp_f32 v95, v95
    v_pk_mul_f32 v[32:33], v[32:33], v[88:89]
    v_pk_mul_f32 v[34:35], v[34:35], v[90:91]
    v_pk_mul_f32 v[36:37], v[36:37], v[92:93]
    v_pk_mul_f32 v[38:39], v[38:39], v[94:95]
    v_cvt_pk_bf16_f32 v116, v32, v33
    v_cvt_pk_bf16_f32 v117, v34, v35
    v_cvt_pk_bf16_f32 v118, v36, v37
    v_cvt_pk_bf16_f32 v119, v38, v39
    buffer_store_dwordx4 v[116:119], v5, s[8:11], s53 offen sc1
    v_pk_mul_f32 v[60:61], v[60:61], v[206:207] op_sel_hi:[1,0]
    v_pk_mul_f32 v[62:63], v[62:63], v[206:207] op_sel_hi:[1,0]
    v_pk_mul_f32 v[64:65], v[64:65], v[206:207] op_sel_hi:[1,0]
    v_pk_mul_f32 v[66:67], v[66:67], v[206:207] op_sel_hi:[1,0]
    v_pk_fma_f32 v[96:97], v[60:61], v[60:61], v[224:225] op_sel_hi:[1,1,0] neg_lo:[1,0,0] neg_hi:[1,0,0]
    v_pk_fma_f32 v[98:99], v[62:63], v[62:63], v[224:225] op_sel_hi:[1,1,0] neg_lo:[1,0,0] neg_hi:[1,0,0]
    v_pk_fma_f32 v[100:101], v[64:65], v[64:65], v[224:225] op_sel_hi:[1,1,0] neg_lo:[1,0,0] neg_hi:[1,0,0]
    v_pk_fma_f32 v[102:103], v[66:67], v[66:67], v[224:225] op_sel_hi:[1,1,0] neg_lo:[1,0,0] neg_hi:[1,0,0]
    v_pk_mul_f32 v[96:97], v[96:97], v[60:61]
    v_pk_mul_f32 v[98:99], v[98:99], v[62:63]
    v_pk_mul_f32 v[100:101], v[100:101], v[64:65]
    v_pk_mul_f32 v[102:103], v[102:103], v[66:67]
    v_exp_f32 v96, v96
    v_exp_f32 v97, v97
    v_exp_f32 v98, v98
    v_exp_f32 v99, v99
    v_exp_f32 v100, v100
    v_exp_f32 v101, v101
    v_exp_f32 v102, v102
    v_exp_f32 v103, v103
    v_pk_fma_f32 v[96:97], v[96:97], v[224:225], v[224:225] op_sel:[0,1,1] op_sel_hi:[1,1,1]
    v_pk_fma_f32 v[98:99], v[98:99], v[224:225], v[224:225] op_sel:[0,1,1] op_sel_hi:[1,1,1]
    v_pk_fma_f32 v[100:101], v[100:101], v[224:225], v[224:225] op_sel:[0,1,1] op_sel_hi:[1,1,1]
    v_pk_fma_f32 v[102:103], v[102:103], v[224:225], v[224:225] op_sel:[0,1,1] op_sel_hi:[1,1,1]
    v_rcp_f32 v96, v96
    v_rcp_f32 v97, v97
    v_rcp_f32 v98, v98
    v_rcp_f32 v99, v99
    v_rcp_f32 v100, v100
    v_rcp_f32 v101, v101
    v_rcp_f32 v102, v102
    v_rcp_f32 v103, v103
    v_pk_mul_f32 v[60:61], v[60:61], v[96:97]
    v_pk_mul_f32 v[62:63], v[62:63], v[98:99]
    v_pk_mul_f32 v[64:65], v[64:65], v[100:101]
    v_pk_mul_f32 v[66:67], v[66:67], v[102:103]
    v_cvt_pk_bf16_f32 v120, v60, v61
    v_cvt_pk_bf16_f32 v121, v62, v63
    v_cvt_pk_bf16_f32 v122, v64, v65
    v_cvt_pk_bf16_f32 v123, v66, v67
    buffer_store_dwordx4 v[120:123], v30, s[8:11], s53 offen sc1
    v_pk_mul_f32 v[40:41], v[40:41], v[202:203] op_sel_hi:[1,0]
    v_pk_mul_f32 v[42:43], v[42:43], v[202:203] op_sel_hi:[1,0]
    v_pk_mul_f32 v[44:45], v[44:45], v[202:203] op_sel_hi:[1,0]
    v_pk_mul_f32 v[46:47], v[46:47], v[202:203] op_sel_hi:[1,0]
    v_pk_fma_f32 v[88:89], v[40:41], v[40:41], v[224:225] op_sel_hi:[1,1,0] neg_lo:[1,0,0] neg_hi:[1,0,0]
    v_pk_fma_f32 v[90:91], v[42:43], v[42:43], v[224:225] op_sel_hi:[1,1,0] neg_lo:[1,0,0] neg_hi:[1,0,0]
    v_pk_fma_f32 v[92:93], v[44:45], v[44:45], v[224:225] op_sel_hi:[1,1,0] neg_lo:[1,0,0] neg_hi:[1,0,0]
    v_pk_fma_f32 v[94:95], v[46:47], v[46:47], v[224:225] op_sel_hi:[1,1,0] neg_lo:[1,0,0] neg_hi:[1,0,0]
    v_pk_mul_f32 v[88:89], v[88:89], v[40:41]
    v_pk_mul_f32 v[90:91], v[90:91], v[42:43]
    v_pk_mul_f32 v[92:93], v[92:93], v[44:45]
    v_pk_mul_f32 v[94:95], v[94:95], v[46:47]
    v_exp_f32 v88, v88
    v_exp_f32 v89, v89
    v_exp_f32 v90, v90
    v_exp_f32 v91, v91
    v_exp_f32 v92, v92
    v_exp_f32 v93, v93
    v_exp_f32 v94, v94
    v_exp_f32 v95, v95
    v_pk_fma_f32 v[88:89], v[88:89], v[224:225], v[224:225] op_sel:[0,1,1] op_sel_hi:[1,1,1]
    v_pk_fma_f32 v[90:91], v[90:91], v[224:225], v[224:225] op_sel:[0,1,1] op_sel_hi:[1,1,1]
    v_pk_fma_f32 v[92:93], v[92:93], v[224:225], v[224:225] op_sel:[0,1,1] op_sel_hi:[1,1,1]
    v_pk_fma_f32 v[94:95], v[94:95], v[224:225], v[224:225] op_sel:[0,1,1] op_sel_hi:[1,1,1]
    v_rcp_f32 v88, v88
    v_rcp_f32 v89, v89
    v_rcp_f32 v90, v90
    v_rcp_f32 v91, v91
    v_rcp_f32 v92, v92
    v_rcp_f32 v93, v93
    v_rcp_f32 v94, v94
    v_rcp_f32 v95, v95
    v_pk_mul_f32 v[40:41], v[40:41], v[88:89]
    v_pk_mul_f32 v[42:43], v[42:43], v[90:91]
    v_pk_mul_f32 v[44:45], v[44:45], v[92:93]
    v_pk_mul_f32 v[46:47], v[46:47], v[94:95]
    v_cvt_pk_bf16_f32 v124, v40, v41
    v_cvt_pk_bf16_f32 v125, v42, v43
    v_cvt_pk_bf16_f32 v126, v44, v45
    v_cvt_pk_bf16_f32 v127, v46, v47
    buffer_store_dwordx4 v[124:127], v5, s[8:11], s54 offen sc1
    v_pk_mul_f32 v[68:69], v[68:69], v[206:207] op_sel_hi:[1,0]
    v_pk_mul_f32 v[70:71], v[70:71], v[206:207] op_sel_hi:[1,0]
    v_pk_mul_f32 v[72:73], v[72:73], v[206:207] op_sel_hi:[1,0]
    v_pk_mul_f32 v[74:75], v[74:75], v[206:207] op_sel_hi:[1,0]
    v_pk_fma_f32 v[96:97], v[68:69], v[68:69], v[224:225] op_sel_hi:[1,1,0] neg_lo:[1,0,0] neg_hi:[1,0,0]
    v_pk_fma_f32 v[98:99], v[70:71], v[70:71], v[224:225] op_sel_hi:[1,1,0] neg_lo:[1,0,0] neg_hi:[1,0,0]
    v_pk_fma_f32 v[100:101], v[72:73], v[72:73], v[224:225] op_sel_hi:[1,1,0] neg_lo:[1,0,0] neg_hi:[1,0,0]
    v_pk_fma_f32 v[102:103], v[74:75], v[74:75], v[224:225] op_sel_hi:[1,1,0] neg_lo:[1,0,0] neg_hi:[1,0,0]
    v_pk_mul_f32 v[96:97], v[96:97], v[68:69]
    v_pk_mul_f32 v[98:99], v[98:99], v[70:71]
    v_pk_mul_f32 v[100:101], v[100:101], v[72:73]
    v_pk_mul_f32 v[102:103], v[102:103], v[74:75]
    v_exp_f32 v96, v96
    v_exp_f32 v97, v97
    v_exp_f32 v98, v98
    v_exp_f32 v99, v99
    v_exp_f32 v100, v100
    v_exp_f32 v101, v101
    v_exp_f32 v102, v102
    v_exp_f32 v103, v103
    v_pk_fma_f32 v[96:97], v[96:97], v[224:225], v[224:225] op_sel:[0,1,1] op_sel_hi:[1,1,1]
    v_pk_fma_f32 v[98:99], v[98:99], v[224:225], v[224:225] op_sel:[0,1,1] op_sel_hi:[1,1,1]
    v_pk_fma_f32 v[100:101], v[100:101], v[224:225], v[224:225] op_sel:[0,1,1] op_sel_hi:[1,1,1]
    v_pk_fma_f32 v[102:103], v[102:103], v[224:225], v[224:225] op_sel:[0,1,1] op_sel_hi:[1,1,1]
    v_rcp_f32 v96, v96
    v_rcp_f32 v97, v97
    v_rcp_f32 v98, v98
    v_rcp_f32 v99, v99
    v_rcp_f32 v100, v100
    v_rcp_f32 v101, v101
    v_rcp_f32 v102, v102
    v_rcp_f32 v103, v103
    v_pk_mul_f32 v[68:69], v[68:69], v[96:97]
    v_pk_mul_f32 v[70:71], v[70:71], v[98:99]
    v_pk_mul_f32 v[72:73], v[72:73], v[100:101]
    v_pk_mul_f32 v[74:75], v[74:75], v[102:103]
    v_cvt_pk_bf16_f32 v128, v68, v69
    v_cvt_pk_bf16_f32 v129, v70, v71
    v_cvt_pk_bf16_f32 v130, v72, v73
    v_cvt_pk_bf16_f32 v131, v74, v75
    buffer_store_dwordx4 v[128:131], v30, s[8:11], s54 offen sc1
    v_pk_mul_f32 v[48:49], v[48:49], v[202:203] op_sel_hi:[1,0]
    v_pk_mul_f32 v[50:51], v[50:51], v[202:203] op_sel_hi:[1,0]
    v_pk_mul_f32 v[52:53], v[52:53], v[202:203] op_sel_hi:[1,0]
    v_pk_mul_f32 v[54:55], v[54:55], v[202:203] op_sel_hi:[1,0]
    v_pk_fma_f32 v[88:89], v[48:49], v[48:49], v[224:225] op_sel_hi:[1,1,0] neg_lo:[1,0,0] neg_hi:[1,0,0]
    v_pk_fma_f32 v[90:91], v[50:51], v[50:51], v[224:225] op_sel_hi:[1,1,0] neg_lo:[1,0,0] neg_hi:[1,0,0]
    v_pk_fma_f32 v[92:93], v[52:53], v[52:53], v[224:225] op_sel_hi:[1,1,0] neg_lo:[1,0,0] neg_hi:[1,0,0]
    v_pk_fma_f32 v[94:95], v[54:55], v[54:55], v[224:225] op_sel_hi:[1,1,0] neg_lo:[1,0,0] neg_hi:[1,0,0]
    v_pk_mul_f32 v[88:89], v[88:89], v[48:49]
    v_pk_mul_f32 v[90:91], v[90:91], v[50:51]
    v_pk_mul_f32 v[92:93], v[92:93], v[52:53]
    v_pk_mul_f32 v[94:95], v[94:95], v[54:55]
    v_exp_f32 v88, v88
    v_exp_f32 v89, v89
    v_exp_f32 v90, v90
    v_exp_f32 v91, v91
    v_exp_f32 v92, v92
    v_exp_f32 v93, v93
    v_exp_f32 v94, v94
    v_exp_f32 v95, v95
    v_pk_fma_f32 v[88:89], v[88:89], v[224:225], v[224:225] op_sel:[0,1,1] op_sel_hi:[1,1,1]
    v_pk_fma_f32 v[90:91], v[90:91], v[224:225], v[224:225] op_sel:[0,1,1] op_sel_hi:[1,1,1]
    v_pk_fma_f32 v[92:93], v[92:93], v[224:225], v[224:225] op_sel:[0,1,1] op_sel_hi:[1,1,1]
    v_pk_fma_f32 v[94:95], v[94:95], v[224:225], v[224:225] op_sel:[0,1,1] op_sel_hi:[1,1,1]
    v_rcp_f32 v88, v88
    v_rcp_f32 v89, v89
    v_rcp_f32 v90, v90
    v_rcp_f32 v91, v91
    v_rcp_f32 v92, v92
    v_rcp_f32 v93, v93
    v_rcp_f32 v94, v94
    v_rcp_f32 v95, v95
    v_pk_mul_f32 v[48:49], v[48:49], v[88:89]
    v_pk_mul_f32 v[50:51], v[50:51], v[90:91]
    v_pk_mul_f32 v[52:53], v[52:53], v[92:93]
    v_pk_mul_f32 v[54:55], v[54:55], v[94:95]
    v_cvt_pk_bf16_f32 v132, v48, v49
    v_cvt_pk_bf16_f32 v133, v50, v51
    v_cvt_pk_bf16_f32 v134, v52, v53
    v_cvt_pk_bf16_f32 v135, v54, v55
    buffer_store_dwordx4 v[132:135], v5, s[8:11], s62 offen sc1
    v_pk_mul_f32 v[76:77], v[76:77], v[206:207] op_sel_hi:[1,0]
    v_pk_mul_f32 v[78:79], v[78:79], v[206:207] op_sel_hi:[1,0]
    v_pk_mul_f32 v[80:81], v[80:81], v[206:207] op_sel_hi:[1,0]
    v_pk_mul_f32 v[82:83], v[82:83], v[206:207] op_sel_hi:[1,0]
    v_pk_fma_f32 v[96:97], v[76:77], v[76:77], v[224:225] op_sel_hi:[1,1,0] neg_lo:[1,0,0] neg_hi:[1,0,0]
    v_pk_fma_f32 v[98:99], v[78:79], v[78:79], v[224:225] op_sel_hi:[1,1,0] neg_lo:[1,0,0] neg_hi:[1,0,0]
    v_pk_fma_f32 v[100:101], v[80:81], v[80:81], v[224:225] op_sel_hi:[1,1,0] neg_lo:[1,0,0] neg_hi:[1,0,0]
    v_pk_fma_f32 v[102:103], v[82:83], v[82:83], v[224:225] op_sel_hi:[1,1,0] neg_lo:[1,0,0] neg_hi:[1,0,0]
    v_pk_mul_f32 v[96:97], v[96:97], v[76:77]
    v_pk_mul_f32 v[98:99], v[98:99], v[78:79]
    v_pk_mul_f32 v[100:101], v[100:101], v[80:81]
    v_pk_mul_f32 v[102:103], v[102:103], v[82:83]
    v_exp_f32 v96, v96
    v_exp_f32 v97, v97
    v_exp_f32 v98, v98
    v_exp_f32 v99, v99
    v_exp_f32 v100, v100
    v_exp_f32 v101, v101
    v_exp_f32 v102, v102
    v_exp_f32 v103, v103
    v_pk_fma_f32 v[96:97], v[96:97], v[224:225], v[224:225] op_sel:[0,1,1] op_sel_hi:[1,1,1]
    v_pk_fma_f32 v[98:99], v[98:99], v[224:225], v[224:225] op_sel:[0,1,1] op_sel_hi:[1,1,1]
    v_pk_fma_f32 v[100:101], v[100:101], v[224:225], v[224:225] op_sel:[0,1,1] op_sel_hi:[1,1,1]
    v_pk_fma_f32 v[102:103], v[102:103], v[224:225], v[224:225] op_sel:[0,1,1] op_sel_hi:[1,1,1]
    v_rcp_f32 v96, v96
    v_rcp_f32 v97, v97
    v_rcp_f32 v98, v98
    v_rcp_f32 v99, v99
    v_rcp_f32 v100, v100
    v_rcp_f32 v101, v101
    v_rcp_f32 v102, v102
    v_rcp_f32 v103, v103
    v_pk_mul_f32 v[76:77], v[76:77], v[96:97]
    v_pk_mul_f32 v[78:79], v[78:79], v[98:99]
    v_pk_mul_f32 v[80:81], v[80:81], v[100:101]
    v_pk_mul_f32 v[82:83], v[82:83], v[102:103]
    v_cvt_pk_bf16_f32 v136, v76, v77
    v_cvt_pk_bf16_f32 v137, v78, v79
    v_cvt_pk_bf16_f32 v138, v80, v81
    v_cvt_pk_bf16_f32 v139, v82, v83
    buffer_store_dwordx4 v[136:139], v30, s[8:11], s62 offen sc1
    s_waitcnt vmcnt(2)
    s_mov_b64 exec, 1
    buffer_store_dword v7, v6, s[8:11], s37 offen offset:384
    buffer_store_dword v7, v6, s[8:11], s37 offen sc1
    s_mov_b64 exec, -1
    v_pk_mul_f32 v[56:57], v[56:57], v[202:203] op_sel_hi:[1,0]
    v_pk_mul_f32 v[58:59], v[58:59], v[202:203] op_sel_hi:[1,0]
    v_pk_fma_f32 v[88:89], v[56:57], v[56:57], v[224:225] op_sel_hi:[1,1,0] neg_lo:[1,0,0] neg_hi:[1,0,0]
    v_pk_fma_f32 v[90:91], v[58:59], v[58:59], v[224:225] op_sel_hi:[1,1,0] neg_lo:[1,0,0] neg_hi:[1,0,0]
    v_pk_mul_f32 v[88:89], v[88:89], v[56:57]
    v_pk_mul_f32 v[90:91], v[90:91], v[58:59]
    v_exp_f32 v88, v88
    v_exp_f32 v89, v89
    v_exp_f32 v90, v90
    v_exp_f32 v91, v91
    v_pk_fma_f32 v[88:89], v[88:89], v[224:225], v[224:225] op_sel:[0,1,1] op_sel_hi:[1,1,1]
    v_pk_fma_f32 v[90:91], v[90:91], v[224:225], v[224:225] op_sel:[0,1,1] op_sel_hi:[1,1,1]
    v_rcp_f32 v88, v88
    v_rcp_f32 v89, v89
    v_rcp_f32 v90, v90
    v_rcp_f32 v91, v91
    v_pk_mul_f32 v[56:57], v[56:57], v[88:89]
    v_pk_mul_f32 v[58:59], v[58:59], v[90:91]
    v_cvt_pk_bf16_f32 v140, v56, v57
    v_cvt_pk_bf16_f32 v141, v58, v59
    buffer_store_dwordx2 v[140:141], v10, s[8:11], s63 offen sc1
    v_pk_mul_f32 v[84:85], v[84:85], v[206:207] op_sel_hi:[1,0]
    v_pk_mul_f32 v[86:87], v[86:87], v[206:207] op_sel_hi:[1,0]
    v_pk_fma_f32 v[96:97], v[84:85], v[84:85], v[224:225] op_sel_hi:[1,1,0] neg_lo:[1,0,0] neg_hi:[1,0,0]
    v_pk_fma_f32 v[98:99], v[86:87], v[86:87], v[224:225] op_sel_hi:[1,1,0] neg_lo:[1,0,0] neg_hi:[1,0,0]
    v_pk_mul_f32 v[96:97], v[96:97], v[84:85]
    v_pk_mul_f32 v[98:99], v[98:99], v[86:87]
    v_exp_f32 v96, v96
    v_exp_f32 v97, v97
    v_exp_f32 v98, v98
    v_exp_f32 v99, v99
    v_pk_fma_f32 v[96:97], v[96:97], v[224:225], v[224:225] op_sel:[0,1,1] op_sel_hi:[1,1,1]
    v_pk_fma_f32 v[98:99], v[98:99], v[224:225], v[224:225] op_sel:[0,1,1] op_sel_hi:[1,1,1]
    v_rcp_f32 v96, v96
    v_rcp_f32 v97, v97
    v_rcp_f32 v98, v98
    v_rcp_f32 v99, v99
    v_pk_mul_f32 v[84:85], v[84:85], v[96:97]
    v_pk_mul_f32 v[86:87], v[86:87], v[98:99]
    v_cvt_pk_bf16_f32 v142, v84, v85
    v_cvt_pk_bf16_f32 v143, v86, v87
    buffer_store_dwordx2 v[142:143], v31, s[8:11], s63 offen sc1
    s_and_b32 s35, s32, 1
    s_mul_i32 s39, s35, 5120
    v_add_u32 v32, s39, v24
    v_add_u32 v33, s39, v25
    v_add_u32 v34, s39, v26
    s_lshl_b32 s35, s35, 10
    s_add_u32 s35, s35, 16777216
    s_mul_i32 s26, s61, 55296
    s_add_u32 s26, s26, s35
    s_xor_b32 s52, s61, 1
    s_mul_i32 s52, s52, 55296
    s_add_u32 s52, s52, s35
    s_cmp_lg_u32 s32, 0
    s_cbranch_scc1 L_f_o9
    buffer_load_dword v2, v23, s[8:11], s64 offen offset:384 sc1
L_f_o9:
    s_waitcnt vmcnt(0)
    s_mov_b64 exec, 1
    buffer_store_dword v7, v6, s[8:11], s42 offen offset:384
    buffer_store_dword v7, v6, s[8:11], s42 offen sc1
    s_mov_b64 exec, -1
    s_cmp_lg_u32 s32, 0
    s_cbranch_scc1 L_f_o10
    v_cmp_ne_u32 vcc, 1, v2
    s_nop 4
    s_cbranch_vccz L_f_aok
    s_mov_b32 s38, 0
    s_branch L_f_q11
L_f_p11:
    s_sleep 1
L_f_q11:
    buffer_load_dword v2, v23, s[8:11], s64 offen offset:384 sc1
    s_add_u32 s38, s38, 1
    s_waitcnt vmcnt(0)
    v_cmp_ne_u32 vcc, 1, v2
    s_nop 4
    s_cbranch_vccz L_f_x11
    s_cmp_lt_u32 s38, 12
    s_cbranch_scc1 L_f_p11
    s_mov_b32 s38, 0
    s_branch L_f_q12
L_f_p12:
    s_sleep 4
L_f_q12:
    buffer_load_dword v2, v23, s[8:11], s64 offen sc1
    s_add_u32 s38, s38, 1
    s_cmp_gt_u32 s38, 100000
    s_waitcnt vmcnt(0)
    s_cbranch_scc1 L_f_x12
    v_cmp_ne_u32 vcc, 1, v2
    s_nop 4
    s_cbranch_vccnz L_f_p12
L_f_x12:
L_f_x11:
L_f_aok:
L_f_o10:
    s_barrier
    buffer_load_dwordx4 v[144:147], v5, s[8:11], s26 offen offset:0 sc1
    buffer_load_dwordx4 v[148:151], v5, s[8:11], s52 offen offset:0 sc1
    buffer_load_dwordx4 v[152:155], v5, s[8:11], s26 offen offset:2048 sc1
    buffer_load_dwordx4 v[156:159], v5, s[8:11], s52 offen offset:2048 sc1
    s_add_u32 s26, s26, 4096
    buffer_load_dwordx4 v[160:163], v5, s[8:11], s26 offen offset:0 sc1
    s_add_u32 s52, s52, 4096
    buffer_load_dwordx4 v[164:167], v5, s[8:11], s52 offen offset:0 sc1
    buffer_load_dwordx4 v[168:171], v5, s[8:11], s26 offen offset:2048 sc1
    buffer_load_dwordx4 v[172:175], v5, s[8:11], s52 offen offset:2048 sc1
    s_add_u32 s26, s26, 4096
    buffer_load_dwordx4 v[176:179], v5, s[8:11], s26 offen offset:0 sc1
    s_add_u32 s52, s52, 4096
    buffer_load_dwordx4 v[180:183], v5, s[8:11], s52 offen offset:0 sc1
    ds_read_b128 v[192:195], v32 offset:0
    ds_read_b128 v[196:199], v32 offset:1024
    ds_read_b128 v[200:203], v32 offset:2048
    ds_read_b128 v[204:207], v32 offset:3072
    ds_read_b128 v[208:211], v32 offset:4096
    s_mul_i32 s35, s32, 5120
    s_add_u32 s35, s35, 112640
    v_add_u32 v232, s35, v5
    s_xor_b32 s35, s32, 1
    s_mul_i32 s35, s35, 5120
    s_add_u32 s35, s35, 112640
    v_add_u32 v233, s35, v5
    v_lshlrev_b32 v36, 16, v12
    v_and_b32 v37, 0xffff0000, v12
    v_lshlrev_b32 v38, 16, v13
    v_and_b32 v39, 0xffff0000, v13
    v_lshlrev_b32 v56, 16, v246
    v_and_b32 v57, 0xffff0000, v246
    v_lshlrev_b32 v58, 16, v247
    v_and_b32 v59, 0xffff0000, v247
    v_lshlrev_b32 v40, 16, v14
    v_and_b32 v41, 0xffff0000, v14
    v_lshlrev_b32 v42, 16, v15
    v_and_b32 v43, 0xffff0000, v15
    v_lshlrev_b32 v60, 16, v248
    v_and_b32 v61, 0xffff0000, v248
    v_lshlrev_b32 v62, 16, v249
    v_and_b32 v63, 0xffff0000, v249
    v_lshlrev_b32 v44, 16, v16
    v_and_b32 v45, 0xffff0000, v16
    v_lshlrev_b32 v46, 16, v17
    v_and_b32 v47, 0xffff0000, v17
    v_lshlrev_b32 v64, 16, v250
    v_and_b32 v65, 0xffff0000, v250
    v_lshlrev_b32 v66, 16, v251
    v_and_b32 v67, 0xffff0000, v251
    v_lshlrev_b32 v48, 16, v18
    v_and_b32 v49, 0xffff0000, v18
    v_lshlrev_b32 v50, 16, v19
    v_and_b32 v51, 0xffff0000, v19
    v_lshlrev_b32 v68, 16, v252
    v_and_b32 v69, 0xffff0000, v252
    v_lshlrev_b32 v70, 16, v253
    v_and_b32 v71, 0xffff0000, v253
    v_lshlrev_b32 v52, 16, v20
    v_and_b32 v53, 0xffff0000, v20
    v_lshlrev_b32 v54, 16, v21
    v_and_b32 v55, 0xffff0000, v21
    v_lshlrev_b32 v72, 16, v254
    v_and_b32 v73, 0xffff0000, v254
    v_lshlrev_b32 v74, 16, v255
    v_and_b32 v75, 0xffff0000, v255
    v_mul_u32_u24 v2, 160, v9
    v_lshl_add_u32 v2, v8, 3, v2
    s_mul_i32 s35, s32, 3072
    s_add_u32 s35, s35, 133120
    v_add_u32 v236, s35, v5
    s_sub_u32 s35, s35, s55
    s_add_u32 s39, s35, s66
    v_add_u32 v234, s39, v2
    s_add_u32 s39, s35, s67
    v_add_u32 v235, s39, v2
    v_add_u32 v2, 0, v1
    v_mul_u32_u24 v4, 6554, v2
    v_lshrrev_b32 v4, 16, v4
    v_mul_u32_u24 v237, 10, v4
    v_sub_u32 v2, v2, v237
    v_mul_u32_u24 v4, 1280, v4
    v_lshl_add_u32 v237, v2, 4, v4
    v_add_u32 v2, 64, v1
    v_mul_u32_u24 v4, 6554, v2
    v_lshrrev_b32 v4, 16, v4
    v_mul_u32_u24 v238, 10, v4
    v_sub_u32 v2, v2, v238
    v_mul_u32_u24 v4, 1280, v4
    v_lshl_add_u32 v238, v2, 4, v4
    v_add_u32 v2, 128, v1
    v_mul_u32_u24 v4, 6554, v2
    v_lshrrev_b32 v4, 16, v4
    v_mul_u32_u24 v239, 10, v4
    v_sub_u32 v2, v2, v239
    v_mul_u32_u24 v4, 1280, v4
    v_lshl_add_u32 v239, v2, 4, v4
    s_waitcnt vmcnt(8)
    s_waitcnt lgkmcnt(4)
    v_mfma_f32_16x16x32_bf16 v[36:39], v[192:195], v[144:147], v[36:39]
    ds_read_b128 v[212:215], v32 offset:10240
    v_mfma_f32_16x16x32_bf16 v[56:59], v[192:195], v[148:151], v[56:59]
    buffer_load_dwordx4 v[184:187], v5, s[8:11], s26 offen offset:2048 sc1
    s_waitcnt lgkmcnt(4)
    v_mfma_f32_16x16x32_bf16 v[40:43], v[196:199], v[144:147], v[40:43]
    ds_read_b128 v[216:219], v32 offset:11264
    v_mfma_f32_16x16x32_bf16 v[60:63], v[196:199], v[148:151], v[60:63]
    s_waitcnt lgkmcnt(4)
    v_mfma_f32_16x16x32_bf16 v[44:47], v[200:203], v[144:147], v[44:47]
    ds_read_b128 v[220:223], v32 offset:12288
    v_mfma_f32_16x16x32_bf16 v[64:67], v[200:203], v[148:151], v[64:67]
    buffer_load_dwordx4 v[188:191], v5, s[8:11], s52 offen offset:2048 sc1
    s_waitcnt lgkmcnt(4)
    v_mfma_f32_16x16x32_bf16 v[48:51], v[204:207], v[144:147], v[48:51]
    ds_read_b128 v[224:227], v32 offset:13312
    v_mfma_f32_16x16x32_bf16 v[68:71], v[204:207], v[148:151], v[68:71]
    s_waitcnt lgkmcnt(4)
    v_mfma_f32_16x16x32_bf16 v[52:55], v[208:211], v[144:147], v[52:55]
    ds_read_b128 v[228:231], v32 offset:14336
    v_mfma_f32_16x16x32_bf16 v[72:75], v[208:211], v[148:151], v[72:75]
    s_waitcnt vmcnt(8)
    s_waitcnt lgkmcnt(4)
    v_mfma_f32_16x16x32_bf16 v[36:39], v[212:215], v[152:155], v[36:39]
    ds_read_b128 v[192:195], v32 offset:20480
    v_mfma_f32_16x16x32_bf16 v[56:59], v[212:215], v[156:159], v[56:59]
    s_add_u32 s26, s26, 4096
    buffer_load_dwordx4 v[144:147], v5, s[8:11], s26 offen offset:0 sc1
    s_waitcnt lgkmcnt(4)
    v_mfma_f32_16x16x32_bf16 v[40:43], v[216:219], v[152:155], v[40:43]
    ds_read_b128 v[196:199], v32 offset:21504
    v_mfma_f32_16x16x32_bf16 v[60:63], v[216:219], v[156:159], v[60:63]
    s_waitcnt lgkmcnt(4)
    v_mfma_f32_16x16x32_bf16 v[44:47], v[220:223], v[152:155], v[44:47]
    ds_read_b128 v[200:203], v32 offset:22528
    v_mfma_f32_16x16x32_bf16 v[64:67], v[220:223], v[156:159], v[64:67]
    s_add_u32 s52, s52, 4096
    buffer_load_dwordx4 v[148:151], v5, s[8:11], s52 offen offset:0 sc1
    s_waitcnt lgkmcnt(4)
    v_mfma_f32_16x16x32_bf16 v[48:51], v[224:227], v[152:155], v[48:51]
    ds_read_b128 v[204:207], v32 offset:23552
    v_mfma_f32_16x16x32_bf16 v[68:71], v[224:227], v[156:159], v[68:71]
    s_waitcnt lgkmcnt(4)
    v_mfma_f32_16x16x32_bf16 v[52:55], v[228:231], v[152:155], v[52:55]
    ds_read_b128 v[208:211], v32 offset:24576
    v_mfma_f32_16x16x32_bf16 v[72:75], v[228:231], v[156:159], v[72:75]
    s_waitcnt vmcnt(8)
    s_waitcnt lgkmcnt(4)
    v_mfma_f32_16x16x32_bf16 v[36:39], v[192:195], v[160:163], v[36:39]
    ds_read_b128 v[212:215], v32 offset:30720
    v_mfma_f32_16x16x32_bf16 v[56:59], v[192:195], v[164:167], v[56:59]
    buffer_load_dwordx4 v[152:155], v5, s[8:11], s26 offen offset:2048 sc1
    s_waitcnt lgkmcnt(4)
    v_mfma_f32_16x16x32_bf16 v[40:43], v[196:199], v[160:163], v[40:43]
    ds_read_b128 v[216:219], v32 offset:31744
    v_mfma_f32_16x16x32_bf16 v[60:63], v[196:199], v[164:167], v[60:63]
    s_waitcnt lgkmcnt(4)
    v_mfma_f32_16x16x32_bf16 v[44:47], v[200:203], v[160:163], v[44:47]
    ds_read_b128 v[220:223], v32 offset:32768
    v_mfma_f32_16x16x32_bf16 v[64:67], v[200:203], v[164:167], v[64:67]
    buffer_load_dwordx4 v[156:159], v5, s[8:11], s52 offen offset:2048 sc1
    s_waitcnt lgkmcnt(4)
    v_mfma_f32_16x16x32_bf16 v[48:51], v[204:207], v[160:163], v[48:51]
    ds_read_b128 v[224:227], v32 offset:33792
    v_mfma_f32_16x16x32_bf16 v[68:71], v[204:207], v[164:167], v[68:71]
    s_waitcnt lgkmcnt(4)
    v_mfma_f32_16x16x32_bf16 v[52:55], v[208:211], v[160:163], v[52:55]
    ds_read_b128 v[228:231], v32 offset:34816
    v_mfma_f32_16x16x32_bf16 v[72:75], v[208:211], v[164:167], v[72:75]
    s_waitcnt vmcnt(8)
    s_waitcnt lgkmcnt(4)
    v_mfma_f32_16x16x32_bf16 v[36:39], v[212:215], v[168:171], v[36:39]
    ds_read_b128 v[192:195], v32 offset:40960
    v_mfma_f32_16x16x32_bf16 v[56:59], v[212:215], v[172:175], v[56:59]
    s_add_u32 s26, s26, 4096
    buffer_load_dwordx4 v[160:163], v5, s[8:11], s26 offen offset:0 sc1
    s_waitcnt lgkmcnt(4)
    v_mfma_f32_16x16x32_bf16 v[40:43], v[216:219], v[168:171], v[40:43]
    ds_read_b128 v[196:199], v32 offset:41984
    v_mfma_f32_16x16x32_bf16 v[60:63], v[216:219], v[172:175], v[60:63]
    s_waitcnt lgkmcnt(4)
    v_mfma_f32_16x16x32_bf16 v[44:47], v[220:223], v[168:171], v[44:47]
    ds_read_b128 v[200:203], v32 offset:43008
    v_mfma_f32_16x16x32_bf16 v[64:67], v[220:223], v[172:175], v[64:67]
    s_add_u32 s52, s52, 4096
    buffer_load_dwordx4 v[164:167], v5, s[8:11], s52 offen offset:0 sc1
    s_waitcnt lgkmcnt(4)
    v_mfma_f32_16x16x32_bf16 v[48:51], v[224:227], v[168:171], v[48:51]
    ds_read_b128 v[204:207], v32 offset:44032
    v_mfma_f32_16x16x32_bf16 v[68:71], v[224:227], v[172:175], v[68:71]
    s_waitcnt lgkmcnt(4)
    v_mfma_f32_16x16x32_bf16 v[52:55], v[228:231], v[168:171], v[52:55]
    ds_read_b128 v[208:211], v32 offset:45056
    v_mfma_f32_16x16x32_bf16 v[72:75], v[228:231], v[172:175], v[72:75]
    s_waitcnt vmcnt(8)
    s_waitcnt lgkmcnt(4)
    v_mfma_f32_16x16x32_bf16 v[36:39], v[192:195], v[176:179], v[36:39]
    ds_read_b128 v[212:215], v32 offset:51200
    v_mfma_f32_16x16x32_bf16 v[56:59], v[192:195], v[180:183], v[56:59]
    buffer_load_dwordx4 v[168:171], v5, s[8:11], s26 offen offset:2048 sc1
    s_waitcnt lgkmcnt(4)
    v_mfma_f32_16x16x32_bf16 v[40:43], v[196:199], v[176:179], v[40:43]
    ds_read_b128 v[216:219], v32 offset:52224
    v_mfma_f32_16x16x32_bf16 v[60:63], v[196:199], v[180:183], v[60:63]
    s_waitcnt lgkmcnt(4)
    v_mfma_f32_16x16x32_bf16 v[44:47], v[200:203], v[176:179], v[44:47]
    ds_read_b128 v[220:223], v32 offset:53248
    v_mfma_f32_16x16x32_bf16 v[64:67], v[200:203], v[180:183], v[64:67]
    buffer_load_dwordx4 v[172:175], v5, s[8:11], s52 offen offset:2048 sc1
    s_waitcnt lgkmcnt(4)
    v_mfma_f32_16x16x32_bf16 v[48:51], v[204:207], v[176:179], v[48:51]
    ds_read_b128 v[224:227], v32 offset:54272
    v_mfma_f32_16x16x32_bf16 v[68:71], v[204:207], v[180:183], v[68:71]
    s_waitcnt lgkmcnt(4)
    v_mfma_f32_16x16x32_bf16 v[52:55], v[208:211], v[176:179], v[52:55]
    ds_read_b128 v[228:231], v32 offset:55296
    v_mfma_f32_16x16x32_bf16 v[72:75], v[208:211], v[180:183], v[72:75]
    s_waitcnt lgkmcnt(0)
    s_barrier
    s_waitcnt vmcnt(8)
    v_mfma_f32_16x16x32_bf16 v[36:39], v[212:215], v[184:187], v[36:39]
    ds_read_b128 v[192:195], v32 offset:61440
    v_mfma_f32_16x16x32_bf16 v[56:59], v[212:215], v[188:191], v[56:59]
    s_add_u32 s26, s26, 4096
    buffer_load_dwordx4 v[176:179], v5, s[8:11], s26 offen offset:0 sc1
    v_mfma_f32_16x16x32_bf16 v[40:43], v[216:219], v[184:187], v[40:43]
    ds_read_b128 v[196:199], v32 offset:62464
    v_mfma_f32_16x16x32_bf16 v[60:63], v[216:219], v[188:191], v[60:63]
    v_mfma_f32_16x16x32_bf16 v[44:47], v[220:223], v[184:187], v[44:47]
    ds_read_b128 v[200:203], v32 offset:63488
    v_mfma_f32_16x16x32_bf16 v[64:67], v[220:223], v[188:191], v[64:67]
    s_add_u32 s52, s52, 4096
    buffer_load_dwordx4 v[180:183], v5, s[8:11], s52 offen offset:0 sc1
    v_mfma_f32_16x16x32_bf16 v[48:51], v[224:227], v[184:187], v[48:51]
    ds_read_b128 v[204:207], v32 offset:64512
    v_mfma_f32_16x16x32_bf16 v[68:71], v[224:227], v[188:191], v[68:71]
    v_mfma_f32_16x16x32_bf16 v[52:55], v[228:231], v[184:187], v[52:55]
    ds_read_b128 v[208:211], v33 offset:0
    v_mfma_f32_16x16x32_bf16 v[72:75], v[228:231], v[188:191], v[72:75]
    s_waitcnt vmcnt(8)
    s_waitcnt lgkmcnt(4)
    v_mfma_f32_16x16x32_bf16 v[36:39], v[192:195], v[144:147], v[36:39]
    ds_read_b128 v[212:215], v33 offset:6144
    v_mfma_f32_16x16x32_bf16 v[56:59], v[192:195], v[148:151], v[56:59]
    buffer_load_dwordx4 v[184:187], v5, s[8:11], s26 offen offset:2048 sc1
    s_waitcnt lgkmcnt(4)
    v_mfma_f32_16x16x32_bf16 v[40:43], v[196:199], v[144:147], v[40:43]
    ds_read_b128 v[216:219], v33 offset:7168
    v_mfma_f32_16x16x32_bf16 v[60:63], v[196:199], v[148:151], v[60:63]
    s_waitcnt lgkmcnt(4)
    v_mfma_f32_16x16x32_bf16 v[44:47], v[200:203], v[144:147], v[44:47]
    ds_read_b128 v[220:223], v33 offset:8192
    v_mfma_f32_16x16x32_bf16 v[64:67], v[200:203], v[148:151], v[64:67]
    buffer_load_dwordx4 v[188:191], v5, s[8:11], s52 offen offset:2048 sc1
    s_waitcnt lgkmcnt(4)
    v_mfma_f32_16x16x32_bf16 v[48:51], v[204:207], v[144:147], v[48:51]
    ds_read_b128 v[224:227], v33 offset:9216
    v_mfma_f32_16x16x32_bf16 v[68:71], v[204:207], v[148:151], v[68:71]
    s_waitcnt lgkmcnt(4)
    v_mfma_f32_16x16x32_bf16 v[52:55], v[208:211], v[144:147], v[52:55]
    ds_read_b128 v[228:231], v33 offset:10240
    v_mfma_f32_16x16x32_bf16 v[72:75], v[208:211], v[148:151], v[72:75]
    s_waitcnt vmcnt(8)
    s_waitcnt lgkmcnt(4)
    v_mfma_f32_16x16x32_bf16 v[36:39], v[212:215], v[152:155], v[36:39]
    ds_read_b128 v[192:195], v33 offset:16384
    v_mfma_f32_16x16x32_bf16 v[56:59], v[212:215], v[156:159], v[56:59]
    s_add_u32 s26, s26, 4096
    buffer_load_dwordx4 v[144:147], v5, s[8:11], s26 offen offset:0 sc1
    s_waitcnt lgkmcnt(4)
    v_mfma_f32_16x16x32_bf16 v[40:43], v[216:219], v[152:155], v[40:43]
    ds_read_b128 v[196:199], v33 offset:17408
    v_mfma_f32_16x16x32_bf16 v[60:63], v[216:219], v[156:159], v[60:63]
    s_waitcnt lgkmcnt(4)
    v_mfma_f32_16x16x32_bf16 v[44:47], v[220:223], v[152:155], v[44:47]
    ds_read_b128 v[200:203], v33 offset:18432
    v_mfma_f32_16x16x32_bf16 v[64:67], v[220:223], v[156:159], v[64:67]
    s_add_u32 s52, s52, 4096
    buffer_load_dwordx4 v[148:151], v5, s[8:11], s52 offen offset:0 sc1
    s_waitcnt lgkmcnt(4)
    v_mfma_f32_16x16x32_bf16 v[48:51], v[224:227], v[152:155], v[48:51]
    ds_read_b128 v[204:207], v33 offset:19456
    v_mfma_f32_16x16x32_bf16 v[68:71], v[224:227], v[156:159], v[68:71]
    s_waitcnt lgkmcnt(4)
    v_mfma_f32_16x16x32_bf16 v[52:55], v[228:231], v[152:155], v[52:55]
    ds_read_b128 v[208:211], v33 offset:20480
    v_mfma_f32_16x16x32_bf16 v[72:75], v[228:231], v[156:159], v[72:75]
    s_waitcnt vmcnt(8)
    s_waitcnt lgkmcnt(4)
    v_mfma_f32_16x16x32_bf16 v[36:39], v[192:195], v[160:163], v[36:39]
    ds_read_b128 v[212:215], v33 offset:26624
    v_mfma_f32_16x16x32_bf16 v[56:59], v[192:195], v[164:167], v[56:59]
    buffer_load_dwordx4 v[152:155], v5, s[8:11], s26 offen offset:2048 sc1
    s_waitcnt lgkmcnt(4)
    v_mfma_f32_16x16x32_bf16 v[40:43], v[196:199], v[160:163], v[40:43]
    ds_read_b128 v[216:219], v33 offset:27648
    v_mfma_f32_16x16x32_bf16 v[60:63], v[196:199], v[164:167], v[60:63]
    s_waitcnt lgkmcnt(4)
    v_mfma_f32_16x16x32_bf16 v[44:47], v[200:203], v[160:163], v[44:47]
    ds_read_b128 v[220:223], v33 offset:28672
    v_mfma_f32_16x16x32_bf16 v[64:67], v[200:203], v[164:167], v[64:67]
    buffer_load_dwordx4 v[156:159], v5, s[8:11], s52 offen offset:2048 sc1
    s_waitcnt lgkmcnt(4)
    v_mfma_f32_16x16x32_bf16 v[48:51], v[204:207], v[160:163], v[48:51]
    ds_read_b128 v[224:227], v33 offset:29696
    v_mfma_f32_16x16x32_bf16 v[68:71], v[204:207], v[164:167], v[68:71]
    s_waitcnt lgkmcnt(4)
    v_mfma_f32_16x16x32_bf16 v[52:55], v[208:211], v[160:163], v[52:55]
    ds_read_b128 v[228:231], v33 offset:30720
    v_mfma_f32_16x16x32_bf16 v[72:75], v[208:211], v[164:167], v[72:75]
    s_waitcnt vmcnt(8)
    s_waitcnt lgkmcnt(4)
    v_mfma_f32_16x16x32_bf16 v[36:39], v[212:215], v[168:171], v[36:39]
    ds_read_b128 v[192:195], v33 offset:36864
    v_mfma_f32_16x16x32_bf16 v[56:59], v[212:215], v[172:175], v[56:59]
    s_add_u32 s26, s26, 4096
    buffer_load_dwordx4 v[160:163], v5, s[8:11], s26 offen offset:0 sc1
    s_waitcnt lgkmcnt(4)
    v_mfma_f32_16x16x32_bf16 v[40:43], v[216:219], v[168:171], v[40:43]
    ds_read_b128 v[196:199], v33 offset:37888
    v_mfma_f32_16x16x32_bf16 v[60:63], v[216:219], v[172:175], v[60:63]
    s_waitcnt lgkmcnt(4)
    v_mfma_f32_16x16x32_bf16 v[44:47], v[220:223], v[168:171], v[44:47]
    ds_read_b128 v[200:203], v33 offset:38912
    v_mfma_f32_16x16x32_bf16 v[64:67], v[220:223], v[172:175], v[64:67]
    s_add_u32 s52, s52, 4096
    buffer_load_dwordx4 v[164:167], v5, s[8:11], s52 offen offset:0 sc1
    s_waitcnt lgkmcnt(4)
    v_mfma_f32_16x16x32_bf16 v[48:51], v[224:227], v[168:171], v[48:51]
    ds_read_b128 v[204:207], v33 offset:39936
    v_mfma_f32_16x16x32_bf16 v[68:71], v[224:227], v[172:175], v[68:71]
    s_waitcnt lgkmcnt(4)
    v_mfma_f32_16x16x32_bf16 v[52:55], v[228:231], v[168:171], v[52:55]
    ds_read_b128 v[208:211], v33 offset:40960
    v_mfma_f32_16x16x32_bf16 v[72:75], v[228:231], v[172:175], v[72:75]
    s_waitcnt lgkmcnt(0)
    s_barrier
    s_waitcnt vmcnt(8)
    v_mfma_f32_16x16x32_bf16 v[36:39], v[192:195], v[176:179], v[36:39]
    ds_read_b128 v[212:215], v33 offset:47104
    v_mfma_f32_16x16x32_bf16 v[56:59], v[192:195], v[180:183], v[56:59]
    buffer_load_dwordx4 v[168:171], v5, s[8:11], s26 offen offset:2048 sc1
    v_mfma_f32_16x16x32_bf16 v[40:43], v[196:199], v[176:179], v[40:43]
    ds_read_b128 v[216:219], v33 offset:48128
    v_mfma_f32_16x16x32_bf16 v[60:63], v[196:199], v[180:183], v[60:63]
    v_mfma_f32_16x16x32_bf16 v[44:47], v[200:203], v[176:179], v[44:47]
    ds_read_b128 v[220:223], v33 offset:49152
    v_mfma_f32_16x16x32_bf16 v[64:67], v[200:203], v[180:183], v[64:67]
    buffer_load_dwordx4 v[172:175], v5, s[8:11], s52 offen offset:2048 sc1
    v_mfma_f32_16x16x32_bf16 v[48:51], v[204:207], v[176:179], v[48:51]
    ds_read_b128 v[224:227], v33 offset:50176
    v_mfma_f32_16x16x32_bf16 v[68:71], v[204:207], v[180:183], v[68:71]
    v_mfma_f32_16x16x32_bf16 v[52:55], v[208:211], v[176:179], v[52:55]
    ds_read_b128 v[228:231], v33 offset:51200
    v_mfma_f32_16x16x32_bf16 v[72:75], v[208:211], v[180:183], v[72:75]
    s_waitcnt vmcnt(8)
    s_waitcnt lgkmcnt(4)
    v_mfma_f32_16x16x32_bf16 v[36:39], v[212:215], v[184:187], v[36:39]
    ds_read_b128 v[192:195], v33 offset:57344
    v_mfma_f32_16x16x32_bf16 v[56:59], v[212:215], v[188:191], v[56:59]
    s_add_u32 s26, s26, 4096
    buffer_load_dwordx4 v[176:179], v5, s[8:11], s26 offen offset:0 sc1
    s_waitcnt lgkmcnt(4)
    v_mfma_f32_16x16x32_bf16 v[40:43], v[216:219], v[184:187], v[40:43]
    ds_read_b128 v[196:199], v33 offset:58368
    v_mfma_f32_16x16x32_bf16 v[60:63], v[216:219], v[188:191], v[60:63]
    s_waitcnt lgkmcnt(4)
    v_mfma_f32_16x16x32_bf16 v[44:47], v[220:223], v[184:187], v[44:47]
    ds_read_b128 v[200:203], v33 offset:59392
    v_mfma_f32_16x16x32_bf16 v[64:67], v[220:223], v[188:191], v[64:67]
    s_add_u32 s52, s52, 4096
    buffer_load_dwordx4 v[180:183], v5, s[8:11], s52 offen offset:0 sc1
    s_waitcnt lgkmcnt(4)
    v_mfma_f32_16x16x32_bf16 v[48:51], v[224:227], v[184:187], v[48:51]
    ds_read_b128 v[204:207], v33 offset:60416
    v_mfma_f32_16x16x32_bf16 v[68:71], v[224:227], v[188:191], v[68:71]
    s_waitcnt lgkmcnt(4)
    v_mfma_f32_16x16x32_bf16 v[52:55], v[228:231], v[184:187], v[52:55]
    ds_read_b128 v[208:211], v33 offset:61440
    v_mfma_f32_16x16x32_bf16 v[72:75], v[228:231], v[188:191], v[72:75]
    s_waitcnt vmcnt(8)
    s_waitcnt lgkmcnt(4)
    v_mfma_f32_16x16x32_bf16 v[36:39], v[192:195], v[144:147], v[36:39]
    ds_read_b128 v[212:215], v34 offset:2048
    v_mfma_f32_16x16x32_bf16 v[56:59], v[192:195], v[148:151], v[56:59]
    buffer_load_dwordx4 v[184:187], v5, s[8:11], s26 offen offset:2048 sc1
    s_waitcnt lgkmcnt(4)
    v_mfma_f32_16x16x32_bf16 v[40:43], v[196:199], v[144:147], v[40:43]
    ds_read_b128 v[216:219], v34 offset:3072
    v_mfma_f32_16x16x32_bf16 v[60:63], v[196:199], v[148:151], v[60:63]
    s_waitcnt lgkmcnt(4)
    v_mfma_f32_16x16x32_bf16 v[44:47], v[200:203], v[144:147], v[44:47]
    ds_read_b128 v[220:223], v34 offset:4096
    v_mfma_f32_16x16x32_bf16 v[64:67], v[200:203], v[148:151], v[64:67]
    buffer_load_dwordx4 v[188:191], v5, s[8:11], s52 offen offset:2048 sc1
    s_waitcnt lgkmcnt(4)
    v_mfma_f32_16x16x32_bf16 v[48:51], v[204:207], v[144:147], v[48:51]
    ds_read_b128 v[224:227], v34 offset:5120
    v_mfma_f32_16x16x32_bf16 v[68:71], v[204:207], v[148:151], v[68:71]
    s_waitcnt lgkmcnt(4)
    v_mfma_f32_16x16x32_bf16 v[52:55], v[208:211], v[144:147], v[52:55]
    ds_read_b128 v[228:231], v34 offset:6144
    v_mfma_f32_16x16x32_bf16 v[72:75], v[208:211], v[148:151], v[72:75]
    s_waitcnt vmcnt(8)
    s_waitcnt lgkmcnt(4)
    v_mfma_f32_16x16x32_bf16 v[36:39], v[212:215], v[152:155], v[36:39]
    ds_read_b128 v[192:195], v34 offset:12288
    v_mfma_f32_16x16x32_bf16 v[56:59], v[212:215], v[156:159], v[56:59]
    s_add_u32 s26, s26, 4096
    buffer_load_dwordx4 v[144:147], v5, s[8:11], s26 offen offset:0 sc1
    s_waitcnt lgkmcnt(4)
    v_mfma_f32_16x16x32_bf16 v[40:43], v[216:219], v[152:155], v[40:43]
    ds_read_b128 v[196:199], v34 offset:13312
    v_mfma_f32_16x16x32_bf16 v[60:63], v[216:219], v[156:159], v[60:63]
    s_waitcnt lgkmcnt(4)
    v_mfma_f32_16x16x32_bf16 v[44:47], v[220:223], v[152:155], v[44:47]
    ds_read_b128 v[200:203], v34 offset:14336
    v_mfma_f32_16x16x32_bf16 v[64:67], v[220:223], v[156:159], v[64:67]
    s_add_u32 s52, s52, 4096
    buffer_load_dwordx4 v[148:151], v5, s[8:11], s52 offen offset:0 sc1
    s_waitcnt lgkmcnt(4)
    v_mfma_f32_16x16x32_bf16 v[48:51], v[224:227], v[152:155], v[48:51]
    ds_read_b128 v[204:207], v34 offset:15360
    v_mfma_f32_16x16x32_bf16 v[68:71], v[224:227], v[156:159], v[68:71]
    s_waitcnt lgkmcnt(4)
    v_mfma_f32_16x16x32_bf16 v[52:55], v[228:231], v[152:155], v[52:55]
    ds_read_b128 v[208:211], v34 offset:16384
    v_mfma_f32_16x16x32_bf16 v[72:75], v[228:231], v[156:159], v[72:75]
    s_waitcnt vmcnt(8)
    s_waitcnt lgkmcnt(4)
    v_mfma_f32_16x16x32_bf16 v[36:39], v[192:195], v[160:163], v[36:39]
    ds_read_b128 v[212:215], v34 offset:22528
    v_mfma_f32_16x16x32_bf16 v[56:59], v[192:195], v[164:167], v[56:59]
    buffer_load_dwordx4 v[152:155], v5, s[8:11], s26 offen offset:2048 sc1
    s_waitcnt lgkmcnt(4)
    v_mfma_f32_16x16x32_bf16 v[40:43], v[196:199], v[160:163], v[40:43]
    ds_read_b128 v[216:219], v34 offset:23552
    v_mfma_f32_16x16x32_bf16 v[60:63], v[196:199], v[164:167], v[60:63]
    s_waitcnt lgkmcnt(4)
    v_mfma_f32_16x16x32_bf16 v[44:47], v[200:203], v[160:163], v[44:47]
    ds_read_b128 v[220:223], v34 offset:24576
    v_mfma_f32_16x16x32_bf16 v[64:67], v[200:203], v[164:167], v[64:67]
    buffer_load_dwordx4 v[156:159], v5, s[8:11], s52 offen offset:2048 sc1
    s_waitcnt lgkmcnt(4)
    v_mfma_f32_16x16x32_bf16 v[48:51], v[204:207], v[160:163], v[48:51]
    ds_read_b128 v[224:227], v34 offset:25600
    v_mfma_f32_16x16x32_bf16 v[68:71], v[204:207], v[164:167], v[68:71]
    s_waitcnt lgkmcnt(4)
    v_mfma_f32_16x16x32_bf16 v[52:55], v[208:211], v[160:163], v[52:55]
    ds_read_b128 v[228:231], v34 offset:26624
    v_mfma_f32_16x16x32_bf16 v[72:75], v[208:211], v[164:167], v[72:75]
    s_waitcnt lgkmcnt(0)
    s_barrier
    s_waitcnt vmcnt(8)
    v_mfma_f32_16x16x32_bf16 v[36:39], v[212:215], v[168:171], v[36:39]
    ds_read_b128 v[192:195], v32 offset:0
    v_mfma_f32_16x16x32_bf16 v[56:59], v[212:215], v[172:175], v[56:59]
    s_add_u32 s26, s26, 4096
    buffer_load_dwordx4 v[160:163], v5, s[8:11], s26 offen offset:0 sc1
    v_mfma_f32_16x16x32_bf16 v[40:43], v[216:219], v[168:171], v[40:43]
    ds_read_b128 v[196:199], v32 offset:1024
    v_mfma_f32_16x16x32_bf16 v[60:63], v[216:219], v[172:175], v[60:63]
    v_mfma_f32_16x16x32_bf16 v[44:47], v[220:223], v[168:171], v[44:47]
    ds_read_b128 v[200:203], v32 offset:2048
    v_mfma_f32_16x16x32_bf16 v[64:67], v[220:223], v[172:175], v[64:67]
    s_add_u32 s52, s52, 4096
    buffer_load_dwordx4 v[164:167], v5, s[8:11], s52 offen offset:0 sc1
    v_mfma_f32_16x16x32_bf16 v[48:51], v[224:227], v[168:171], v[48:51]
    ds_read_b128 v[204:207], v32 offset:3072
    v_mfma_f32_16x16x32_bf16 v[68:71], v[224:227], v[172:175], v[68:71]
    v_mfma_f32_16x16x32_bf16 v[52:55], v[228:231], v[168:171], v[52:55]
    ds_read_b128 v[208:211], v32 offset:4096
    v_mfma_f32_16x16x32_bf16 v[72:75], v[228:231], v[172:175], v[72:75]
    s_waitcnt vmcnt(8)
    s_waitcnt lgkmcnt(4)
    v_mfma_f32_16x16x32_bf16 v[36:39], v[192:195], v[176:179], v[36:39]
    ds_read_b128 v[212:215], v32 offset:10240
    v_mfma_f32_16x16x32_bf16 v[56:59], v[192:195], v[180:183], v[56:59]
    buffer_load_dwordx4 v[168:171], v5, s[8:11], s26 offen offset:2048 sc1
    s_waitcnt lgkmcnt(4)
    v_mfma_f32_16x16x32_bf16 v[40:43], v[196:199], v[176:179], v[40:43]
    ds_read_b128 v[216:219], v32 offset:11264
    v_mfma_f32_16x16x32_bf16 v[60:63], v[196:199], v[180:183], v[60:63]
    s_waitcnt lgkmcnt(4)
    v_mfma_f32_16x16x32_bf16 v[44:47], v[200:203], v[176:179], v[44:47]
    ds_read_b128 v[220:223], v32 offset:12288
    v_mfma_f32_16x16x32_bf16 v[64:67], v[200:203], v[180:183], v[64:67]
    buffer_load_dwordx4 v[172:175], v5, s[8:11], s52 offen offset:2048 sc1
    s_waitcnt lgkmcnt(4)
    v_mfma_f32_16x16x32_bf16 v[48:51], v[204:207], v[176:179], v[48:51]
    ds_read_b128 v[224:227], v32 offset:13312
    v_mfma_f32_16x16x32_bf16 v[68:71], v[204:207], v[180:183], v[68:71]
    s_waitcnt lgkmcnt(4)
    v_mfma_f32_16x16x32_bf16 v[52:55], v[208:211], v[176:179], v[52:55]
    ds_read_b128 v[228:231], v32 offset:14336
    v_mfma_f32_16x16x32_bf16 v[72:75], v[208:211], v[180:183], v[72:75]
    s_waitcnt vmcnt(8)
    s_waitcnt lgkmcnt(4)
    v_mfma_f32_16x16x32_bf16 v[36:39], v[212:215], v[184:187], v[36:39]
    ds_read_b128 v[192:195], v32 offset:20480
    v_mfma_f32_16x16x32_bf16 v[56:59], v[212:215], v[188:191], v[56:59]
    s_add_u32 s26, s26, 4096
    buffer_load_dwordx4 v[176:179], v5, s[8:11], s26 offen offset:0 sc1
    s_waitcnt lgkmcnt(4)
    v_mfma_f32_16x16x32_bf16 v[40:43], v[216:219], v[184:187], v[40:43]
    ds_read_b128 v[196:199], v32 offset:21504
    v_mfma_f32_16x16x32_bf16 v[60:63], v[216:219], v[188:191], v[60:63]
    s_waitcnt lgkmcnt(4)
    v_mfma_f32_16x16x32_bf16 v[44:47], v[220:223], v[184:187], v[44:47]
    ds_read_b128 v[200:203], v32 offset:22528
    v_mfma_f32_16x16x32_bf16 v[64:67], v[220:223], v[188:191], v[64:67]
    s_add_u32 s52, s52, 4096
    buffer_load_dwordx4 v[180:183], v5, s[8:11], s52 offen offset:0 sc1
    s_waitcnt lgkmcnt(4)
    v_mfma_f32_16x16x32_bf16 v[48:51], v[224:227], v[184:187], v[48:51]
    ds_read_b128 v[204:207], v32 offset:23552
    v_mfma_f32_16x16x32_bf16 v[68:71], v[224:227], v[188:191], v[68:71]
    s_waitcnt lgkmcnt(4)
    v_mfma_f32_16x16x32_bf16 v[52:55], v[228:231], v[184:187], v[52:55]
    ds_read_b128 v[208:211], v32 offset:24576
    v_mfma_f32_16x16x32_bf16 v[72:75], v[228:231], v[188:191], v[72:75]
    s_waitcnt vmcnt(8)
    s_waitcnt lgkmcnt(4)
    v_mfma_f32_16x16x32_bf16 v[36:39], v[192:195], v[144:147], v[36:39]
    ds_read_b128 v[212:215], v32 offset:30720
    v_mfma_f32_16x16x32_bf16 v[56:59], v[192:195], v[148:151], v[56:59]
    buffer_load_dwordx2 v[184:185], v10, s[8:11], s26 offen offset:2048 sc1
    buffer_load_dwordx2 v[186:187], v10, s[8:11], s26 offen offset:2560 sc1
    s_waitcnt lgkmcnt(4)
    v_mfma_f32_16x16x32_bf16 v[40:43], v[196:199], v[144:147], v[40:43]
    ds_read_b128 v[216:219], v32 offset:31744
    v_mfma_f32_16x16x32_bf16 v[60:63], v[196:199], v[148:151], v[60:63]
    s_waitcnt lgkmcnt(4)
    v_mfma_f32_16x16x32_bf16 v[44:47], v[200:203], v[144:147], v[44:47]
    ds_read_b128 v[220:223], v32 offset:32768
    v_mfma_f32_16x16x32_bf16 v[64:67], v[200:203], v[148:151], v[64:67]
    buffer_load_dwordx2 v[188:189], v10, s[8:11], s52 offen offset:2048 sc1
    buffer_load_dwordx2 v[190:191], v10, s[8:11], s52 offen offset:2560 sc1
    s_waitcnt lgkmcnt(4)
    v_mfma_f32_16x16x32_bf16 v[48:51], v[204:207], v[144:147], v[48:51]
    ds_read_b128 v[224:227], v32 offset:33792
    v_mfma_f32_16x16x32_bf16 v[68:71], v[204:207], v[148:151], v[68:71]
    s_waitcnt lgkmcnt(4)
    v_mfma_f32_16x16x32_bf16 v[52:55], v[208:211], v[144:147], v[52:55]
    ds_read_b128 v[228:231], v32 offset:34816
    v_mfma_f32_16x16x32_bf16 v[72:75], v[208:211], v[148:151], v[72:75]
    s_waitcnt vmcnt(10)
    s_waitcnt lgkmcnt(4)
    v_mfma_f32_16x16x32_bf16 v[36:39], v[212:215], v[152:155], v[36:39]
    ds_read_b128 v[192:195], v32 offset:40960
    v_mfma_f32_16x16x32_bf16 v[56:59], v[212:215], v[156:159], v[56:59]
    s_add_u32 s26, s26, 4096
    buffer_load_dwordx2 v[144:145], v10, s[8:11], s26 offen offset:0 sc1
    buffer_load_dwordx2 v[146:147], v10, s[8:11], s26 offen offset:512 sc1
    s_waitcnt lgkmcnt(4)
    v_mfma_f32_16x16x32_bf16 v[40:43], v[216:219], v[152:155], v[40:43]
    ds_read_b128 v[196:199], v32 offset:41984
    v_mfma_f32_16x16x32_bf16 v[60:63], v[216:219], v[156:159], v[60:63]
    s_waitcnt lgkmcnt(4)
    v_mfma_f32_16x16x32_bf16 v[44:47], v[220:223], v[152:155], v[44:47]
    ds_read_b128 v[200:203], v32 offset:43008
    v_mfma_f32_16x16x32_bf16 v[64:67], v[220:223], v[156:159], v[64:67]
    s_add_u32 s52, s52, 4096
    buffer_load_dwordx2 v[148:149], v10, s[8:11], s52 offen offset:0 sc1
    buffer_load_dwordx2 v[150:151], v10, s[8:11], s52 offen offset:512 sc1
    s_waitcnt lgkmcnt(4)
    v_mfma_f32_16x16x32_bf16 v[48:51], v[224:227], v[152:155], v[48:51]
    ds_read_b128 v[204:207], v32 offset:44032
    v_mfma_f32_16x16x32_bf16 v[68:71], v[224:227], v[156:159], v[68:71]
    s_waitcnt lgkmcnt(4)
    v_mfma_f32_16x16x32_bf16 v[52:55], v[228:231], v[152:155], v[52:55]
    ds_read_b128 v[208:211], v32 offset:45056
    v_mfma_f32_16x16x32_bf16 v[72:75], v[228:231], v[156:159], v[72:75]
    s_waitcnt vmcnt(12)
    s_waitcnt lgkmcnt(4)
    v_mfma_f32_16x16x32_bf16 v[36:39], v[192:195], v[160:163], v[36:39]
    ds_read_b128 v[212:215], v32 offset:51200
    v_mfma_f32_16x16x32_bf16 v[56:59], v[192:195], v[164:167], v[56:59]
    buffer_load_dwordx2 v[152:153], v10, s[8:11], s26 offen offset:2048 sc1
    buffer_load_dwordx2 v[154:155], v10, s[8:11], s26 offen offset:2560 sc1
    s_waitcnt lgkmcnt(4)
    v_mfma_f32_16x16x32_bf16 v[40:43], v[196:199], v[160:163], v[40:43]
    ds_read_b128 v[216:219], v32 offset:52224
    v_mfma_f32_16x16x32_bf16 v[60:63], v[196:199], v[164:167], v[60:63]
    s_waitcnt lgkmcnt(4)
    v_mfma_f32_16x16x32_bf16 v[44:47], v[200:203], v[160:163], v[44:47]
    ds_read_b128 v[220:223], v32 offset:53248
    v_mfma_f32_16x16x32_bf16 v[64:67], v[200:203], v[164:167], v[64:67]
    buffer_load_dwordx2 v[156:157], v10, s[8:11], s52 offen offset:2048 sc1
    buffer_load_dwordx2 v[158:159], v10, s[8:11], s52 offen offset:2560 sc1
    s_waitcnt lgkmcnt(4)
    v_mfma_f32_16x16x32_bf16 v[48:51], v[204:207], v[160:163], v[48:51]
    ds_read_b128 v[224:227], v32 offset:54272
    v_mfma_f32_16x16x32_bf16 v[68:71], v[204:207], v[164:167], v[68:71]
    s_waitcnt lgkmcnt(4)
    v_mfma_f32_16x16x32_bf16 v[52:55], v[208:211], v[160:163], v[52:55]
    ds_read_b128 v[228:231], v32 offset:55296
    v_mfma_f32_16x16x32_bf16 v[72:75], v[208:211], v[164:167], v[72:75]
    s_waitcnt vmcnt(14)
    s_waitcnt lgkmcnt(4)
    v_mfma_f32_16x16x32_bf16 v[36:39], v[212:215], v[168:171], v[36:39]
    ds_read_b128 v[192:195], v32 offset:61440
    v_mfma_f32_16x16x32_bf16 v[56:59], v[212:215], v[172:175], v[56:59]
    s_add_u32 s26, s26, 4096
    buffer_load_dwordx2 v[160:161], v10, s[8:11], s26 offen offset:0 sc1
    buffer_load_dwordx2 v[162:163], v10, s[8:11], s26 offen offset:512 sc1
    s_waitcnt lgkmcnt(4)
    v_mfma_f32_16x16x32_bf16 v[40:43], v[216:219], v[168:171], v[40:43]
    ds_read_b128 v[196:199], v32 offset:62464
    v_mfma_f32_16x16x32_bf16 v[60:63], v[216:219], v[172:175], v[60:63]
    s_waitcnt lgkmcnt(4)
    v_mfma_f32_16x16x32_bf16 v[44:47], v[220:223], v[168:171], v[44:47]
    ds_read_b128 v[200:203], v32 offset:63488
    v_mfma_f32_16x16x32_bf16 v[64:67], v[220:223], v[172:175], v[64:67]
    s_add_u32 s52, s52, 4096
    buffer_load_dwordx2 v[164:165], v10, s[8:11], s52 offen offset:0 sc1
    buffer_load_dwordx2 v[166:167], v10, s[8:11], s52 offen offset:512 sc1
    s_waitcnt lgkmcnt(4)
    v_mfma_f32_16x16x32_bf16 v[48:51], v[224:227], v[168:171], v[48:51]
    ds_read_b128 v[204:207], v32 offset:64512
    v_mfma_f32_16x16x32_bf16 v[68:71], v[224:227], v[172:175], v[68:71]
    s_waitcnt lgkmcnt(4)
    v_mfma_f32_16x16x32_bf16 v[52:55], v[228:231], v[168:171], v[52:55]
    ds_read_b128 v[208:211], v33 offset:0
    v_mfma_f32_16x16x32_bf16 v[72:75], v[228:231], v[172:175], v[72:75]
    s_waitcnt vmcnt(16)
    s_waitcnt lgkmcnt(4)
    v_mfma_f32_16x16x32_bf16 v[36:39], v[192:195], v[176:179], v[36:39]
    ds_read_b128 v[212:215], v33 offset:6144
    v_mfma_f32_16x16x32_bf16 v[56:59], v[192:195], v[180:183], v[56:59]
    s_waitcnt lgkmcnt(4)
    v_mfma_f32_16x16x32_bf16 v[40:43], v[196:199], v[176:179], v[40:43]
    ds_read_b128 v[216:219], v33 offset:7168
    v_mfma_f32_16x16x32_bf16 v[60:63], v[196:199], v[180:183], v[60:63]
    s_waitcnt lgkmcnt(4)
    v_mfma_f32_16x16x32_bf16 v[44:47], v[200:203], v[176:179], v[44:47]
    ds_read_b128 v[220:223], v33 offset:8192
    v_mfma_f32_16x16x32_bf16 v[64:67], v[200:203], v[180:183], v[64:67]
    s_waitcnt lgkmcnt(4)
    v_mfma_f32_16x16x32_bf16 v[48:51], v[204:207], v[176:179], v[48:51]
    ds_read_b128 v[224:227], v33 offset:9216
    v_mfma_f32_16x16x32_bf16 v[68:71], v[204:207], v[180:183], v[68:71]
    s_waitcnt lgkmcnt(4)
    v_mfma_f32_16x16x32_bf16 v[52:55], v[208:211], v[176:179], v[52:55]
    ds_read_b128 v[228:231], v33 offset:10240
    v_mfma_f32_16x16x32_bf16 v[72:75], v[208:211], v[180:183], v[72:75]
    s_waitcnt vmcnt(12)
    s_waitcnt lgkmcnt(4)
    v_mfma_f32_16x16x32_bf16 v[36:39], v[212:215], v[184:187], v[36:39]
    ds_read_b128 v[192:195], v33 offset:16384
    v_mfma_f32_16x16x32_bf16 v[56:59], v[212:215], v[188:191], v[56:59]
    s_waitcnt lgkmcnt(4)
    v_mfma_f32_16x16x32_bf16 v[40:43], v[216:219], v[184:187], v[40:43]
    ds_read_b128 v[196:199], v33 offset:17408
    v_mfma_f32_16x16x32_bf16 v[60:63], v[216:219], v[188:191], v[60:63]
    s_waitcnt lgkmcnt(4)
    v_mfma_f32_16x16x32_bf16 v[44:47], v[220:223], v[184:187], v[44:47]
    ds_read_b128 v[200:203], v33 offset:18432
    v_mfma_f32_16x16x32_bf16 v[64:67], v[220:223], v[188:191], v[64:67]
    s_waitcnt lgkmcnt(4)
    v_mfma_f32_16x16x32_bf16 v[48:51], v[224:227], v[184:187], v[48:51]
    ds_read_b128 v[204:207], v33 offset:19456
    v_mfma_f32_16x16x32_bf16 v[68:71], v[224:227], v[188:191], v[68:71]
    s_waitcnt lgkmcnt(4)
    v_mfma_f32_16x16x32_bf16 v[52:55], v[228:231], v[184:187], v[52:55]
    ds_read_b128 v[208:211], v33 offset:20480
    v_mfma_f32_16x16x32_bf16 v[72:75], v[228:231], v[188:191], v[72:75]
    s_waitcnt vmcnt(8)
    s_waitcnt lgkmcnt(4)
    v_mfma_f32_16x16x32_bf16 v[36:39], v[192:195], v[144:147], v[36:39]
    ds_read_b128 v[212:215], v33 offset:26624
    v_mfma_f32_16x16x32_bf16 v[56:59], v[192:195], v[148:151], v[56:59]
    s_waitcnt lgkmcnt(4)
    v_mfma_f32_16x16x32_bf16 v[40:43], v[196:199], v[144:147], v[40:43]
    ds_read_b128 v[216:219], v33 offset:27648
    v_mfma_f32_16x16x32_bf16 v[60:63], v[196:199], v[148:151], v[60:63]
    s_waitcnt lgkmcnt(4)
    v_mfma_f32_16x16x32_bf16 v[44:47], v[200:203], v[144:147], v[44:47]
    ds_read_b128 v[220:223], v33 offset:28672
    v_mfma_f32_16x16x32_bf16 v[64:67], v[200:203], v[148:151], v[64:67]
    s_waitcnt lgkmcnt(4)
    v_mfma_f32_16x16x32_bf16 v[48:51], v[204:207], v[144:147], v[48:51]
    ds_read_b128 v[224:227], v33 offset:29696
    v_mfma_f32_16x16x32_bf16 v[68:71], v[204:207], v[148:151], v[68:71]
    s_waitcnt lgkmcnt(4)
    v_mfma_f32_16x16x32_bf16 v[52:55], v[208:211], v[144:147], v[52:55]
    ds_read_b128 v[228:231], v33 offset:30720
    v_mfma_f32_16x16x32_bf16 v[72:75], v[208:211], v[148:151], v[72:75]
    s_waitcnt vmcnt(4)
    s_waitcnt lgkmcnt(4)
    v_mfma_f32_16x16x32_bf16 v[36:39], v[212:215], v[152:155], v[36:39]
    ds_read_b128 v[192:195], v33 offset:36864
    v_mfma_f32_16x16x32_bf16 v[56:59], v[212:215], v[156:159], v[56:59]
    s_waitcnt lgkmcnt(4)
    v_mfma_f32_16x16x32_bf16 v[40:43], v[216:219], v[152:155], v[40:43]
    ds_read_b128 v[196:199], v33 offset:37888
    v_mfma_f32_16x16x32_bf16 v[60:63], v[216:219], v[156:159], v[60:63]
    s_waitcnt lgkmcnt(4)
    v_mfma_f32_16x16x32_bf16 v[44:47], v[220:223], v[152:155], v[44:47]
    ds_read_b128 v[200:203], v33 offset:38912
    v_mfma_f32_16x16x32_bf16 v[64:67], v[220:223], v[156:159], v[64:67]
    s_waitcnt lgkmcnt(4)
    v_mfma_f32_16x16x32_bf16 v[48:51], v[224:227], v[152:155], v[48:51]
    ds_read_b128 v[204:207], v33 offset:39936
    v_mfma_f32_16x16x32_bf16 v[68:71], v[224:227], v[156:159], v[68:71]
    s_waitcnt lgkmcnt(4)
    v_mfma_f32_16x16x32_bf16 v[52:55], v[228:231], v[152:155], v[52:55]
    ds_read_b128 v[208:211], v33 offset:40960
    v_mfma_f32_16x16x32_bf16 v[72:75], v[228:231], v[156:159], v[72:75]
    s_waitcnt vmcnt(0)
    s_waitcnt lgkmcnt(4)
    v_mfma_f32_16x16x32_bf16 v[56:59], v[192:195], v[164:167], v[56:59]
    s_waitcnt lgkmcnt(3)
    v_mfma_f32_16x16x32_bf16 v[60:63], v[196:199], v[164:167], v[60:63]
    s_waitcnt lgkmcnt(2)
    v_mfma_f32_16x16x32_bf16 v[64:67], v[200:203], v[164:167], v[64:67]
    s_waitcnt lgkmcnt(1)
    v_mfma_f32_16x16x32_bf16 v[68:71], v[204:207], v[164:167], v[68:71]
    s_waitcnt lgkmcnt(0)
    v_mfma_f32_16x16x32_bf16 v[72:75], v[208:211], v[164:167], v[72:75]
    v_mfma_f32_16x16x32_bf16 v[36:39], v[192:195], v[160:163], v[36:39]
    v_mfma_f32_16x16x32_bf16 v[40:43], v[196:199], v[160:163], v[40:43]
    v_mfma_f32_16x16x32_bf16 v[44:47], v[200:203], v[160:163], v[44:47]
    v_mfma_f32_16x16x32_bf16 v[48:51], v[204:207], v[160:163], v[48:51]
    v_mfma_f32_16x16x32_bf16 v[52:55], v[208:211], v[160:163], v[52:55]
    ds_write_b128 v232, v[56:59] offset:0
    ds_write_b128 v232, v[60:63] offset:1024
    ds_write_b128 v232, v[64:67] offset:2048
    ds_write_b128 v232, v[68:71] offset:3072
    ds_write_b128 v232, v[72:75] offset:4096
    s_waitcnt lgkmcnt(0)
    s_barrier
    ds_read_b128 v[192:195], v233 offset:0
    ds_read_b128 v[196:199], v233 offset:1024
    ds_read_b128 v[200:203], v233 offset:2048
    ds_read_b128 v[204:207], v233 offset:3072
    ds_read_b128 v[208:211], v233 offset:4096
    s_waitcnt lgkmcnt(4)
    v_pk_add_f32 v[36:37], v[36:37], v[192:193]
    v_pk_add_f32 v[38:39], v[38:39], v[194:195]
    v_cvt_pk_bf16_f32 v192, v36, v37
    v_cvt_pk_bf16_f32 v193, v38, v39
    ds_write_b64 v234, v[192:193] offset:0
    s_waitcnt lgkmcnt(4)
    v_pk_add_f32 v[40:41], v[40:41], v[196:197]
    v_pk_add_f32 v[42:43], v[42:43], v[198:199]
    v_cvt_pk_bf16_f32 v196, v40, v41
    v_cvt_pk_bf16_f32 v197, v42, v43
    ds_write_b64 v234, v[196:197] offset:32
    s_waitcnt lgkmcnt(4)
    v_pk_add_f32 v[44:45], v[44:45], v[200:201]
    v_pk_add_f32 v[46:47], v[46:47], v[202:203]
    v_cvt_pk_bf16_f32 v200, v44, v45
    v_cvt_pk_bf16_f32 v201, v46, v47
    ds_write_b64 v234, v[200:201] offset:64
    s_waitcnt lgkmcnt(4)
    v_pk_add_f32 v[48:49], v[48:49], v[204:205]
    v_pk_add_f32 v[50:51], v[50:51], v[206:207]
    v_cvt_pk_bf16_f32 v204, v48, v49
    v_cvt_pk_bf16_f32 v205, v50, v51
    ds_write_b64 v234, v[204:205] offset:96
    s_waitcnt lgkmcnt(4)
    v_pk_add_f32 v[52:53], v[52:53], v[208:209]
    v_pk_add_f32 v[54:55], v[54:55], v[210:211]
    v_cvt_pk_bf16_f32 v208, v52, v53
    v_cvt_pk_bf16_f32 v209, v54, v55
    ds_write_b64 v235, v[208:209]
    s_waitcnt lgkmcnt(0)
    ds_read_b128 v[212:215], v236 offset:0
    ds_read_b128 v[216:219], v236 offset:1024
    ds_read_b128 v[220:223], v236 offset:2048
    s_waitcnt lgkmcnt(2)
    buffer_store_dwordx4 v[212:215], v237, s[20:23], s55 offen
    s_waitcnt lgkmcnt(1)
    buffer_store_dwordx4 v[216:219], v238, s[20:23], s55 offen
    s_waitcnt lgkmcnt(0)
    s_mov_b32 exec_hi, 0
    buffer_store_dwordx4 v[220:223], v239, s[20:23], s55 offen
    s_mov_b32 exec_hi, -1
L_f_end:
    s_endpgm
L_f_help:
    v_add_u32 v22, s91, v5
    s_mul_i32 s88, s57, 276480
    s_lshl_b32 s26, s41, 10
    s_add_u32 s88, s88, s26
    s_add_u32 s88, s88, 29360128
    s_add_u32 s101, s88, 126976
    buffer_load_dwordx4 v[24:27], v5, s[8:11], s101 offen sc1
    s_add_u32 s101, s101, 4096
    buffer_load_dwordx4 v[28:31], v5, s[8:11], s101 offen sc1
    s_add_u32 s101, s101, 4096
    buffer_load_dwordx4 v[32:35], v5, s[8:11], s101 offen sc1
    s_add_u32 s101, s101, 4096
    buffer_load_dwordx4 v[36:39], v5, s[8:11], s101 offen sc1
    s_add_u32 s101, s101, 4096
    s_waitcnt vmcnt(3)
    buffer_load_dwordx4 v[40:43], v5, s[8:11], s101 offen sc1
    s_add_u32 s101, s101, 4096
    s_waitcnt vmcnt(3)
    buffer_load_dwordx4 v[44:47], v5, s[8:11], s101 offen sc1
    s_add_u32 s101, s101, 4096
    s_waitcnt vmcnt(3)
    buffer_load_dwordx4 v[48:51], v5, s[8:11], s101 offen sc1
    s_add_u32 s101, s101, 4096
    s_waitcnt vmcnt(3)
    buffer_load_dwordx4 v[52:55], v5, s[8:11], s101 offen sc1
    s_add_u32 s101, s101, 4096
    s_waitcnt vmcnt(3)
    buffer_load_dwordx4 v[56:59], v5, s[8:11], s101 offen sc1
    s_add_u32 s101, s101, 4096
    s_waitcnt vmcnt(3)
    buffer_load_dwordx4 v[60:63], v5, s[8:11], s101 offen sc1
    s_add_u32 s101, s101, 4096
    s_waitcnt vmcnt(3)
    buffer_load_dwordx4 v[64:67], v5, s[8:11], s101 offen sc1
    s_add_u32 s101, s101, 4096
    s_waitcnt vmcnt(3)
    buffer_load_dwordx4 v[68:71], v5, s[8:11], s101 offen sc1
    s_add_u32 s101, s101, 4096
    s_waitcnt vmcnt(3)
    buffer_load_dwordx4 v[72:75], v5, s[8:11], s101 offen sc1
    s_add_u32 s101, s101, 4096
    s_waitcnt vmcnt(3)
    buffer_load_dwordx4 v[76:79], v5, s[8:11], s101 offen sc1
    s_add_u32 s101, s101, 4096
    s_barrier
    s_waitcnt vmcnt(3)
    buffer_load_dwordx4 v[80:83], v5, s[8:11], s101 offen sc1
    s_add_u32 s101, s101, 4096
    s_waitcnt vmcnt(3)
    buffer_load_dwordx4 v[84:87], v5, s[8:11], s101 offen sc1
    s_add_u32 s101, s101, 4096
    s_waitcnt vmcnt(3)
    buffer_load_dwordx4 v[88:91], v5, s[8:11], s101 offen sc1
    s_add_u32 s101, s101, 4096
    s_waitcnt vmcnt(3)
    buffer_load_dwordx4 v[92:95], v5, s[8:11], s101 offen sc1
    s_add_u32 s101, s101, 4096
    s_waitcnt vmcnt(3)
    buffer_load_dwordx4 v[96:99], v5, s[8:11], s101 offen sc1
    s_add_u32 s101, s101, 4096
    s_cmp_lg_u32 s32, 5
    s_cbranch_scc1 L_f_o13
    s_load_dwordx2 s[46:47], s[0:1], 40
    s_mul_i32 s35, s59, 448
    s_add_u32 s35, s35, 16252928
    s_cmp_eq_u32 s59, 15
    s_movk_i32 s39, 440
    s_cselect_b32 s39, 184, s39
    v_min_u32 v14, s39, v10
    buffer_load_dwordx2 v[100:101], v14, s[8:11], s35 offen sc1
    s_add_u32 s35, s35, 6912
    buffer_load_dwordx2 v[102:103], v14, s[8:11], s35 offen sc1
    s_add_u32 s35, s35, 6912
    buffer_load_dwordx2 v[104:105], v14, s[8:11], s35 offen sc1
    s_add_u32 s35, s35, 6912
    buffer_load_dwordx2 v[106:107], v14, s[8:11], s35 offen sc1
    s_add_u32 s35, s35, 6912
    buffer_load_dwordx2 v[108:109], v14, s[8:11], s35 offen sc1
    s_add_u32 s35, s35, 6912
    buffer_load_dwordx2 v[110:111], v14, s[8:11], s35 offen sc1
    s_add_u32 s35, s35, 6912
    buffer_load_dwordx2 v[112:113], v14, s[8:11], s35 offen sc1
    s_add_u32 s35, s35, 6912
    buffer_load_dwordx2 v[114:115], v14, s[8:11], s35 offen sc1
    s_add_u32 s35, s35, 6912
    buffer_load_dwordx2 v[116:117], v14, s[8:11], s35 offen sc1
    s_add_u32 s35, s35, 6912
    buffer_load_dwordx2 v[118:119], v14, s[8:11], s35 offen sc1
    s_add_u32 s35, s35, 6912
    buffer_load_dwordx2 v[120:121], v14, s[8:11], s35 offen sc1
    s_add_u32 s35, s35, 6912
    buffer_load_dwordx2 v[122:123], v14, s[8:11], s35 offen sc1
    s_add_u32 s35, s35, 6912
    buffer_load_dwordx2 v[124:125], v14, s[8:11], s35 offen sc1
    s_add_u32 s35, s35, 6912
    buffer_load_dwordx2 v[126:127], v14, s[8:11], s35 offen sc1
    s_add_u32 s35, s35, 6912
    buffer_load_dwordx2 v[128:129], v14, s[8:11], s35 offen sc1
    s_add_u32 s35, s35, 6912
    buffer_load_dwordx2 v[130:131], v14, s[8:11], s35 offen sc1
    s_add_u32 s35, s35, 6912
    buffer_load_dwordx2 v[132:133], v14, s[8:11], s35 offen sc1
    s_add_u32 s35, s35, 6912
    buffer_load_dwordx2 v[134:135], v14, s[8:11], s35 offen sc1
    s_add_u32 s35, s35, 6912
    buffer_load_dwordx2 v[136:137], v14, s[8:11], s35 offen sc1
    s_add_u32 s35, s35, 6912
    buffer_load_dwordx2 v[138:139], v14, s[8:11], s35 offen sc1
    s_add_u32 s35, s35, 6912
    v_lshlrev_b32 v14, 2, v1
    s_mul_i32 s35, s59, 224
    s_waitcnt lgkmcnt(0)
    s_mov_b32 s92, s46
    s_mov_b32 s93, s47
    s_mov_b32 s94, 3456
    s_mov_b32 s95, 0x00020000
    buffer_load_dword v15, v14, s[92:95], s35 offen
    v_lshrrev_b32 v16, 3, v1
    v_subrev_u32 v16, s69, v16
    v_add_u32 v17, 7, v16
    v_min_u32 v16, v16, v17
    v_lshlrev_b32 v16, 7, v16
    v_bfe_u32 v17, v1, 1, 2
    v_lshl_add_u32 v16, v17, 5, v16
    v_and_b32 v17, 1, v1
    v_lshl_add_u32 v16, v17, 3, v16
    v_add_u32 v16, 162816, v16
L_f_o13:
    v_add_u32 v2, s26, v5
    v_add_u32 v3, 0x10000, v2
    v_add_u32 v4, 0x20000, v2
    s_barrier
    ds_write_b128 v22, v[212:215] offset:0
    ds_write_b128 v22, v[216:219] offset:1024
    ds_write_b128 v22, v[220:223] offset:2048
    ds_write_b128 v22, v[224:227] offset:3072
    ds_write_b128 v22, v[228:231] offset:4096
    ds_write_b128 v22, v[232:235] offset:5120
    ds_write_b128 v22, v[236:239] offset:6144
    ds_write_b128 v22, v[240:243] offset:7168
    ds_write_b128 v22, v[244:247] offset:8192
    ds_write_b128 v22, v[248:251] offset:9216
    ds_write_b128 v22, v[252:255] offset:10240
    s_barrier
    s_cmp_lg_u32 s32, 5
    s_cbranch_scc1 L_f_o14
    s_waitcnt vmcnt(0)
    v_pk_add_f32 v[100:101], v[100:101], v[102:103]
    v_pk_add_f32 v[100:101], v[100:101], v[104:105]
    v_pk_add_f32 v[100:101], v[100:101], v[106:107]
    v_pk_add_f32 v[100:101], v[100:101], v[108:109]
    v_pk_add_f32 v[100:101], v[100:101], v[110:111]
    v_pk_add_f32 v[100:101], v[100:101], v[112:113]
    v_pk_add_f32 v[100:101], v[100:101], v[114:115]
    v_pk_add_f32 v[100:101], v[100:101], v[116:117]
    v_pk_add_f32 v[100:101], v[100:101], v[118:119]
    v_pk_add_f32 v[100:101], v[100:101], v[120:121]
    v_pk_add_f32 v[100:101], v[100:101], v[122:123]
    v_pk_add_f32 v[100:101], v[100:101], v[124:125]
    v_pk_add_f32 v[100:101], v[100:101], v[126:127]
    v_pk_add_f32 v[100:101], v[100:101], v[128:129]
    v_pk_add_f32 v[100:101], v[100:101], v[130:131]
    v_pk_add_f32 v[100:101], v[100:101], v[132:133]
    v_pk_add_f32 v[100:101], v[100:101], v[134:135]
    v_pk_add_f32 v[100:101], v[100:101], v[136:137]
    v_pk_add_f32 v[100:101], v[100:101], v[138:139]
    v_lshlrev_b32 v18, 16, v15
    v_and_b32 v19, 0xffff0000, v15
    s_mov_b32 exec_hi, 0xffffff
    ds_write_b64 v16, v[100:101]
    ds_write_b64 v16, v[18:19] offset:16
    s_mov_b32 exec_hi, -1
L_f_o14:
    s_waitcnt vmcnt(0)
    ds_write_b128 v4, v[44:47] offset:16384
    ds_write_b128 v4, v[48:51] offset:20480
    ds_write_b128 v4, v[52:55] offset:24576
    s_waitcnt lgkmcnt(0)
    s_barrier
    s_add_u32 m0, s26, 0
    s_add_u32 s27, s88, 0
    buffer_load_dwordx4 v5, s[8:11], s27 offen sc1 lds
    s_add_u32 m0, s26, 4096
    s_add_u32 s27, s88, 4096
    buffer_load_dwordx4 v5, s[8:11], s27 offen sc1 lds
    s_add_u32 m0, s26, 8192
    s_add_u32 s27, s88, 8192
    buffer_load_dwordx4 v5, s[8:11], s27 offen sc1 lds
    s_add_u32 m0, s26, 12288
    s_add_u32 s27, s88, 12288
    buffer_load_dwordx4 v5, s[8:11], s27 offen sc1 lds
    s_add_u32 m0, s26, 16384
    s_add_u32 s27, s88, 16384
    buffer_load_dwordx4 v5, s[8:11], s27 offen sc1 lds
    s_add_u32 m0, s26, 20480
    s_add_u32 s27, s88, 20480
    buffer_load_dwordx4 v5, s[8:11], s27 offen sc1 lds
    s_add_u32 m0, s26, 24576
    s_add_u32 s27, s88, 24576
    buffer_load_dwordx4 v5, s[8:11], s27 offen sc1 lds
    s_add_u32 m0, s26, 28672
    s_add_u32 s27, s88, 28672
    buffer_load_dwordx4 v5, s[8:11], s27 offen sc1 lds
    s_add_u32 m0, s26, 32768
    s_add_u32 s27, s88, 32768
    s_waitcnt vmcnt(7)
    buffer_load_dwordx4 v5, s[8:11], s27 offen sc1 lds
    s_add_u32 m0, s26, 36864
    s_add_u32 s27, s88, 36864
    s_waitcnt vmcnt(7)
    buffer_load_dwordx4 v5, s[8:11], s27 offen sc1 lds
    s_add_u32 m0, s26, 40960
    s_add_u32 s27, s88, 40960
    s_waitcnt vmcnt(7)
    buffer_load_dwordx4 v5, s[8:11], s27 offen sc1 lds
    s_add_u32 m0, s26, 45056
    s_add_u32 s27, s88, 45056
    s_waitcnt vmcnt(7)
    buffer_load_dwordx4 v5, s[8:11], s27 offen sc1 lds
    s_barrier
    s_add_u32 m0, s26, 49152
    s_add_u32 s27, s88, 49152
    s_waitcnt vmcnt(7)
    buffer_load_dwordx4 v5, s[8:11], s27 offen sc1 lds
    s_add_u32 m0, s26, 53248
    s_add_u32 s27, s88, 53248
    s_waitcnt vmcnt(7)
    buffer_load_dwordx4 v5, s[8:11], s27 offen sc1 lds
    s_add_u32 m0, s26, 57344
    s_add_u32 s27, s88, 57344
    s_waitcnt vmcnt(7)
    buffer_load_dwordx4 v5, s[8:11], s27 offen sc1 lds
    s_add_u32 m0, s26, 61440
    s_add_u32 s27, s88, 61440
    s_waitcnt vmcnt(7)
    buffer_load_dwordx4 v5, s[8:11], s27 offen sc1 lds
    s_add_u32 m0, s26, 65536
    s_add_u32 s27, s88, 65536
    s_waitcnt vmcnt(7)
    buffer_load_dwordx4 v5, s[8:11], s27 offen sc1 lds
    s_add_u32 m0, s26, 69632
    s_add_u32 s27, s88, 69632
    s_waitcnt vmcnt(7)
    buffer_load_dwordx4 v5, s[8:11], s27 offen sc1 lds
    s_add_u32 m0, s26, 73728
    s_add_u32 s27, s88, 73728
    s_waitcnt vmcnt(7)
    buffer_load_dwordx4 v5, s[8:11], s27 offen sc1 lds
    s_add_u32 m0, s26, 77824
    s_add_u32 s27, s88, 77824
    s_waitcnt vmcnt(7)
    buffer_load_dwordx4 v5, s[8:11], s27 offen sc1 lds
    s_add_u32 m0, s26, 81920
    s_add_u32 s27, s88, 81920
    s_waitcnt vmcnt(7)
    buffer_load_dwordx4 v5, s[8:11], s27 offen sc1 lds
    s_add_u32 m0, s26, 86016
    s_add_u32 s27, s88, 86016
    s_waitcnt vmcnt(7)
    buffer_load_dwordx4 v5, s[8:11], s27 offen sc1 lds
    s_add_u32 m0, s26, 90112
    s_add_u32 s27, s88, 90112
    s_waitcnt vmcnt(7)
    buffer_load_dwordx4 v5, s[8:11], s27 offen sc1 lds
    s_add_u32 m0, s26, 94208
    s_add_u32 s27, s88, 94208
    s_waitcnt vmcnt(7)
    buffer_load_dwordx4 v5, s[8:11], s27 offen sc1 lds
    s_add_u32 m0, s26, 98304
    s_add_u32 s27, s88, 98304
    s_waitcnt vmcnt(7)
    buffer_load_dwordx4 v5, s[8:11], s27 offen sc1 lds
    s_barrier
    s_add_u32 m0, s26, 102400
    s_add_u32 s27, s88, 102400
    s_waitcnt vmcnt(7)
    buffer_load_dwordx4 v5, s[8:11], s27 offen sc1 lds
    s_add_u32 m0, s26, 106496
    s_add_u32 s27, s88, 106496
    s_waitcnt vmcnt(7)
    buffer_load_dwordx4 v5, s[8:11], s27 offen sc1 lds
    s_add_u32 m0, s26, 110592
    s_add_u32 s27, s88, 110592
    s_waitcnt vmcnt(7)
    buffer_load_dwordx4 v5, s[8:11], s27 offen sc1 lds
    s_add_u32 m0, s26, 114688
    s_add_u32 s27, s88, 114688
    s_waitcnt vmcnt(7)
    buffer_load_dwordx4 v5, s[8:11], s27 offen sc1 lds
    s_add_u32 m0, s26, 118784
    s_add_u32 s27, s88, 118784
    s_waitcnt vmcnt(7)
    buffer_load_dwordx4 v5, s[8:11], s27 offen sc1 lds
    s_add_u32 m0, s26, 122880
    s_add_u32 s27, s88, 122880
    s_waitcnt vmcnt(7)
    buffer_load_dwordx4 v5, s[8:11], s27 offen sc1 lds
    ds_write_b128 v3, v[24:27] offset:61440
    ds_write_b128 v4, v[28:31] offset:0
    ds_write_b128 v4, v[32:35] offset:4096
    ds_write_b128 v4, v[36:39] offset:8192
    ds_write_b128 v4, v[40:43] offset:12288
    s_waitcnt vmcnt(0) lgkmcnt(0)
    s_barrier
    ds_write_b128 v4, v[56:59] offset:28672
    s_waitcnt lgkmcnt(0)
    s_barrier
    s_cmp_lg_u32 s32, 4
    s_cbranch_scc1 L_f_o15
    buffer_load_dword v0, v23, s[8:11], s65 offen offset:384 sc1
L_f_o15:
    ds_write_b128 v2, v[60:63] offset:0
    ds_write_b128 v2, v[64:67] offset:4096
    ds_write_b128 v2, v[68:71] offset:8192
    ds_write_b128 v2, v[72:75] offset:12288
    ds_write_b128 v2, v[76:79] offset:16384
    ds_write_b128 v2, v[80:83] offset:20480
    ds_write_b128 v2, v[84:87] offset:24576
    ds_write_b128 v2, v[88:91] offset:28672
    ds_write_b128 v2, v[92:95] offset:32768
    ds_write_b128 v2, v[96:99] offset:36864
    ds_write_b128 v2, v[140:143] offset:40960
    ds_write_b128 v2, v[144:147] offset:45056
    ds_write_b128 v2, v[148:151] offset:49152
    ds_write_b128 v2, v[152:155] offset:53248
    ds_write_b128 v2, v[156:159] offset:57344
    s_waitcnt vmcnt(0) lgkmcnt(0)
    s_cmp_lg_u32 s32, 4
    s_cbranch_scc1 L_f_o16
    v_cmp_ne_u32 vcc, 1, v0
    s_nop 4
    s_cbranch_vccz L_f_bok
    s_mov_b32 s38, 0
    s_branch L_f_q17
L_f_p17:
    s_sleep 1
L_f_q17:
    buffer_load_dword v0, v23, s[8:11], s65 offen offset:384 sc1
    s_add_u32 s38, s38, 1
    s_waitcnt vmcnt(0)
    v_cmp_ne_u32 vcc, 1, v0
    s_nop 4
    s_cbranch_vccz L_f_x17
    s_cmp_lt_u32 s38, 12
    s_cbranch_scc1 L_f_p17
    s_mov_b32 s38, 0
    s_branch L_f_q18
L_f_p18:
    s_sleep 4
L_f_q18:
    buffer_load_dword v0, v23, s[8:11], s65 offen sc1
    s_add_u32 s38, s38, 1
    s_cmp_gt_u32 s38, 100000
    s_waitcnt vmcnt(0)
    s_cbranch_scc1 L_f_x18
    v_cmp_ne_u32 vcc, 1, v0
    s_nop 4
    s_cbranch_vccnz L_f_p18
L_f_x18:
L_f_x17:
L_f_bok:
L_f_o16:
    s_barrier
    ds_write_b128 v2, v[160:163] offset:61440
    ds_write_b128 v3, v[164:167] offset:0
    ds_write_b128 v3, v[168:171] offset:4096
    ds_write_b128 v3, v[172:175] offset:8192
    ds_write_b128 v3, v[176:179] offset:12288
    ds_write_b128 v3, v[180:183] offset:16384
    ds_write_b128 v3, v[184:187] offset:20480
    ds_write_b128 v3, v[188:191] offset:24576
    ds_write_b128 v3, v[192:195] offset:28672
    ds_write_b128 v3, v[196:199] offset:32768
    ds_write_b128 v3, v[200:203] offset:36864
    ds_write_b128 v3, v[204:207] offset:40960
    s_cmp_ge_u32 s41, 2
    s_cbranch_scc1 L_f_hl
    ds_write_b128 v3, v[208:211] offset:45056
L_f_hl:
    s_waitcnt lgkmcnt(0)
    s_barrier
    s_endpgm
L_f_slow:
    v_lshrrev_b32 v4, 5, v1
    v_mul_u32_u24 v24, 10240, v4
    v_and_b32 v2, 31, v1
    v_lshl_add_u32 v24, v2, 4, v24
    s_mov_b64 s[96:97], -1
    s_mov_b32 exec_lo, 0
    v_mov_b32 v46, 0
    s_mov_b32 exec_lo, -1
    v_mov_b32 v2, 0xff800000
    s_mov_b32 s38, 0
    s_mov_b32 s35, s36
L_f_maxloop:
    buffer_load_dwordx2 v[48:49], v10, s[8:11], s35 offen offset:0 sc1
    buffer_load_dwordx2 v[50:51], v10, s[8:11], s35 offen offset:512 sc1
    buffer_load_dwordx2 v[52:53], v25, s[8:11], s35 offen offset:1024 sc1
    s_waitcnt vmcnt(0)
    v_mfma_f32_32x32x8_bf16 v[88:103], v[52:53], v[46:47], 0
    v_mfma_f32_32x32x16_bf16 v[88:103], v[48:51], v[40:43], v[88:103]
    s_add_u32 s35, s35, 40960
    s_nop 10
    v_max3_f32 v2, v2, v88, v89
    v_max3_f32 v2, v2, v90, v91
    v_max3_f32 v2, v2, v92, v93
    v_max3_f32 v2, v2, v94, v95
    v_max3_f32 v2, v2, v96, v97
    v_max3_f32 v2, v2, v98, v99
    v_max3_f32 v2, v2, v100, v101
    v_max3_f32 v2, v2, v102, v103
    s_add_u32 s38, s38, 1
    s_cmp_lt_u32 s38, 64
    s_cbranch_scc1 L_f_maxloop
    v_mov_b32 v3, v2
    s_nop 1
    v_permlane32_swap_b32 v2, v3
    v_max_f32 v2, v2, v3
    v_sub_f32 v104, 0, v2
    v_mov_b32 v120, 0
    v_sub_f32 v105, 0, v2
    v_mov_b32 v121, 0
    v_sub_f32 v106, 0, v2
    v_mov_b32 v122, 0
    v_sub_f32 v107, 0, v2
    v_mov_b32 v123, 0
    v_sub_f32 v108, 0, v2
    v_mov_b32 v124, 0
    v_sub_f32 v109, 0, v2
    v_mov_b32 v125, 0
    v_sub_f32 v110, 0, v2
    v_mov_b32 v126, 0
    v_sub_f32 v111, 0, v2
    v_mov_b32 v127, 0
    v_sub_f32 v112, 0, v2
    v_mov_b32 v128, 0
    v_sub_f32 v113, 0, v2
    v_mov_b32 v129, 0
    v_sub_f32 v114, 0, v2
    v_mov_b32 v130, 0
    v_sub_f32 v115, 0, v2
    v_mov_b32 v131, 0
    v_sub_f32 v116, 0, v2
    v_mov_b32 v132, 0
    v_sub_f32 v117, 0, v2
    v_mov_b32 v133, 0
    v_sub_f32 v118, 0, v2
    v_mov_b32 v134, 0
    v_sub_f32 v119, 0, v2
    v_mov_b32 v135, 0
    s_mov_b32 s38, 0
    s_mov_b32 s35, s36
L_f_slowloop:
    buffer_load_dwordx2 v[48:49], v10, s[8:11], s35 offen offset:0 sc1
    buffer_load_dwordx2 v[50:51], v10, s[8:11], s35 offen offset:512 sc1
    buffer_load_dwordx2 v[52:53], v25, s[8:11], s35 offen offset:1024 sc1
    s_mov_b64 exec, s[44:45]
    s_add_u32 s39, s3, 20480
    buffer_load_dwordx4 v[56:59], v24, s[8:11], s3 offen sc1
    buffer_load_dwordx4 v[60:63], v24, s[8:11], s39 offen sc1
    s_add_u32 s3, s3, 40960
    s_mov_b64 exec, -1
    s_waitcnt vmcnt(0)
    v_mfma_f32_32x32x8_bf16 v[88:103], v[52:53], v[46:47], v[104:119]
    v_mfma_f32_32x32x16_bf16 v[88:103], v[48:51], v[40:43], v[88:103]
    s_add_u32 s35, s35, 40960
    s_nop 10
    v_exp_f32 v88, v88
    v_exp_f32 v89, v89
    v_exp_f32 v90, v90
    v_exp_f32 v91, v91
    v_exp_f32 v92, v92
    v_exp_f32 v93, v93
    v_exp_f32 v94, v94
    v_exp_f32 v95, v95
    v_exp_f32 v96, v96
    v_exp_f32 v97, v97
    v_exp_f32 v98, v98
    v_exp_f32 v99, v99
    v_exp_f32 v100, v100
    v_exp_f32 v101, v101
    v_exp_f32 v102, v102
    v_exp_f32 v103, v103
    v_cvt_pk_bf16_f32 v64, v88, v89
    v_cvt_pk_bf16_f32 v65, v90, v91
    v_cvt_pk_bf16_f32 v66, v96, v97
    v_cvt_pk_bf16_f32 v67, v98, v99
    v_cvt_pk_bf16_f32 v68, v92, v93
    v_cvt_pk_bf16_f32 v69, v94, v95
    v_cvt_pk_bf16_f32 v70, v100, v101
    v_cvt_pk_bf16_f32 v71, v102, v103
    v_mfma_f32_32x32x16_bf16 v[120:135], v[56:59], v[64:67], v[120:135]
    s_nop 0
    v_mfma_f32_32x32x16_bf16 v[120:135], v[60:63], v[68:71], v[120:135]
    s_add_u32 s38, s38, 1
    s_cmp_lt_u32 s38, 64
    s_cbranch_scc1 L_f_slowloop
    s_branch L_f_store
L_qkv_help:
    s_waitcnt lgkmcnt(0)
    s_mov_b32 s20, s8
    s_mov_b32 s21, s9
    s_mov_b32 s22, 35651584
    s_mov_b32 s23, 0x00020000
    s_mov_b32 s12, s4
    s_mov_b32 s13, s5
    s_mov_b32 s14, 2621440
    s_mov_b32 s15, 0x00020000
    s_mov_b32 s76, s10
    s_mov_b32 s77, s11
    s_mov_b32 s78, 256
    s_mov_b32 s79, 0x00020000
    v_lshrrev_b32 v2, 2, v0
    v_mul_u32_u24 v3, 1280, v2
    v_and_b32 v4, 3, v0
    v_lshl_add_u32 v3, v4, 4, v3
    s_cmp_lg_u32 s24, 3
    s_cbranch_scc1 L_q_o10
    v_mov_b32 v240, 0
    v_mov_b32 v241, 0
    v_mov_b32 v242, 0
    v_mov_b32 v243, 0
    v_lshlrev_b32 v244, 4, v1
    s_lshl_b32 s27, s2, 10
    s_add_u32 s27, s27, 32505856
    buffer_store_dwordx4 v[240:243], v244, s[20:23], s27 offen sc1
L_q_o10:
    buffer_load_dwordx4 v[32:35], v3, s[12:15], s37 offen offset:0
    buffer_load_dwordx4 v[36:39], v3, s[12:15], s37 offen offset:64
    buffer_load_dwordx4 v[40:43], v3, s[12:15], s37 offen offset:128
    buffer_load_dwordx4 v[44:47], v3, s[12:15], s37 offen offset:192
    buffer_load_dwordx4 v[48:51], v3, s[12:15], s37 offen offset:256
    buffer_load_dwordx4 v[52:55], v3, s[12:15], s37 offen offset:320
    buffer_load_dwordx4 v[56:59], v3, s[12:15], s37 offen offset:384
    buffer_load_dwordx4 v[60:63], v3, s[12:15], s37 offen offset:448
    buffer_load_dwordx4 v[64:67], v3, s[12:15], s37 offen offset:512
    buffer_load_dwordx4 v[68:71], v3, s[12:15], s37 offen offset:576
    buffer_load_dwordx4 v[72:75], v3, s[12:15], s37 offen offset:640
    buffer_load_dwordx4 v[76:79], v3, s[12:15], s37 offen offset:704
    buffer_load_dwordx4 v[80:83], v3, s[12:15], s37 offen offset:768
    buffer_load_dwordx4 v[84:87], v3, s[12:15], s37 offen offset:832
    buffer_load_dwordx4 v[88:91], v3, s[12:15], s37 offen offset:896
    buffer_load_dwordx4 v[92:95], v3, s[12:15], s37 offen offset:960
    buffer_load_dwordx4 v[96:99], v3, s[12:15], s37 offen offset:1024
    buffer_load_dwordx4 v[100:103], v3, s[12:15], s37 offen offset:1088
    buffer_load_dwordx4 v[104:107], v3, s[12:15], s37 offen offset:1152
    buffer_load_dwordx4 v[108:111], v3, s[12:15], s37 offen offset:1216
    v_mov_b32 v16, 0
    v_mov_b32 v17, 0
    v_mov_b32 v18, 0x3f803f80
    s_waitcnt vmcnt(19)
    v_dot2c_f32_bf16 v16, v32, v18
    v_dot2c_f32_bf16 v17, v32, v32
    v_dot2c_f32_bf16 v16, v33, v18
    v_dot2c_f32_bf16 v17, v33, v33
    v_dot2c_f32_bf16 v16, v34, v18
    v_dot2c_f32_bf16 v17, v34, v34
    v_dot2c_f32_bf16 v16, v35, v18
    v_dot2c_f32_bf16 v17, v35, v35
    s_waitcnt vmcnt(18)
    v_dot2c_f32_bf16 v16, v36, v18
    v_dot2c_f32_bf16 v17, v36, v36
    v_dot2c_f32_bf16 v16, v37, v18
    v_dot2c_f32_bf16 v17, v37, v37
    v_dot2c_f32_bf16 v16, v38, v18
    v_dot2c_f32_bf16 v17, v38, v38
    v_dot2c_f32_bf16 v16, v39, v18
    v_dot2c_f32_bf16 v17, v39, v39
    s_waitcnt vmcnt(17)
    v_dot2c_f32_bf16 v16, v40, v18
    v_dot2c_f32_bf16 v17, v40, v40
    v_dot2c_f32_bf16 v16, v41, v18
    v_dot2c_f32_bf16 v17, v41, v41
    v_dot2c_f32_bf16 v16, v42, v18
    v_dot2c_f32_bf16 v17, v42, v42
    v_dot2c_f32_bf16 v16, v43, v18
    v_dot2c_f32_bf16 v17, v43, v43
    s_waitcnt vmcnt(16)
    v_dot2c_f32_bf16 v16, v44, v18
    v_dot2c_f32_bf16 v17, v44, v44
    v_dot2c_f32_bf16 v16, v45, v18
    v_dot2c_f32_bf16 v17, v45, v45
    v_dot2c_f32_bf16 v16, v46, v18
    v_dot2c_f32_bf16 v17, v46, v46
    v_dot2c_f32_bf16 v16, v47, v18
    v_dot2c_f32_bf16 v17, v47, v47
    s_waitcnt vmcnt(15)
    v_dot2c_f32_bf16 v16, v48, v18
    v_dot2c_f32_bf16 v17, v48, v48
    v_dot2c_f32_bf16 v16, v49, v18
    v_dot2c_f32_bf16 v17, v49, v49
    v_dot2c_f32_bf16 v16, v50, v18
    v_dot2c_f32_bf16 v17, v50, v50
    v_dot2c_f32_bf16 v16, v51, v18
    v_dot2c_f32_bf16 v17, v51, v51
    s_waitcnt vmcnt(14)
    v_dot2c_f32_bf16 v16, v52, v18
    v_dot2c_f32_bf16 v17, v52, v52
    v_dot2c_f32_bf16 v16, v53, v18
    v_dot2c_f32_bf16 v17, v53, v53
    v_dot2c_f32_bf16 v16, v54, v18
    v_dot2c_f32_bf16 v17, v54, v54
    v_dot2c_f32_bf16 v16, v55, v18
    v_dot2c_f32_bf16 v17, v55, v55
    s_waitcnt vmcnt(13)
    v_dot2c_f32_bf16 v16, v56, v18
    v_dot2c_f32_bf16 v17, v56, v56
    v_dot2c_f32_bf16 v16, v57, v18
    v_dot2c_f32_bf16 v17, v57, v57
    v_dot2c_f32_bf16 v16, v58, v18
    v_dot2c_f32_bf16 v17, v58, v58
    v_dot2c_f32_bf16 v16, v59, v18
    v_dot2c_f32_bf16 v17, v59, v59
    s_waitcnt vmcnt(12)
    v_dot2c_f32_bf16 v16, v60, v18
    v_dot2c_f32_bf16 v17, v60, v60
    v_dot2c_f32_bf16 v16, v61, v18
    v_dot2c_f32_bf16 v17, v61, v61
    v_dot2c_f32_bf16 v16, v62, v18
    v_dot2c_f32_bf16 v17, v62, v62
    v_dot2c_f32_bf16 v16, v63, v18
    v_dot2c_f32_bf16 v17, v63, v63
    s_waitcnt vmcnt(11)
    v_dot2c_f32_bf16 v16, v64, v18
    v_dot2c_f32_bf16 v17, v64, v64
    v_dot2c_f32_bf16 v16, v65, v18
    v_dot2c_f32_bf16 v17, v65, v65
    v_dot2c_f32_bf16 v16, v66, v18
    v_dot2c_f32_bf16 v17, v66, v66
    v_dot2c_f32_bf16 v16, v67, v18
    v_dot2c_f32_bf16 v17, v67, v67
    s_waitcnt vmcnt(10)
    v_dot2c_f32_bf16 v16, v68, v18
    v_dot2c_f32_bf16 v17, v68, v68
    v_dot2c_f32_bf16 v16, v69, v18
    v_dot2c_f32_bf16 v17, v69, v69
    v_dot2c_f32_bf16 v16, v70, v18
    v_dot2c_f32_bf16 v17, v70, v70
    v_dot2c_f32_bf16 v16, v71, v18
    v_dot2c_f32_bf16 v17, v71, v71
    s_waitcnt vmcnt(9)
    v_dot2c_f32_bf16 v16, v72, v18
    v_dot2c_f32_bf16 v17, v72, v72
    v_dot2c_f32_bf16 v16, v73, v18
    v_dot2c_f32_bf16 v17, v73, v73
    v_dot2c_f32_bf16 v16, v74, v18
    v_dot2c_f32_bf16 v17, v74, v74
    v_dot2c_f32_bf16 v16, v75, v18
    v_dot2c_f32_bf16 v17, v75, v75
    s_waitcnt vmcnt(8)
    v_dot2c_f32_bf16 v16, v76, v18
    v_dot2c_f32_bf16 v17, v76, v76
    v_dot2c_f32_bf16 v16, v77, v18
    v_dot2c_f32_bf16 v17, v77, v77
    v_dot2c_f32_bf16 v16, v78, v18
    v_dot2c_f32_bf16 v17, v78, v78
    v_dot2c_f32_bf16 v16, v79, v18
    v_dot2c_f32_bf16 v17, v79, v79
    s_waitcnt vmcnt(7)
    v_dot2c_f32_bf16 v16, v80, v18
    v_dot2c_f32_bf16 v17, v80, v80
    v_dot2c_f32_bf16 v16, v81, v18
    v_dot2c_f32_bf16 v17, v81, v81
    v_dot2c_f32_bf16 v16, v82, v18
    v_dot2c_f32_bf16 v17, v82, v82
    v_dot2c_f32_bf16 v16, v83, v18
    v_dot2c_f32_bf16 v17, v83, v83
    s_waitcnt vmcnt(6)
    v_dot2c_f32_bf16 v16, v84, v18
    v_dot2c_f32_bf16 v17, v84, v84
    v_dot2c_f32_bf16 v16, v85, v18
    v_dot2c_f32_bf16 v17, v85, v85
    v_dot2c_f32_bf16 v16, v86, v18
    v_dot2c_f32_bf16 v17, v86, v86
    v_dot2c_f32_bf16 v16, v87, v18
    v_dot2c_f32_bf16 v17, v87, v87
    s_waitcnt vmcnt(5)
    v_dot2c_f32_bf16 v16, v88, v18
    v_dot2c_f32_bf16 v17, v88, v88
    v_dot2c_f32_bf16 v16, v89, v18
    v_dot2c_f32_bf16 v17, v89, v89
    v_dot2c_f32_bf16 v16, v90, v18
    v_dot2c_f32_bf16 v17, v90, v90
    v_dot2c_f32_bf16 v16, v91, v18
    v_dot2c_f32_bf16 v17, v91, v91
    s_waitcnt vmcnt(4)
    v_dot2c_f32_bf16 v16, v92, v18
    v_dot2c_f32_bf16 v17, v92, v92
    v_dot2c_f32_bf16 v16, v93, v18
    v_dot2c_f32_bf16 v17, v93, v93
    v_dot2c_f32_bf16 v16, v94, v18
    v_dot2c_f32_bf16 v17, v94, v94
    v_dot2c_f32_bf16 v16, v95, v18
    v_dot2c_f32_bf16 v17, v95, v95
    s_waitcnt vmcnt(3)
    v_dot2c_f32_bf16 v16, v96, v18
    v_dot2c_f32_bf16 v17, v96, v96
    v_dot2c_f32_bf16 v16, v97, v18
    v_dot2c_f32_bf16 v17, v97, v97
    v_dot2c_f32_bf16 v16, v98, v18
    v_dot2c_f32_bf16 v17, v98, v98
    v_dot2c_f32_bf16 v16, v99, v18
    v_dot2c_f32_bf16 v17, v99, v99
    s_waitcnt vmcnt(2)
    v_dot2c_f32_bf16 v16, v100, v18
    v_dot2c_f32_bf16 v17, v100, v100
    v_dot2c_f32_bf16 v16, v101, v18
    v_dot2c_f32_bf16 v17, v101, v101
    v_dot2c_f32_bf16 v16, v102, v18
    v_dot2c_f32_bf16 v17, v102, v102
    v_dot2c_f32_bf16 v16, v103, v18
    v_dot2c_f32_bf16 v17, v103, v103
    s_waitcnt vmcnt(1)
    v_dot2c_f32_bf16 v16, v104, v18
    v_dot2c_f32_bf16 v17, v104, v104
    v_dot2c_f32_bf16 v16, v105, v18
    v_dot2c_f32_bf16 v17, v105, v105
    v_dot2c_f32_bf16 v16, v106, v18
    v_dot2c_f32_bf16 v17, v106, v106
    v_dot2c_f32_bf16 v16, v107, v18
    v_dot2c_f32_bf16 v17, v107, v107
    s_waitcnt vmcnt(0)
    v_dot2c_f32_bf16 v16, v108, v18
    v_dot2c_f32_bf16 v17, v108, v108
    v_dot2c_f32_bf16 v16, v109, v18
    v_dot2c_f32_bf16 v17, v109, v109
    v_dot2c_f32_bf16 v16, v110, v18
    v_dot2c_f32_bf16 v17, v110, v110
    v_dot2c_f32_bf16 v16, v111, v18
    v_dot2c_f32_bf16 v17, v111, v111
    s_nop 1
    v_add_f32_dpp v16, v16, v16 quad_perm:[1,0,3,2] row_mask:0xf bank_mask:0xf
    v_add_f32_dpp v17, v17, v17 quad_perm:[1,0,3,2] row_mask:0xf bank_mask:0xf
    s_nop 0
    v_add_f32_dpp v16, v16, v16 quad_perm:[2,3,0,1] row_mask:0xf bank_mask:0xf
    v_add_f32_dpp v17, v17, v17 quad_perm:[2,3,0,1] row_mask:0xf bank_mask:0xf
    v_mul_f32 v19, 0xbacccccd, v16
    v_mul_f32 v17, 0x3acccccd, v17
    v_fma_f32 v17, -v19, v19, v17
    v_max_f32 v17, 0, v17
    v_add_f32 v17, 0x3727c5ac, v17
    v_rsq_f32 v16, v17
    v_lshlrev_b32 v2, 3, v2
    v_mul_f32 v17, v16, v19
    s_lshl_b32 s27, s25, 10
    s_add_u32 s27, s27, 16121856
    s_mov_b32 exec_lo, 0x11111111
    s_mov_b32 exec_hi, 0x11111111
    buffer_store_dwordx2 v[16:17], v2, s[20:23], s27 offen sc1
    s_mov_b64 exec, -1
    s_waitcnt vmcnt(0)
    s_barrier
    s_cmp_lg_u32 s24, 0
    s_cbranch_scc1 L_q_o11
    v_mov_b32 v16, 1
    s_lshl_b32 s27, s25, 2
    s_mov_b64 exec, 1
    buffer_store_dword v16, v246, s[76:79], s27 offen sc1
    s_mov_b64 exec, -1
L_q_o11:
    s_cmp_lg_u32 s24, 3
    s_cbranch_scc1 L_q_o12
    s_and_b32 s27, s2, 31
    s_lshl_b32 s27, s27, 2
    s_add_u32 s27, s27, 128
    v_mov_b32 v245, 1
    s_mov_b64 exec, 1
    buffer_atomic_add v245, v246, s[76:79], s27 offen sc1
    s_mov_b64 exec, -1
L_q_o12:
    s_branch L_qkv_join
.section .rodata,"a"
.p2align 6
.amdhsa_kernel sequential_preLN__mha_block__mixer_channel_mlp__prompt_kernel
  .amdhsa_next_free_vgpr 256
  .amdhsa_next_free_sgpr 102
  .amdhsa_accum_offset 256
  .amdhsa_group_segment_fixed_size 0
  .amdhsa_kernarg_size 88
  .amdhsa_user_sgpr_count 2
  .amdhsa_user_sgpr_kernarg_segment_ptr 1
  .amdhsa_system_sgpr_workgroup_id_x 1
  .amdhsa_float_denorm_mode_32 3
.end_amdhsa_kernel
```
